```python
import torch

def _softmax(x, axis=-1):
    return torch.softmax(x, dim=axis)
def _gelu(x):
    return torch.nn.functional.gelu(x, approximate="tanh")
def _silu(x):
    return torch.nn.functional.silu(x)
def _sigmoid(x):
    return torch.sigmoid(x)
def _layernorm(x, axis=-1, eps=1e-5):
    m = x.mean(dim=axis, keepdim=True)
    v = x.var(dim=axis, keepdim=True, unbiased=False)
    return (x - m) / torch.sqrt(v + eps)
def _scatter_add(tgt, idx, src, axis=0):
    return tgt.clone().index_add_(axis, idx, src)
def _segment_sum(src, seg, n):
    out = torch.zeros((n,) + src.shape[1:], dtype=src.dtype)
    return out.index_add_(0, seg, src)
def _pad(x, pw):
    flat = tuple(v for pair in reversed(pw) for v in pair)
    return torch.nn.functional.pad(x, flat)

kernel_name = 'parallel_sum__sliding_block__glu_gated_reglu__prompt'

def setup_inputs():

    _w = (lambda a: (lambda t: t.to(torch.bfloat16) if t.is_floating_point() else t)(torch.as_tensor(a)))
    def _A_setup():
        B, S, D = 1, 2048, 640
        return {
            "x": _w((lambda *s: torch.randn(*s, dtype=torch.bfloat16) * 0.05)(B, S, D)),
            "wqkv": _w((lambda *s: torch.randn(*s, dtype=torch.bfloat16) * 0.05)(D, 3 * D)),
            "wo": _w((lambda *s: torch.randn(*s, dtype=torch.bfloat16) * 0.05)(D, D)),
        }
    _A_in = _A_setup()

    def _B_setup():
        B, S, D, F = 1, 2048, 640, 1728
        return {
            "x": _w((lambda *s: torch.randn(*s, dtype=torch.bfloat16) * 0.05)(B, S, D)),
            "W_gate": _w((lambda *s: torch.randn(*s, dtype=torch.bfloat16) * 0.8)(D, F) * (2.0 / D) ** 0.5),
            "W_up": _w((lambda *s: torch.randn(*s, dtype=torch.bfloat16) * 0.8)(D, F) * (2.0 / D) ** 0.5),
            "W_down": _w((lambda *s: torch.randn(*s, dtype=torch.bfloat16) * 0.8)(F, D) * (1.0 / F) ** 0.5),
        }
    _B_in = _B_setup()

    return {
        "A_x": _A_in["x"],
        "A_wqkv": _A_in["wqkv"],
        "A_wo": _A_in["wo"],
        "B_x": _B_in["x"],
        "B_W_gate": _B_in["W_gate"],
        "B_W_up": _B_in["W_up"],
        "B_W_down": _B_in["W_down"],
    }

def reference(A_x, A_wqkv, A_wo, B_x, B_W_gate, B_W_up, B_W_down):
    def _A_ref(x, wqkv, wo):
        B, S, D = x.shape
        H = 32; Dh = D // H; W = 256
        qkv = (lambda x, *d: x.permute(*d))((x @ wqkv).reshape(B, S, 3, H, Dh), 2, 0, 3, 1, 4)
        q, k, v = qkv[0], qkv[1], qkv[2]
        scores = torch.einsum("bhqd,bhkd->bhqk", q, k) * (Dh ** -0.5)
        idx = torch.arange(S)
        mask = (idx[:, None] - idx[None, :] >= 0) & (idx[:, None] - idx[None, :] < W)
        scores = torch.where(mask[None, None], scores, -1e9)
        p = _softmax(scores, axis=-1)
        o = torch.einsum("bhqk,bhkd->bhqd", p, v)
        return (lambda x, *d: x.permute(*d))(o, 0, 2, 1, 3).reshape(B, S, D) @ wo

    def _B_ref(x, W_gate, W_up, W_down):
        gate = torch.einsum("bsd,df->bsf", x, W_gate)
        up = torch.einsum("bsd,df->bsf", x, W_up)
        gate = gate * (lambda x, dt: x.to(dt))(gate > 0, gate.dtype)
        h = gate * up
        return torch.einsum("bsf,fd->bsd", h, W_down)

    x = A_x
    xn = _layernorm(x, axis=-1)
    return x + _A_ref(xn, A_wqkv, A_wo) + _B_ref(xn, B_W_gate, B_W_up, B_W_down)
```

```asm
; @launch grid=(256,1,1) block=(512,1,1) lds=163840
.amdgcn_target "amdgcn-amd-amdhsa--gfx950"
.text
.globl parallel_sum__sliding_block__glu_gated_reglu__prompt_kernel
.p2align 8
.type parallel_sum__sliding_block__glu_gated_reglu__prompt_kernel,@function
parallel_sum__sliding_block__glu_gated_reglu__prompt_kernel:

    s_cmp_ge_u32 s2, 256
    s_cbranch_scc1 k1_exit
    s_load_dwordx16 s[40:55], s[0:1], 0
    s_load_dwordx4 s[56:59], s[0:1], 64
    v_and_b32 v1, 63, v0
    v_lshrrev_b32 v2, 6, v0
    s_and_b32 s3, s2, 7
    s_lshr_b32 s4, s2, 3
    v_readfirstlane_b32 s22, v2
    s_and_b32 s5, s3, 1
    s_lshl_b32 s5, s5, 3
    s_and_b32 s6, s4, 7
    s_add_u32 s20, s5, s6
    s_lshr_b32 s5, s3, 1
    s_lshl_b32 s5, s5, 2
    s_lshr_b32 s6, s4, 3
    s_lshr_b32 s7, s3, 2
    s_lshl_b32 s7, s7, 2
    s_xor_b32 s5, s5, s7
    s_add_u32 s21, s5, s6
    s_add_u32 s21, s21, 6
    s_and_b32 s21, s21, 15
    s_lshr_b32 s5, s3, 1
    s_lshl_b32 s5, s5, 2
    s_lshr_b32 s6, s4, 3
    s_add_u32 s5, s5, s6
    s_lshl_b32 s5, s5, 2
    s_mov_b32 s6, 0x32981076
    s_mov_b32 s7, 0x54baedcf
    s_lshr_b64 s[6:7], s[6:7], s5
    s_and_b32 s21, s6, 15
    s_mov_b32 s39, 0xffff0000
    s_cmp_eq_u32 s21, 15
    s_cbranch_scc1 k1_helper
    s_cmp_ge_u32 s21, 6
    s_cbranch_scc1 k1_ffn
    s_cmp_ge_u32 s21, 4
    s_cbranch_scc1 k1_v
    s_branch k1_qk
k1_qk:
    s_and_b32 s36, s22, 3
    s_lshr_b32 s37, s22, 2
    s_mul_i32 s4, s22, 3
    s_lshl_b32 s5, s22, 1
    s_add_u32 s5, s5, 4
    s_cmp_ge_u32 s22, 4
    s_cselect_b32 s4, s5, s4
    s_lshl_b32 s27, s4, 10
    s_lshl_b32 s4, s4, 6
    s_mul_i32 s34, s21, 640
    v_add_u32 v6, s4, v1
    s_mov_b32 s4, 1639
    s_mov_b32 s5, 3840
    v_add_u32 v2, 0, v6
    v_mul_lo_u32 v3, v2, s4
    v_lshrrev_b32 v3, 16, v3
    v_mul_u32_u24 v4, 40, v3
    v_sub_u32 v4, v2, v4
    v_bfe_u32 v5, v3, 1, 1
    v_lshlrev_b32 v5, 2, v5
    v_xor_b32 v4, v4, v5
    v_mul_lo_u32 v3, v3, s5
    v_lshl_add_u32 v3, v4, 4, v3
    v_add_u32 v3, s34, v3
    v_subrev_u32 v10, 0, v3
    v_add_u32 v2, 64, v6
    v_mul_lo_u32 v3, v2, s4
    v_lshrrev_b32 v3, 16, v3
    v_mul_u32_u24 v4, 40, v3
    v_sub_u32 v4, v2, v4
    v_bfe_u32 v5, v3, 1, 1
    v_lshlrev_b32 v5, 2, v5
    v_xor_b32 v4, v4, v5
    v_mul_lo_u32 v3, v3, s5
    v_lshl_add_u32 v3, v4, 4, v3
    v_add_u32 v3, s34, v3
    v_subrev_u32 v11, 1024, v3
    v_add_u32 v2, 128, v6
    v_mul_lo_u32 v3, v2, s4
    v_lshrrev_b32 v3, 16, v3
    v_mul_u32_u24 v4, 40, v3
    v_sub_u32 v4, v2, v4
    v_bfe_u32 v5, v3, 1, 1
    v_lshlrev_b32 v5, 2, v5
    v_xor_b32 v4, v4, v5
    v_mul_lo_u32 v3, v3, s5
    v_lshl_add_u32 v3, v4, 4, v3
    v_add_u32 v3, s34, v3
    v_subrev_u32 v12, 2048, v3
    s_lshl_b32 s4, s20, 7
    s_lshl_b32 s5, s22, 4
    s_add_u32 s4, s4, s5
    s_mul_i32 s4, s4, 1280
    v_lshrrev_b32 v2, 2, v1
    v_bfe_u32 v3, v1, 4, 2
    v_and_b32 v4, 3, v1
    v_xor_b32 v4, v4, v3
    v_mul_u32_u24 v2, 1280, v2
    v_lshl_add_u32 v2, v4, 4, v2
    v_add_u32 v13, s4, v2
    s_lshl_b32 s28, s22, 10
    s_add_u32 s28, s28, 122880
    s_lshr_b32 s6, s20, 2
    s_mul_i32 s6, s6, 5
    s_and_b32 s4, s20, 3
    s_cmp_eq_u32 s4, 0
    s_cselect_b32 s5, 4, 99
    s_mul_i32 s24, s6, 122880
    s_lshl_b32 s25, s6, 6
    s_mov_b32 s60, 99
    s_cmp_eq_u32 s4, 0
    s_cselect_b32 s60, 3, s60
    s_cmp_eq_u32 s4, 5
    s_cselect_b32 s60, 2, s60
    s_cmp_eq_u32 s5, 0
    s_cselect_b32 s60, 3, s60
    s_cmp_eq_u32 s5, 5
    s_cselect_b32 s60, 2, s60
    s_mov_b32 s61, 99
    s_cmp_eq_u32 s4, 1
    s_cselect_b32 s61, 3, s61
    s_cmp_eq_u32 s4, 6
    s_cselect_b32 s61, 2, s61
    s_cmp_eq_u32 s5, 1
    s_cselect_b32 s61, 3, s61
    s_cmp_eq_u32 s5, 6
    s_cselect_b32 s61, 2, s61
    s_mov_b32 s62, 99
    s_cmp_eq_u32 s4, 2
    s_cselect_b32 s62, 3, s62
    s_cmp_eq_u32 s4, 7
    s_cselect_b32 s62, 2, s62
    s_cmp_eq_u32 s5, 2
    s_cselect_b32 s62, 3, s62
    s_cmp_eq_u32 s5, 7
    s_cselect_b32 s62, 2, s62
    s_mov_b32 s63, 99
    s_cmp_eq_u32 s4, 3
    s_cselect_b32 s63, 3, s63
    s_cmp_eq_u32 s4, 8
    s_cselect_b32 s63, 2, s63
    s_cmp_eq_u32 s5, 3
    s_cselect_b32 s63, 3, s63
    s_cmp_eq_u32 s5, 8
    s_cselect_b32 s63, 2, s63
    s_mov_b32 s64, 99
    s_cmp_eq_u32 s4, 4
    s_cselect_b32 s64, 3, s64
    s_cmp_eq_u32 s4, 9
    s_cselect_b32 s64, 2, s64
    s_cmp_eq_u32 s5, 4
    s_cselect_b32 s64, 3, s64
    s_cmp_eq_u32 s5, 9
    s_cselect_b32 s64, 2, s64
    s_lshl_b32 s5, s21, 4
    s_add_u32 s4, s20, s5
    s_mul_i32 s4, s4, 12
    s_mul_i32 s5, s37, 5
    s_add_u32 s4, s4, s5
    s_lshl_b32 s4, s4, 8
    s_add_u32 s30, s4, 131072
    s_lshl_b32 s26, 1, s36
    s_cmp_eq_u32 s36, 0
    s_cselect_b32 s26, 17, s26
    s_waitcnt lgkmcnt(0)
    s_mov_b32 s8, s40
    s_mov_b32 s9, s41
    s_mov_b32 s10, 0x280000
    s_mov_b32 s11, 0x00020000
    s_mov_b32 s12, s42
    s_mov_b32 s13, s43
    s_mov_b32 s14, 0x258000
    s_mov_b32 s15, 0x00020000
    s_cmp_ge_u32 s22, 4
    s_cbranch_scc1 k1_qk_v1
    s_add_u32 m0, s28, 0
    s_nop 0
    buffer_load_dwordx4 v13, s[8:11], s25 offen lds
    s_add_u32 m0, s27, 0
    s_add_u32 s25, s25, 64
    buffer_load_dwordx4 v10, s[12:15], s24 offen lds
    buffer_load_dwordx4 v11, s[12:15], s24 offen offset:1024 lds
    buffer_load_dwordx4 v12, s[12:15], s24 offen offset:2048 lds
    s_add_u32 s24, s24, 122880
    s_cmp_eq_u32 s25, 1280
    s_cselect_b32 s25, 0, s25
    s_cselect_b32 s24, 0, s24
    v_lshrrev_b32 v2, 4, v1
    v_bfe_u32 v3, v1, 2, 2
    v_and_b32 v4, 3, v1
    v_bfe_u32 v5, v1, 3, 1
    v_lshrrev_b32 v6, 1, v2
    v_lshl_add_u32 v6, v6, 3, v3
    v_mul_u32_u24 v6, 640, v6
    v_and_b32 v7, 1, v2
    v_lshl_add_u32 v6, v7, 5, v6
    v_lshl_add_u32 v6, v4, 3, v6
    s_mul_i32 s4, s37, 320
    v_add_u32 v6, s4, v6
    v_lshlrev_b32 v7, 6, v5
    v_sub_u32 v8, 0, v7
    s_cmp_eq_u32 s37, 0
    s_cselect_b64 vcc, -1, 0
    v_cndmask_b32 v9, v8, v7, vcc
    v_add_u32 v14, v6, v9
    v_sub_u32 v15, v6, v9
    v_add_u32 v16, 61440, v14
    v_add_u32 v17, 61440, v15
    v_and_b32 v2, 31, v1
    v_bfe_u32 v3, v1, 2, 2
    v_lshrrev_b32 v4, 5, v1
    s_lshl_b32 s5, s36, 11
    s_add_u32 s5, s5, 122880
    v_lshlrev_b32 v2, 6, v2
    v_add_u32 v2, s5, v2
    v_xor_b32 v5, v4, v3
    v_lshl_add_u32 v18, v5, 4, v2
    v_xor_b32 v19, 32, v18
    v_min_u32 v2, 319, v0
    v_lshlrev_b32 v23, 2, v2
    v_and_b32 v2, 127, v0
    v_lshlrev_b32 v24, 2, v2
    v_and_b32 v2, 15, v1
    v_lshlrev_b32 v25, 4, v2
    s_add_u32 m0, s28, 8192
    s_nop 0
    buffer_load_dwordx4 v13, s[8:11], s25 offen lds
    s_add_u32 m0, s27, 20480
    s_add_u32 s25, s25, 64
    buffer_load_dwordx4 v10, s[12:15], s24 offen lds
    buffer_load_dwordx4 v11, s[12:15], s24 offen offset:1024 lds
    buffer_load_dwordx4 v12, s[12:15], s24 offen offset:2048 lds
    s_add_u32 s24, s24, 122880
    s_cmp_eq_u32 s25, 1280
    s_cselect_b32 s25, 0, s25
    s_cselect_b32 s24, 0, s24
    v_and_b32 v2, 31, v1
    v_mov_b32 v3, 0x3f803f80
    v_cmp_eq_u32 vcc, 0, v2
    v_cmp_eq_u32 s[4:5], 17, v2
    s_nop 1
    s_or_b64 vcc, vcc, s[4:5]
    s_nop 1
    v_cndmask_b32 v32, 0, v3, vcc
    v_mov_b32 v33, v32
    v_mov_b32 v34, v32
    v_mov_b32 v35, v32
    v_mov_b32 v36, 0
    v_mov_b32 v37, 0
    v_mov_b32 v38, 0
    v_mov_b32 v39, 0
    v_mov_b32 v40, 0
    v_mov_b32 v41, 0
    v_mov_b32 v42, 0
    v_mov_b32 v43, 0
    v_mov_b32 v44, 0
    v_mov_b32 v45, 0
    v_mov_b32 v46, 0
    v_mov_b32 v47, 0
    v_mov_b32 v48, 0
    v_mov_b32 v49, 0
    v_mov_b32 v50, 0
    v_mov_b32 v51, 0
    v_mov_b32 v52, 0
    v_mov_b32 v53, 0
    v_mov_b32 v54, 0
    v_mov_b32 v55, 0
    v_mov_b32 v108, 0
    v_mov_b32 v109, 0
    v_mov_b32 v110, 0
    v_mov_b32 v111, 0
    v_mov_b32 v112, 0
    v_mov_b32 v113, 0
    s_add_u32 m0, s28, 16384
    s_nop 0
    buffer_load_dwordx4 v13, s[8:11], s25 offen lds
    s_add_u32 m0, s27, 40960
    s_add_u32 s25, s25, 64
    buffer_load_dwordx4 v10, s[12:15], s24 offen lds
    buffer_load_dwordx4 v11, s[12:15], s24 offen offset:1024 lds
    buffer_load_dwordx4 v12, s[12:15], s24 offen offset:2048 lds
    s_add_u32 s24, s24, 122880
    s_cmp_eq_u32 s25, 1280
    s_cselect_b32 s25, 0, s25
    s_cselect_b32 s24, 0, s24
    v_mov_b32 v114, 0
    v_mov_b32 v115, 0
    v_mov_b32 v116, 0
    v_mov_b32 v117, 0
    v_mov_b32 v118, 0
    v_mov_b32 v119, 0
    v_mov_b32 v120, 0
    v_mov_b32 v121, 0
    v_mov_b32 v122, 0
    v_mov_b32 v123, 0
    v_mov_b32 v124, 0
    v_mov_b32 v125, 0
    v_mov_b32 v126, 0
    v_mov_b32 v127, 0
    v_mov_b32 v128, 0
    v_mov_b32 v129, 0
    v_mov_b32 v130, 0
    v_mov_b32 v131, 0
    v_mov_b32 v132, 0
    v_mov_b32 v133, 0
    v_mov_b32 v134, 0
    v_mov_b32 v135, 0
    v_mov_b32 v136, 0
    v_mov_b32 v137, 0
    v_mov_b32 v138, 0
    v_mov_b32 v139, 0
    v_mov_b32 v140, 0
    v_mov_b32 v141, 0
    v_mov_b32 v142, 0
    v_mov_b32 v143, 0
    v_mov_b32 v144, 0
    v_mov_b32 v145, 0
    v_mov_b32 v146, 0
    v_mov_b32 v147, 0
    v_mov_b32 v148, 0
    v_mov_b32 v149, 0
    v_mov_b32 v150, 0
    s_add_u32 m0, s28, 24576
    s_nop 0
    buffer_load_dwordx4 v13, s[8:11], s25 offen lds
    s_add_u32 m0, s27, 61440
    s_add_u32 s25, s25, 64
    buffer_load_dwordx4 v10, s[12:15], s24 offen lds
    buffer_load_dwordx4 v11, s[12:15], s24 offen offset:1024 lds
    buffer_load_dwordx4 v12, s[12:15], s24 offen offset:2048 lds
    s_add_u32 s24, s24, 122880
    s_cmp_eq_u32 s25, 1280
    s_cselect_b32 s25, 0, s25
    s_cselect_b32 s24, 0, s24
    v_mov_b32 v151, 0
    v_mov_b32 v152, 0
    v_mov_b32 v153, 0
    v_mov_b32 v154, 0
    v_mov_b32 v155, 0
    v_mov_b32 v156, 0
    v_mov_b32 v157, 0
    v_mov_b32 v158, 0
    v_mov_b32 v159, 0
    v_mov_b32 v160, 0
    v_mov_b32 v161, 0
    v_mov_b32 v162, 0
    v_mov_b32 v163, 0
    v_mov_b32 v164, 0
    v_mov_b32 v165, 0
    v_mov_b32 v166, 0
    v_mov_b32 v167, 0
    v_mov_b32 v168, 0
    v_mov_b32 v169, 0
    v_mov_b32 v170, 0
    v_mov_b32 v171, 0
    v_mov_b32 v172, 0
    v_mov_b32 v173, 0
    v_mov_b32 v174, 0
    v_mov_b32 v175, 0
    v_mov_b32 v176, 0
    v_mov_b32 v177, 0
    v_mov_b32 v178, 0
    v_mov_b32 v179, 0
    v_mov_b32 v180, 0
    v_mov_b32 v181, 0
    v_mov_b32 v182, 0
    v_mov_b32 v183, 0
    v_mov_b32 v184, 0
    v_mov_b32 v185, 0
    v_mov_b32 v186, 0
    v_mov_b32 v187, 0
    s_mov_b32 s76, s56
    s_mov_b32 s77, s57
    s_mov_b32 s78, 0x100
    s_mov_b32 s79, 0x00020000
    s_add_u32 s72, s58, 0x1800000
    s_addc_u32 s73, s59, 0
    s_mov_b32 s74, 0x100000
    s_mov_b32 s75, 0x00020000
    s_waitcnt vmcnt(12)
    s_barrier
    ds_read_b64_tr_b16 v[56:57], v14 offset:0
    ds_read_b64_tr_b16 v[58:59], v14 offset:2560
    ds_read_b128 v[96:99], v18 offset:0
    ds_read_b64_tr_b16 v[60:61], v15 offset:64
    ds_read_b64_tr_b16 v[62:63], v15 offset:2624
    ds_read_b64_tr_b16 v[64:65], v14 offset:128
    ds_read_b64_tr_b16 v[66:67], v14 offset:2688
    ds_read_b64_tr_b16 v[68:69], v15 offset:192
    ds_read_b64_tr_b16 v[70:71], v15 offset:2752
    ds_read_b64_tr_b16 v[72:73], v14 offset:256
    ds_read_b64_tr_b16 v[74:75], v14 offset:2816
    s_mov_b32 s23, 3
k1_qk_loop0:
    s_waitcnt lgkmcnt(8)
    v_mfma_f32_32x32x16_bf16 v[108:123], v[56:59], v[96:99], v[108:123]
    ds_read_b64_tr_b16 v[76:77], v14 offset:10240
    ds_read_b64_tr_b16 v[78:79], v14 offset:12800
    ds_read_b128 v[100:103], v19 offset:0
    s_waitcnt lgkmcnt(9)
    v_mfma_f32_32x32x16_bf16 v[124:139], v[60:63], v[96:99], v[124:139]
    ds_read_b64_tr_b16 v[80:81], v15 offset:10304
    ds_read_b64_tr_b16 v[82:83], v15 offset:12864
    s_waitcnt lgkmcnt(9)
    v_mfma_f32_32x32x16_bf16 v[140:155], v[64:67], v[96:99], v[140:155]
    ds_read_b64_tr_b16 v[84:85], v14 offset:10368
    ds_read_b64_tr_b16 v[86:87], v14 offset:12928
    s_waitcnt lgkmcnt(9)
    v_mfma_f32_32x32x16_bf16 v[156:171], v[68:71], v[96:99], v[156:171]
    ds_read_b64_tr_b16 v[88:89], v15 offset:10432
    ds_read_b64_tr_b16 v[90:91], v15 offset:12992
    s_waitcnt lgkmcnt(9)
    v_mfma_f32_32x32x16_bf16 v[172:187], v[72:75], v[96:99], v[172:187]
    ds_read_b64_tr_b16 v[92:93], v14 offset:10496
    ds_read_b64_tr_b16 v[94:95], v14 offset:13056
    s_cmp_eq_u32 s23, s60
    s_cbranch_scc1 k1cs_1
k1cs_1_back:
    s_waitcnt vmcnt(8)
    s_barrier
    s_cmp_eq_u32 s23, 1
    s_cbranch_scc1 k1dg_2
k1dg_2_back:
    s_waitcnt lgkmcnt(8)
    v_mfma_f32_32x32x16_bf16 v[108:123], v[76:79], v[100:103], v[108:123]
    ds_read_b64_tr_b16 v[56:57], v14 offset:20480
    ds_read_b64_tr_b16 v[58:59], v14 offset:23040
    ds_read_b128 v[96:99], v18 offset:8192
    s_waitcnt lgkmcnt(9)
    v_mfma_f32_32x32x16_bf16 v[124:139], v[80:83], v[100:103], v[124:139]
    ds_read_b64_tr_b16 v[60:61], v15 offset:20544
    ds_read_b64_tr_b16 v[62:63], v15 offset:23104
    s_add_u32 m0, s28, 32768
    s_nop 0
    buffer_load_dwordx4 v13, s[8:11], s25 offen lds
    s_waitcnt lgkmcnt(9)
    v_mfma_f32_32x32x16_bf16 v[140:155], v[84:87], v[100:103], v[140:155]
    ds_read_b64_tr_b16 v[64:65], v14 offset:20608
    ds_read_b64_tr_b16 v[66:67], v14 offset:23168
    s_add_u32 m0, s27, 81920
    s_add_u32 s25, s25, 64
    buffer_load_dwordx4 v10, s[12:15], s24 offen lds
    s_waitcnt lgkmcnt(9)
    v_mfma_f32_32x32x16_bf16 v[156:171], v[88:91], v[100:103], v[156:171]
    ds_read_b64_tr_b16 v[68:69], v15 offset:20672
    ds_read_b64_tr_b16 v[70:71], v15 offset:23232
    buffer_load_dwordx4 v11, s[12:15], s24 offen offset:1024 lds
    s_waitcnt lgkmcnt(9)
    v_mfma_f32_32x32x16_bf16 v[172:187], v[92:95], v[100:103], v[172:187]
    ds_read_b64_tr_b16 v[72:73], v14 offset:20736
    ds_read_b64_tr_b16 v[74:75], v14 offset:23296
    buffer_load_dwordx4 v12, s[12:15], s24 offen offset:2048 lds
    s_add_u32 s24, s24, 122880
    s_cmp_eq_u32 s25, 1280
    s_cselect_b32 s25, 0, s25
    s_cselect_b32 s24, 0, s24
    s_waitcnt lgkmcnt(8)
    v_mfma_f32_32x32x16_bf16 v[108:123], v[56:59], v[96:99], v[108:123]
    ds_read_b64_tr_b16 v[76:77], v14 offset:30720
    ds_read_b64_tr_b16 v[78:79], v14 offset:33280
    ds_read_b128 v[100:103], v19 offset:8192
    s_waitcnt lgkmcnt(9)
    v_mfma_f32_32x32x16_bf16 v[124:139], v[60:63], v[96:99], v[124:139]
    ds_read_b64_tr_b16 v[80:81], v15 offset:30784
    ds_read_b64_tr_b16 v[82:83], v15 offset:33344
    s_waitcnt lgkmcnt(9)
    v_mfma_f32_32x32x16_bf16 v[140:155], v[64:67], v[96:99], v[140:155]
    ds_read_b64_tr_b16 v[84:85], v14 offset:30848
    ds_read_b64_tr_b16 v[86:87], v14 offset:33408
    s_waitcnt lgkmcnt(9)
    v_mfma_f32_32x32x16_bf16 v[156:171], v[68:71], v[96:99], v[156:171]
    ds_read_b64_tr_b16 v[88:89], v15 offset:30912
    ds_read_b64_tr_b16 v[90:91], v15 offset:33472
    s_waitcnt lgkmcnt(9)
    v_mfma_f32_32x32x16_bf16 v[172:187], v[72:75], v[96:99], v[172:187]
    ds_read_b64_tr_b16 v[92:93], v14 offset:30976
    ds_read_b64_tr_b16 v[94:95], v14 offset:33536
    s_cmp_eq_u32 s23, s61
    s_cbranch_scc1 k1cs_3
k1cs_3_back:
    s_waitcnt vmcnt(8)
    s_barrier
    s_waitcnt lgkmcnt(8)
    v_mfma_f32_32x32x16_bf16 v[108:123], v[76:79], v[100:103], v[108:123]
    ds_read_b64_tr_b16 v[56:57], v14 offset:40960
    ds_read_b64_tr_b16 v[58:59], v14 offset:43520
    ds_read_b128 v[96:99], v18 offset:16384
    s_waitcnt lgkmcnt(9)
    v_mfma_f32_32x32x16_bf16 v[124:139], v[80:83], v[100:103], v[124:139]
    ds_read_b64_tr_b16 v[60:61], v15 offset:41024
    ds_read_b64_tr_b16 v[62:63], v15 offset:43584
    s_add_u32 m0, s28, 0
    s_nop 0
    buffer_load_dwordx4 v13, s[8:11], s25 offen lds
    s_waitcnt lgkmcnt(9)
    v_mfma_f32_32x32x16_bf16 v[140:155], v[84:87], v[100:103], v[140:155]
    ds_read_b64_tr_b16 v[64:65], v14 offset:41088
    ds_read_b64_tr_b16 v[66:67], v14 offset:43648
    s_add_u32 m0, s27, 0
    s_add_u32 s25, s25, 64
    buffer_load_dwordx4 v10, s[12:15], s24 offen lds
    s_waitcnt lgkmcnt(9)
    v_mfma_f32_32x32x16_bf16 v[156:171], v[88:91], v[100:103], v[156:171]
    ds_read_b64_tr_b16 v[68:69], v15 offset:41152
    ds_read_b64_tr_b16 v[70:71], v15 offset:43712
    buffer_load_dwordx4 v11, s[12:15], s24 offen offset:1024 lds
    s_waitcnt lgkmcnt(9)
    v_mfma_f32_32x32x16_bf16 v[172:187], v[92:95], v[100:103], v[172:187]
    ds_read_b64_tr_b16 v[72:73], v14 offset:41216
    ds_read_b64_tr_b16 v[74:75], v14 offset:43776
    buffer_load_dwordx4 v12, s[12:15], s24 offen offset:2048 lds
    s_add_u32 s24, s24, 122880
    s_cmp_eq_u32 s25, 1280
    s_cselect_b32 s25, 0, s25
    s_cselect_b32 s24, 0, s24
    s_waitcnt lgkmcnt(8)
    v_mfma_f32_32x32x16_bf16 v[108:123], v[56:59], v[96:99], v[108:123]
    ds_read_b64_tr_b16 v[76:77], v14 offset:51200
    ds_read_b64_tr_b16 v[78:79], v14 offset:53760
    ds_read_b128 v[100:103], v19 offset:16384
    s_waitcnt lgkmcnt(9)
    v_mfma_f32_32x32x16_bf16 v[124:139], v[60:63], v[96:99], v[124:139]
    ds_read_b64_tr_b16 v[80:81], v15 offset:51264
    ds_read_b64_tr_b16 v[82:83], v15 offset:53824
    s_waitcnt lgkmcnt(9)
    v_mfma_f32_32x32x16_bf16 v[140:155], v[64:67], v[96:99], v[140:155]
    ds_read_b64_tr_b16 v[84:85], v14 offset:51328
    ds_read_b64_tr_b16 v[86:87], v14 offset:53888
    s_waitcnt lgkmcnt(9)
    v_mfma_f32_32x32x16_bf16 v[156:171], v[68:71], v[96:99], v[156:171]
    ds_read_b64_tr_b16 v[88:89], v15 offset:51392
    ds_read_b64_tr_b16 v[90:91], v15 offset:53952
    s_waitcnt lgkmcnt(9)
    v_mfma_f32_32x32x16_bf16 v[172:187], v[72:75], v[96:99], v[172:187]
    ds_read_b64_tr_b16 v[92:93], v14 offset:51456
    ds_read_b64_tr_b16 v[94:95], v14 offset:54016
    s_cmp_eq_u32 s23, s62
    s_cbranch_scc1 k1cs_4
k1cs_4_back:
    s_cmp_eq_u32 s23, 3
    s_cbranch_scc0 k1nl_5
    buffer_load_dword v22, off, s[76:79], 0 sc1
k1nl_5:
    s_waitcnt vmcnt(8)
    s_barrier
    s_cmp_eq_u32 s23, 1
    s_cbranch_scc1 k1dg_6
k1dg_6_back:
    s_waitcnt lgkmcnt(8)
    v_mfma_f32_32x32x16_bf16 v[108:123], v[76:79], v[100:103], v[108:123]
    ds_read_b64_tr_b16 v[56:57], v16 offset:0
    ds_read_b64_tr_b16 v[58:59], v16 offset:2560
    ds_read_b128 v[96:99], v18 offset:24576
    s_waitcnt lgkmcnt(9)
    v_mfma_f32_32x32x16_bf16 v[124:139], v[80:83], v[100:103], v[124:139]
    ds_read_b64_tr_b16 v[60:61], v17 offset:64
    ds_read_b64_tr_b16 v[62:63], v17 offset:2624
    s_add_u32 m0, s28, 8192
    s_nop 0
    buffer_load_dwordx4 v13, s[8:11], s25 offen lds
    s_waitcnt lgkmcnt(9)
    v_mfma_f32_32x32x16_bf16 v[140:155], v[84:87], v[100:103], v[140:155]
    ds_read_b64_tr_b16 v[64:65], v16 offset:128
    ds_read_b64_tr_b16 v[66:67], v16 offset:2688
    s_add_u32 m0, s27, 20480
    s_add_u32 s25, s25, 64
    buffer_load_dwordx4 v10, s[12:15], s24 offen lds
    s_waitcnt lgkmcnt(9)
    v_mfma_f32_32x32x16_bf16 v[156:171], v[88:91], v[100:103], v[156:171]
    ds_read_b64_tr_b16 v[68:69], v17 offset:192
    ds_read_b64_tr_b16 v[70:71], v17 offset:2752
    buffer_load_dwordx4 v11, s[12:15], s24 offen offset:1024 lds
    s_waitcnt lgkmcnt(9)
    v_mfma_f32_32x32x16_bf16 v[172:187], v[92:95], v[100:103], v[172:187]
    ds_read_b64_tr_b16 v[72:73], v16 offset:256
    ds_read_b64_tr_b16 v[74:75], v16 offset:2816
    buffer_load_dwordx4 v12, s[12:15], s24 offen offset:2048 lds
    s_add_u32 s24, s24, 122880
    s_cmp_eq_u32 s25, 1280
    s_cselect_b32 s25, 0, s25
    s_cselect_b32 s24, 0, s24
    s_waitcnt lgkmcnt(8)
    v_mfma_f32_32x32x16_bf16 v[108:123], v[56:59], v[96:99], v[108:123]
    ds_read_b64_tr_b16 v[76:77], v16 offset:10240
    ds_read_b64_tr_b16 v[78:79], v16 offset:12800
    ds_read_b128 v[100:103], v19 offset:24576
    s_waitcnt lgkmcnt(9)
    v_mfma_f32_32x32x16_bf16 v[124:139], v[60:63], v[96:99], v[124:139]
    ds_read_b64_tr_b16 v[80:81], v17 offset:10304
    ds_read_b64_tr_b16 v[82:83], v17 offset:12864
    s_waitcnt lgkmcnt(9)
    v_mfma_f32_32x32x16_bf16 v[140:155], v[64:67], v[96:99], v[140:155]
    ds_read_b64_tr_b16 v[84:85], v16 offset:10368
    ds_read_b64_tr_b16 v[86:87], v16 offset:12928
    s_waitcnt lgkmcnt(9)
    v_mfma_f32_32x32x16_bf16 v[156:171], v[68:71], v[96:99], v[156:171]
    ds_read_b64_tr_b16 v[88:89], v17 offset:10432
    ds_read_b64_tr_b16 v[90:91], v17 offset:12992
    s_waitcnt lgkmcnt(9)
    v_mfma_f32_32x32x16_bf16 v[172:187], v[72:75], v[96:99], v[172:187]
    ds_read_b64_tr_b16 v[92:93], v16 offset:10496
    ds_read_b64_tr_b16 v[94:95], v16 offset:13056
    s_cmp_eq_u32 s23, s63
    s_cbranch_scc1 k1cs_7
k1cs_7_back:
    s_waitcnt vmcnt(8)
    s_barrier
    s_waitcnt lgkmcnt(8)
    v_mfma_f32_32x32x16_bf16 v[108:123], v[76:79], v[100:103], v[108:123]
    ds_read_b64_tr_b16 v[56:57], v16 offset:20480
    ds_read_b64_tr_b16 v[58:59], v16 offset:23040
    ds_read_b128 v[96:99], v18 offset:32768
    s_waitcnt lgkmcnt(9)
    v_mfma_f32_32x32x16_bf16 v[124:139], v[80:83], v[100:103], v[124:139]
    ds_read_b64_tr_b16 v[60:61], v17 offset:20544
    ds_read_b64_tr_b16 v[62:63], v17 offset:23104
    s_add_u32 m0, s28, 16384
    s_nop 0
    buffer_load_dwordx4 v13, s[8:11], s25 offen lds
    s_waitcnt lgkmcnt(9)
    v_mfma_f32_32x32x16_bf16 v[140:155], v[84:87], v[100:103], v[140:155]
    ds_read_b64_tr_b16 v[64:65], v16 offset:20608
    ds_read_b64_tr_b16 v[66:67], v16 offset:23168
    s_add_u32 m0, s27, 40960
    s_add_u32 s25, s25, 64
    buffer_load_dwordx4 v10, s[12:15], s24 offen lds
    s_waitcnt lgkmcnt(9)
    v_mfma_f32_32x32x16_bf16 v[156:171], v[88:91], v[100:103], v[156:171]
    ds_read_b64_tr_b16 v[68:69], v17 offset:20672
    ds_read_b64_tr_b16 v[70:71], v17 offset:23232
    buffer_load_dwordx4 v11, s[12:15], s24 offen offset:1024 lds
    s_waitcnt lgkmcnt(9)
    v_mfma_f32_32x32x16_bf16 v[172:187], v[92:95], v[100:103], v[172:187]
    ds_read_b64_tr_b16 v[72:73], v16 offset:20736
    ds_read_b64_tr_b16 v[74:75], v16 offset:23296
    buffer_load_dwordx4 v12, s[12:15], s24 offen offset:2048 lds
    s_add_u32 s24, s24, 122880
    s_cmp_eq_u32 s25, 1280
    s_cselect_b32 s25, 0, s25
    s_cselect_b32 s24, 0, s24
    s_waitcnt lgkmcnt(8)
    v_mfma_f32_32x32x16_bf16 v[108:123], v[56:59], v[96:99], v[108:123]
    ds_read_b64_tr_b16 v[76:77], v16 offset:30720
    ds_read_b64_tr_b16 v[78:79], v16 offset:33280
    ds_read_b128 v[100:103], v19 offset:32768
    s_waitcnt lgkmcnt(9)
    v_mfma_f32_32x32x16_bf16 v[124:139], v[60:63], v[96:99], v[124:139]
    ds_read_b64_tr_b16 v[80:81], v17 offset:30784
    ds_read_b64_tr_b16 v[82:83], v17 offset:33344
    s_waitcnt lgkmcnt(9)
    v_mfma_f32_32x32x16_bf16 v[140:155], v[64:67], v[96:99], v[140:155]
    ds_read_b64_tr_b16 v[84:85], v16 offset:30848
    ds_read_b64_tr_b16 v[86:87], v16 offset:33408
    s_waitcnt lgkmcnt(9)
    v_mfma_f32_32x32x16_bf16 v[156:171], v[68:71], v[96:99], v[156:171]
    ds_read_b64_tr_b16 v[88:89], v17 offset:30912
    ds_read_b64_tr_b16 v[90:91], v17 offset:33472
    s_waitcnt lgkmcnt(9)
    v_mfma_f32_32x32x16_bf16 v[172:187], v[72:75], v[96:99], v[172:187]
    ds_read_b64_tr_b16 v[92:93], v16 offset:30976
    ds_read_b64_tr_b16 v[94:95], v16 offset:33536
    s_cmp_eq_u32 s23, s64
    s_cbranch_scc1 k1cs_8
k1cs_8_back:
    s_waitcnt vmcnt(8)
    s_barrier
    s_cmp_eq_u32 s23, 3
    s_cbranch_scc1 k1pub_9
k1pub_9_back:
    s_waitcnt lgkmcnt(8)
    v_mfma_f32_32x32x16_bf16 v[108:123], v[76:79], v[100:103], v[108:123]
    ds_read_b64_tr_b16 v[56:57], v14 offset:0
    ds_read_b64_tr_b16 v[58:59], v14 offset:2560
    ds_read_b128 v[96:99], v18 offset:0
    s_waitcnt lgkmcnt(9)
    v_mfma_f32_32x32x16_bf16 v[124:139], v[80:83], v[100:103], v[124:139]
    ds_read_b64_tr_b16 v[60:61], v15 offset:64
    ds_read_b64_tr_b16 v[62:63], v15 offset:2624
    s_add_u32 m0, s28, 24576
    s_nop 0
    buffer_load_dwordx4 v13, s[8:11], s25 offen lds
    s_waitcnt lgkmcnt(9)
    v_mfma_f32_32x32x16_bf16 v[140:155], v[84:87], v[100:103], v[140:155]
    ds_read_b64_tr_b16 v[64:65], v14 offset:128
    ds_read_b64_tr_b16 v[66:67], v14 offset:2688
    s_add_u32 m0, s27, 61440
    s_add_u32 s25, s25, 64
    buffer_load_dwordx4 v10, s[12:15], s24 offen lds
    s_waitcnt lgkmcnt(9)
    v_mfma_f32_32x32x16_bf16 v[156:171], v[88:91], v[100:103], v[156:171]
    ds_read_b64_tr_b16 v[68:69], v15 offset:192
    ds_read_b64_tr_b16 v[70:71], v15 offset:2752
    buffer_load_dwordx4 v11, s[12:15], s24 offen offset:1024 lds
    s_waitcnt lgkmcnt(9)
    v_mfma_f32_32x32x16_bf16 v[172:187], v[92:95], v[100:103], v[172:187]
    ds_read_b64_tr_b16 v[72:73], v14 offset:256
    ds_read_b64_tr_b16 v[74:75], v14 offset:2816
    buffer_load_dwordx4 v12, s[12:15], s24 offen offset:2048 lds
    s_add_u32 s24, s24, 122880
    s_cmp_eq_u32 s25, 1280
    s_cselect_b32 s25, 0, s25
    s_cselect_b32 s24, 0, s24
    s_sub_u32 s23, s23, 1
    s_cmp_lg_u32 s23, 0
    s_cbranch_scc1 k1_qk_loop0
    s_waitcnt lgkmcnt(8)
    v_mfma_f32_32x32x16_bf16 v[108:123], v[56:59], v[96:99], v[108:123]
    ds_read_b64_tr_b16 v[76:77], v14 offset:10240
    ds_read_b64_tr_b16 v[78:79], v14 offset:12800
    ds_read_b128 v[100:103], v19 offset:0
    s_waitcnt lgkmcnt(9)
    v_mfma_f32_32x32x16_bf16 v[124:139], v[60:63], v[96:99], v[124:139]
    ds_read_b64_tr_b16 v[80:81], v15 offset:10304
    ds_read_b64_tr_b16 v[82:83], v15 offset:12864
    s_waitcnt lgkmcnt(9)
    v_mfma_f32_32x32x16_bf16 v[140:155], v[64:67], v[96:99], v[140:155]
    ds_read_b64_tr_b16 v[84:85], v14 offset:10368
    ds_read_b64_tr_b16 v[86:87], v14 offset:12928
    s_waitcnt lgkmcnt(9)
    v_mfma_f32_32x32x16_bf16 v[156:171], v[68:71], v[96:99], v[156:171]
    ds_read_b64_tr_b16 v[88:89], v15 offset:10432
    ds_read_b64_tr_b16 v[90:91], v15 offset:12992
    s_waitcnt lgkmcnt(9)
    v_mfma_f32_32x32x16_bf16 v[172:187], v[72:75], v[96:99], v[172:187]
    ds_read_b64_tr_b16 v[92:93], v14 offset:10496
    ds_read_b64_tr_b16 v[94:95], v14 offset:13056
    s_waitcnt vmcnt(8)
    s_barrier
    s_waitcnt lgkmcnt(8)
    v_mfma_f32_32x32x16_bf16 v[108:123], v[76:79], v[100:103], v[108:123]
    ds_read_b64_tr_b16 v[56:57], v14 offset:20480
    ds_read_b64_tr_b16 v[58:59], v14 offset:23040
    ds_read_b128 v[96:99], v18 offset:8192
    s_waitcnt lgkmcnt(9)
    v_mfma_f32_32x32x16_bf16 v[124:139], v[80:83], v[100:103], v[124:139]
    ds_read_b64_tr_b16 v[60:61], v15 offset:20544
    ds_read_b64_tr_b16 v[62:63], v15 offset:23104
    s_add_u32 m0, s28, 32768
    s_nop 0
    buffer_load_dwordx4 v13, s[8:11], s25 offen lds
    s_waitcnt lgkmcnt(9)
    v_mfma_f32_32x32x16_bf16 v[140:155], v[84:87], v[100:103], v[140:155]
    ds_read_b64_tr_b16 v[64:65], v14 offset:20608
    ds_read_b64_tr_b16 v[66:67], v14 offset:23168
    s_add_u32 m0, s27, 81920
    s_add_u32 s25, s25, 64
    buffer_load_dwordx4 v10, s[12:15], s24 offen lds
    s_waitcnt lgkmcnt(9)
    v_mfma_f32_32x32x16_bf16 v[156:171], v[88:91], v[100:103], v[156:171]
    ds_read_b64_tr_b16 v[68:69], v15 offset:20672
    ds_read_b64_tr_b16 v[70:71], v15 offset:23232
    buffer_load_dwordx4 v11, s[12:15], s24 offen offset:1024 lds
    s_waitcnt lgkmcnt(9)
    v_mfma_f32_32x32x16_bf16 v[172:187], v[92:95], v[100:103], v[172:187]
    ds_read_b64_tr_b16 v[72:73], v14 offset:20736
    ds_read_b64_tr_b16 v[74:75], v14 offset:23296
    buffer_load_dwordx4 v12, s[12:15], s24 offen offset:2048 lds
    s_add_u32 s24, s24, 122880
    s_cmp_eq_u32 s25, 1280
    s_cselect_b32 s25, 0, s25
    s_cselect_b32 s24, 0, s24
    s_waitcnt lgkmcnt(8)
    v_mfma_f32_32x32x16_bf16 v[108:123], v[56:59], v[96:99], v[108:123]
    ds_read_b64_tr_b16 v[76:77], v14 offset:30720
    ds_read_b64_tr_b16 v[78:79], v14 offset:33280
    ds_read_b128 v[100:103], v19 offset:8192
    s_waitcnt lgkmcnt(9)
    v_mfma_f32_32x32x16_bf16 v[124:139], v[60:63], v[96:99], v[124:139]
    ds_read_b64_tr_b16 v[80:81], v15 offset:30784
    ds_read_b64_tr_b16 v[82:83], v15 offset:33344
    s_waitcnt lgkmcnt(9)
    v_mfma_f32_32x32x16_bf16 v[140:155], v[64:67], v[96:99], v[140:155]
    ds_read_b64_tr_b16 v[84:85], v14 offset:30848
    ds_read_b64_tr_b16 v[86:87], v14 offset:33408
    s_waitcnt lgkmcnt(9)
    v_mfma_f32_32x32x16_bf16 v[156:171], v[68:71], v[96:99], v[156:171]
    ds_read_b64_tr_b16 v[88:89], v15 offset:30912
    ds_read_b64_tr_b16 v[90:91], v15 offset:33472
    s_waitcnt lgkmcnt(9)
    v_mfma_f32_32x32x16_bf16 v[172:187], v[72:75], v[96:99], v[172:187]
    ds_read_b64_tr_b16 v[92:93], v14 offset:30976
    ds_read_b64_tr_b16 v[94:95], v14 offset:33536
    s_waitcnt vmcnt(8)
    s_barrier
    s_waitcnt lgkmcnt(8)
    v_mfma_f32_32x32x16_bf16 v[108:123], v[76:79], v[100:103], v[108:123]
    ds_read_b64_tr_b16 v[56:57], v14 offset:40960
    ds_read_b64_tr_b16 v[58:59], v14 offset:43520
    ds_read_b128 v[96:99], v18 offset:16384
    s_waitcnt lgkmcnt(9)
    v_mfma_f32_32x32x16_bf16 v[124:139], v[80:83], v[100:103], v[124:139]
    ds_read_b64_tr_b16 v[60:61], v15 offset:41024
    ds_read_b64_tr_b16 v[62:63], v15 offset:43584
    s_waitcnt lgkmcnt(9)
    v_mfma_f32_32x32x16_bf16 v[140:155], v[84:87], v[100:103], v[140:155]
    ds_read_b64_tr_b16 v[64:65], v14 offset:41088
    ds_read_b64_tr_b16 v[66:67], v14 offset:43648
    s_waitcnt lgkmcnt(9)
    v_mfma_f32_32x32x16_bf16 v[156:171], v[88:91], v[100:103], v[156:171]
    ds_read_b64_tr_b16 v[68:69], v15 offset:41152
    ds_read_b64_tr_b16 v[70:71], v15 offset:43712
    s_waitcnt lgkmcnt(9)
    v_mfma_f32_32x32x16_bf16 v[172:187], v[92:95], v[100:103], v[172:187]
    ds_read_b64_tr_b16 v[72:73], v14 offset:41216
    ds_read_b64_tr_b16 v[74:75], v14 offset:43776
    s_waitcnt lgkmcnt(8)
    v_mfma_f32_32x32x16_bf16 v[108:123], v[56:59], v[96:99], v[108:123]
    ds_read_b64_tr_b16 v[76:77], v14 offset:51200
    ds_read_b64_tr_b16 v[78:79], v14 offset:53760
    ds_read_b128 v[100:103], v19 offset:16384
    s_waitcnt lgkmcnt(9)
    v_mfma_f32_32x32x16_bf16 v[124:139], v[60:63], v[96:99], v[124:139]
    ds_read_b64_tr_b16 v[80:81], v15 offset:51264
    ds_read_b64_tr_b16 v[82:83], v15 offset:53824
    s_waitcnt lgkmcnt(9)
    v_mfma_f32_32x32x16_bf16 v[140:155], v[64:67], v[96:99], v[140:155]
    ds_read_b64_tr_b16 v[84:85], v14 offset:51328
    ds_read_b64_tr_b16 v[86:87], v14 offset:53888
    s_waitcnt lgkmcnt(9)
    v_mfma_f32_32x32x16_bf16 v[156:171], v[68:71], v[96:99], v[156:171]
    ds_read_b64_tr_b16 v[88:89], v15 offset:51392
    ds_read_b64_tr_b16 v[90:91], v15 offset:53952
    s_waitcnt lgkmcnt(9)
    v_mfma_f32_32x32x16_bf16 v[172:187], v[72:75], v[96:99], v[172:187]
    ds_read_b64_tr_b16 v[92:93], v14 offset:51456
    ds_read_b64_tr_b16 v[94:95], v14 offset:54016
    s_waitcnt vmcnt(4)
    s_barrier
    s_waitcnt lgkmcnt(8)
    v_mfma_f32_32x32x16_bf16 v[108:123], v[76:79], v[100:103], v[108:123]
    ds_read_b64_tr_b16 v[56:57], v16 offset:0
    ds_read_b64_tr_b16 v[58:59], v16 offset:2560
    ds_read_b128 v[96:99], v18 offset:24576
    s_waitcnt lgkmcnt(9)
    v_mfma_f32_32x32x16_bf16 v[124:139], v[80:83], v[100:103], v[124:139]
    ds_read_b64_tr_b16 v[60:61], v17 offset:64
    ds_read_b64_tr_b16 v[62:63], v17 offset:2624
    s_waitcnt lgkmcnt(9)
    v_mfma_f32_32x32x16_bf16 v[140:155], v[84:87], v[100:103], v[140:155]
    ds_read_b64_tr_b16 v[64:65], v16 offset:128
    ds_read_b64_tr_b16 v[66:67], v16 offset:2688
    s_waitcnt lgkmcnt(9)
    v_mfma_f32_32x32x16_bf16 v[156:171], v[88:91], v[100:103], v[156:171]
    ds_read_b64_tr_b16 v[68:69], v17 offset:192
    ds_read_b64_tr_b16 v[70:71], v17 offset:2752
    s_waitcnt lgkmcnt(9)
    v_mfma_f32_32x32x16_bf16 v[172:187], v[92:95], v[100:103], v[172:187]
    ds_read_b64_tr_b16 v[72:73], v16 offset:256
    ds_read_b64_tr_b16 v[74:75], v16 offset:2816
    s_waitcnt lgkmcnt(8)
    v_mfma_f32_32x32x16_bf16 v[108:123], v[56:59], v[96:99], v[108:123]
    ds_read_b64_tr_b16 v[76:77], v16 offset:10240
    ds_read_b64_tr_b16 v[78:79], v16 offset:12800
    ds_read_b128 v[100:103], v19 offset:24576
    s_waitcnt lgkmcnt(9)
    v_mfma_f32_32x32x16_bf16 v[124:139], v[60:63], v[96:99], v[124:139]
    ds_read_b64_tr_b16 v[80:81], v17 offset:10304
    ds_read_b64_tr_b16 v[82:83], v17 offset:12864
    s_waitcnt lgkmcnt(9)
    v_mfma_f32_32x32x16_bf16 v[140:155], v[64:67], v[96:99], v[140:155]
    ds_read_b64_tr_b16 v[84:85], v16 offset:10368
    ds_read_b64_tr_b16 v[86:87], v16 offset:12928
    s_waitcnt lgkmcnt(9)
    v_mfma_f32_32x32x16_bf16 v[156:171], v[68:71], v[96:99], v[156:171]
    ds_read_b64_tr_b16 v[88:89], v17 offset:10432
    ds_read_b64_tr_b16 v[90:91], v17 offset:12992
    s_waitcnt lgkmcnt(9)
    v_mfma_f32_32x32x16_bf16 v[172:187], v[72:75], v[96:99], v[172:187]
    ds_read_b64_tr_b16 v[92:93], v16 offset:10496
    ds_read_b64_tr_b16 v[94:95], v16 offset:13056
    v_lshlrev_b32 v3, 1, v23
    v_lshlrev_b32 v4, 2, v24
    s_mul_i32 s4, s21, 3072
    s_lshl_b32 s5, s20, 11
    s_add_u32 s5, s5, 65536
    buffer_load_dwordx2 v[20:21], v3, s[72:75], s4 offen sc1
    buffer_load_dwordx4 v[28:31], v4, s[72:75], s5 offen sc1
    s_waitcnt vmcnt(2)
    s_barrier
    s_waitcnt lgkmcnt(8)
    v_mfma_f32_32x32x16_bf16 v[108:123], v[76:79], v[100:103], v[108:123]
    ds_read_b64_tr_b16 v[56:57], v16 offset:20480
    ds_read_b64_tr_b16 v[58:59], v16 offset:23040
    ds_read_b128 v[96:99], v18 offset:32768
    s_waitcnt lgkmcnt(9)
    v_mfma_f32_32x32x16_bf16 v[124:139], v[80:83], v[100:103], v[124:139]
    ds_read_b64_tr_b16 v[60:61], v17 offset:20544
    ds_read_b64_tr_b16 v[62:63], v17 offset:23104
    s_waitcnt lgkmcnt(9)
    v_mfma_f32_32x32x16_bf16 v[140:155], v[84:87], v[100:103], v[140:155]
    ds_read_b64_tr_b16 v[64:65], v16 offset:20608
    ds_read_b64_tr_b16 v[66:67], v16 offset:23168
    s_waitcnt lgkmcnt(9)
    v_mfma_f32_32x32x16_bf16 v[156:171], v[88:91], v[100:103], v[156:171]
    ds_read_b64_tr_b16 v[68:69], v17 offset:20672
    ds_read_b64_tr_b16 v[70:71], v17 offset:23232
    s_waitcnt lgkmcnt(9)
    v_mfma_f32_32x32x16_bf16 v[172:187], v[92:95], v[100:103], v[172:187]
    ds_read_b64_tr_b16 v[72:73], v16 offset:20736
    ds_read_b64_tr_b16 v[74:75], v16 offset:23296
    s_waitcnt lgkmcnt(8)
    v_mfma_f32_32x32x16_bf16 v[108:123], v[56:59], v[96:99], v[108:123]
    ds_read_b64_tr_b16 v[76:77], v16 offset:30720
    ds_read_b64_tr_b16 v[78:79], v16 offset:33280
    ds_read_b128 v[100:103], v19 offset:32768
    s_waitcnt lgkmcnt(9)
    v_mfma_f32_32x32x16_bf16 v[124:139], v[60:63], v[96:99], v[124:139]
    ds_read_b64_tr_b16 v[80:81], v17 offset:30784
    ds_read_b64_tr_b16 v[82:83], v17 offset:33344
    s_waitcnt lgkmcnt(9)
    v_mfma_f32_32x32x16_bf16 v[140:155], v[64:67], v[96:99], v[140:155]
    ds_read_b64_tr_b16 v[84:85], v16 offset:30848
    ds_read_b64_tr_b16 v[86:87], v16 offset:33408
    s_waitcnt lgkmcnt(9)
    v_mfma_f32_32x32x16_bf16 v[156:171], v[68:71], v[96:99], v[156:171]
    ds_read_b64_tr_b16 v[88:89], v17 offset:30912
    ds_read_b64_tr_b16 v[90:91], v17 offset:33472
    s_waitcnt lgkmcnt(9)
    v_mfma_f32_32x32x16_bf16 v[172:187], v[72:75], v[96:99], v[172:187]
    ds_read_b64_tr_b16 v[92:93], v16 offset:30976
    ds_read_b64_tr_b16 v[94:95], v16 offset:33536
    s_waitcnt lgkmcnt(8)
    v_mfma_f32_32x32x16_bf16 v[108:123], v[76:79], v[100:103], v[108:123]
    s_waitcnt lgkmcnt(6)
    v_mfma_f32_32x32x16_bf16 v[124:139], v[80:83], v[100:103], v[124:139]
    s_waitcnt lgkmcnt(4)
    v_mfma_f32_32x32x16_bf16 v[140:155], v[84:87], v[100:103], v[140:155]
    s_waitcnt vmcnt(0)
    v_cmp_ne_u32 vcc, s29, v21
    v_cmp_ne_u32 s[6:7], s29, v30
    s_nop 1
    s_or_b64 vcc, vcc, s[6:7]
    s_cbranch_vccnz k1retry_10
k1back_11:
    ds_write_b32 v23, v20 offset:0
    ds_write_b32 v24, v28 offset:1536
    ds_write_b32 v24, v29 offset:2048
    s_waitcnt lgkmcnt(5)
    v_mfma_f32_32x32x16_bf16 v[156:171], v[88:91], v[100:103], v[156:171]
    s_waitcnt lgkmcnt(3)
    v_mfma_f32_32x32x16_bf16 v[172:187], v[92:95], v[100:103], v[172:187]
    s_waitcnt lgkmcnt(0)
    s_barrier
    s_branch k1_qk_epi
k1retry_10:
    s_mov_b32 s23, 200000
k1retry_10_l:
    s_sleep 2
    v_lshlrev_b32 v3, 1, v23
    v_lshlrev_b32 v4, 2, v24
    s_mul_i32 s4, s21, 3072
    s_lshl_b32 s5, s20, 11
    s_add_u32 s5, s5, 65536
    buffer_load_dwordx2 v[20:21], v3, s[72:75], s4 offen sc1
    buffer_load_dwordx4 v[28:31], v4, s[72:75], s5 offen sc1
    s_waitcnt vmcnt(0)
    v_cmp_ne_u32 vcc, s29, v21
    v_cmp_ne_u32 s[6:7], s29, v30
    s_nop 1
    s_or_b64 vcc, vcc, s[6:7]
    s_cbranch_vccz k1back_11
    s_sub_u32 s23, s23, 1
    s_cmp_lg_u32 s23, 0
    s_cbranch_scc1 k1retry_10_l
    s_branch k1back_11
k1cs_1:
    s_waitcnt lgkmcnt(0)
    s_bitcmp1_b32 s26, 0
    s_cbranch_scc0 k1cs_1_s0
    v_mfma_f32_16x16x32_bf16 v[36:39], v[32:35], v[56:59], v[36:39]
    v_mfma_f32_16x16x32_bf16 v[36:39], v[32:35], v[76:79], v[36:39]
k1cs_1_s0:
    s_bitcmp1_b32 s26, 1
    s_cbranch_scc0 k1cs_1_s1
    v_mfma_f32_16x16x32_bf16 v[40:43], v[32:35], v[60:63], v[40:43]
    v_mfma_f32_16x16x32_bf16 v[40:43], v[32:35], v[80:83], v[40:43]
k1cs_1_s1:
    s_bitcmp1_b32 s26, 2
    s_cbranch_scc0 k1cs_1_s2
    v_mfma_f32_16x16x32_bf16 v[44:47], v[32:35], v[64:67], v[44:47]
    v_mfma_f32_16x16x32_bf16 v[44:47], v[32:35], v[84:87], v[44:47]
k1cs_1_s2:
    s_bitcmp1_b32 s26, 3
    s_cbranch_scc0 k1cs_1_s3
    v_mfma_f32_16x16x32_bf16 v[48:51], v[32:35], v[68:71], v[48:51]
    v_mfma_f32_16x16x32_bf16 v[48:51], v[32:35], v[88:91], v[48:51]
k1cs_1_s3:
    s_bitcmp1_b32 s26, 4
    s_cbranch_scc0 k1cs_1_s4
    v_mfma_f32_16x16x32_bf16 v[52:55], v[32:35], v[72:75], v[52:55]
    v_mfma_f32_16x16x32_bf16 v[52:55], v[32:35], v[92:95], v[52:55]
k1cs_1_s4:
    s_branch k1cs_1_back
k1dg_2:
    s_cmp_ge_u32 s22, 3
    s_cbranch_scc1 k1dg_2_back
    v_lshrrev_b32 v2, 4, v1
    s_lshl_b32 s4, s22, 2
    v_add_u32 v2, s4, v2
    v_min_u32 v2, 9, v2
    s_mul_i32 s4, s20, 10
    v_add_u32 v2, s4, v2
    v_and_b32 v3, 15, v1
    v_mul_u32_u24 v3, 3072, v3
    v_lshl_add_u32 v3, v2, 4, v3
    s_mul_i32 s5, s21, 49152
    s_add_u32 s5, s5, 131072
    buffer_load_dwordx4 v[28:31], v3, s[72:75], s5 offen sc1
    s_branch k1dg_2_back
k1cs_3:
    s_waitcnt lgkmcnt(0)
    s_bitcmp1_b32 s26, 0
    s_cbranch_scc0 k1cs_3_s0
    v_mfma_f32_16x16x32_bf16 v[36:39], v[32:35], v[56:59], v[36:39]
    v_mfma_f32_16x16x32_bf16 v[36:39], v[32:35], v[76:79], v[36:39]
k1cs_3_s0:
    s_bitcmp1_b32 s26, 1
    s_cbranch_scc0 k1cs_3_s1
    v_mfma_f32_16x16x32_bf16 v[40:43], v[32:35], v[60:63], v[40:43]
    v_mfma_f32_16x16x32_bf16 v[40:43], v[32:35], v[80:83], v[40:43]
k1cs_3_s1:
    s_bitcmp1_b32 s26, 2
    s_cbranch_scc0 k1cs_3_s2
    v_mfma_f32_16x16x32_bf16 v[44:47], v[32:35], v[64:67], v[44:47]
    v_mfma_f32_16x16x32_bf16 v[44:47], v[32:35], v[84:87], v[44:47]
k1cs_3_s2:
    s_bitcmp1_b32 s26, 3
    s_cbranch_scc0 k1cs_3_s3
    v_mfma_f32_16x16x32_bf16 v[48:51], v[32:35], v[68:71], v[48:51]
    v_mfma_f32_16x16x32_bf16 v[48:51], v[32:35], v[88:91], v[48:51]
k1cs_3_s3:
    s_bitcmp1_b32 s26, 4
    s_cbranch_scc0 k1cs_3_s4
    v_mfma_f32_16x16x32_bf16 v[52:55], v[32:35], v[72:75], v[52:55]
    v_mfma_f32_16x16x32_bf16 v[52:55], v[32:35], v[92:95], v[52:55]
k1cs_3_s4:
    s_branch k1cs_3_back
k1cs_4:
    s_waitcnt lgkmcnt(0)
    s_bitcmp1_b32 s26, 0
    s_cbranch_scc0 k1cs_4_s0
    v_mfma_f32_16x16x32_bf16 v[36:39], v[32:35], v[56:59], v[36:39]
    v_mfma_f32_16x16x32_bf16 v[36:39], v[32:35], v[76:79], v[36:39]
k1cs_4_s0:
    s_bitcmp1_b32 s26, 1
    s_cbranch_scc0 k1cs_4_s1
    v_mfma_f32_16x16x32_bf16 v[40:43], v[32:35], v[60:63], v[40:43]
    v_mfma_f32_16x16x32_bf16 v[40:43], v[32:35], v[80:83], v[40:43]
k1cs_4_s1:
    s_bitcmp1_b32 s26, 2
    s_cbranch_scc0 k1cs_4_s2
    v_mfma_f32_16x16x32_bf16 v[44:47], v[32:35], v[64:67], v[44:47]
    v_mfma_f32_16x16x32_bf16 v[44:47], v[32:35], v[84:87], v[44:47]
k1cs_4_s2:
    s_bitcmp1_b32 s26, 3
    s_cbranch_scc0 k1cs_4_s3
    v_mfma_f32_16x16x32_bf16 v[48:51], v[32:35], v[68:71], v[48:51]
    v_mfma_f32_16x16x32_bf16 v[48:51], v[32:35], v[88:91], v[48:51]
k1cs_4_s3:
    s_bitcmp1_b32 s26, 4
    s_cbranch_scc0 k1cs_4_s4
    v_mfma_f32_16x16x32_bf16 v[52:55], v[32:35], v[72:75], v[52:55]
    v_mfma_f32_16x16x32_bf16 v[52:55], v[32:35], v[92:95], v[52:55]
k1cs_4_s4:
    s_branch k1cs_4_back
k1dg_6:
    s_cmp_ge_u32 s22, 3
    s_cbranch_scc1 k1dg_6_back
    s_mov_b32 s4, 200000
k1dg_6_l:
    v_cmp_ne_u32 vcc, s29, v30
    s_nop 1
    s_cbranch_vccz k1dg_6_ok
    s_sleep 2
    s_mul_i32 s5, s21, 49152
    s_add_u32 s5, s5, 131072
    buffer_load_dwordx4 v[28:31], v3, s[72:75], s5 offen sc1
    s_waitcnt vmcnt(0)
    s_sub_u32 s4, s4, 1
    s_cmp_lg_u32 s4, 0
    s_cbranch_scc1 k1dg_6_l
k1dg_6_ok:
    s_nop 1
    v_add_f32_dpp v28, v28, v28 row_ror:8 row_mask:0xf bank_mask:0xf
    v_add_f32_dpp v29, v29, v29 row_ror:8 row_mask:0xf bank_mask:0xf
    s_nop 1
    v_add_f32_dpp v28, v28, v28 row_ror:4 row_mask:0xf bank_mask:0xf
    v_add_f32_dpp v29, v29, v29 row_ror:4 row_mask:0xf bank_mask:0xf
    s_nop 1
    v_add_f32_dpp v28, v28, v28 row_ror:2 row_mask:0xf bank_mask:0xf
    v_add_f32_dpp v29, v29, v29 row_ror:2 row_mask:0xf bank_mask:0xf
    s_nop 1
    v_add_f32_dpp v28, v28, v28 row_ror:1 row_mask:0xf bank_mask:0xf
    v_add_f32_dpp v29, v29, v29 row_ror:1 row_mask:0xf bank_mask:0xf
    v_lshrrev_b32 v4, 4, v2
    v_and_b32 v5, 15, v2
    v_lshlrev_b32 v5, 3, v5
    v_lshl_add_u32 v5, v4, 8, v5
    v_mov_b32 v30, v29
    v_mov_b32 v29, s29
    v_mov_b32 v31, s29
    s_mul_i32 s4, s21, 3072
    s_mov_b32 exec_lo, 0x00010001
    s_mov_b32 exec_hi, 0x00010001
    buffer_store_dwordx2 v[28:29], v5, s[72:75], s4 offen sc1
    buffer_store_dwordx2 v[30:31], v5, s[72:75], s4 offen offset:128 sc1
    s_mov_b64 exec, -1
    s_branch k1dg_6_back
k1cs_7:
    s_waitcnt lgkmcnt(0)
    s_bitcmp1_b32 s26, 0
    s_cbranch_scc0 k1cs_7_s0
    v_mfma_f32_16x16x32_bf16 v[36:39], v[32:35], v[56:59], v[36:39]
    v_mfma_f32_16x16x32_bf16 v[36:39], v[32:35], v[76:79], v[36:39]
k1cs_7_s0:
    s_bitcmp1_b32 s26, 1
    s_cbranch_scc0 k1cs_7_s1
    v_mfma_f32_16x16x32_bf16 v[40:43], v[32:35], v[60:63], v[40:43]
    v_mfma_f32_16x16x32_bf16 v[40:43], v[32:35], v[80:83], v[40:43]
k1cs_7_s1:
    s_bitcmp1_b32 s26, 2
    s_cbranch_scc0 k1cs_7_s2
    v_mfma_f32_16x16x32_bf16 v[44:47], v[32:35], v[64:67], v[44:47]
    v_mfma_f32_16x16x32_bf16 v[44:47], v[32:35], v[84:87], v[44:47]
k1cs_7_s2:
    s_bitcmp1_b32 s26, 3
    s_cbranch_scc0 k1cs_7_s3
    v_mfma_f32_16x16x32_bf16 v[48:51], v[32:35], v[68:71], v[48:51]
    v_mfma_f32_16x16x32_bf16 v[48:51], v[32:35], v[88:91], v[48:51]
k1cs_7_s3:
    s_bitcmp1_b32 s26, 4
    s_cbranch_scc0 k1cs_7_s4
    v_mfma_f32_16x16x32_bf16 v[52:55], v[32:35], v[72:75], v[52:55]
    v_mfma_f32_16x16x32_bf16 v[52:55], v[32:35], v[92:95], v[52:55]
k1cs_7_s4:
    s_branch k1cs_7_back
k1cs_8:
    s_waitcnt lgkmcnt(0)
    s_bitcmp1_b32 s26, 0
    s_cbranch_scc0 k1cs_8_s0
    v_mfma_f32_16x16x32_bf16 v[36:39], v[32:35], v[56:59], v[36:39]
    v_mfma_f32_16x16x32_bf16 v[36:39], v[32:35], v[76:79], v[36:39]
k1cs_8_s0:
    s_bitcmp1_b32 s26, 1
    s_cbranch_scc0 k1cs_8_s1
    v_mfma_f32_16x16x32_bf16 v[40:43], v[32:35], v[60:63], v[40:43]
    v_mfma_f32_16x16x32_bf16 v[40:43], v[32:35], v[80:83], v[40:43]
k1cs_8_s1:
    s_bitcmp1_b32 s26, 2
    s_cbranch_scc0 k1cs_8_s2
    v_mfma_f32_16x16x32_bf16 v[44:47], v[32:35], v[64:67], v[44:47]
    v_mfma_f32_16x16x32_bf16 v[44:47], v[32:35], v[84:87], v[44:47]
k1cs_8_s2:
    s_bitcmp1_b32 s26, 3
    s_cbranch_scc0 k1cs_8_s3
    v_mfma_f32_16x16x32_bf16 v[48:51], v[32:35], v[68:71], v[48:51]
    v_mfma_f32_16x16x32_bf16 v[48:51], v[32:35], v[88:91], v[48:51]
k1cs_8_s3:
    s_bitcmp1_b32 s26, 4
    s_cbranch_scc0 k1cs_8_s4
    v_mfma_f32_16x16x32_bf16 v[52:55], v[32:35], v[72:75], v[52:55]
    v_mfma_f32_16x16x32_bf16 v[52:55], v[32:35], v[92:95], v[52:55]
k1cs_8_s4:
    s_branch k1cs_8_back
k1pub_9:
    s_nop 7
    s_mov_b32 s4, 200000
k1pub_9_n:
    v_readfirstlane_b32 s29, v22
    s_cmp_lg_u32 s29, 0
    s_cbranch_scc1 k1pub_9_ok
    s_sleep 2
    buffer_load_dword v22, off, s[76:79], 0 sc1
    s_waitcnt vmcnt(0)
    s_sub_u32 s4, s4, 1
    s_cmp_lg_u32 s4, 0
    s_cbranch_scc1 k1pub_9_n
k1pub_9_ok:
    s_mov_b64 exec, 0xffff
    s_bitcmp1_b32 s26, 0
    s_cbranch_scc0 k1pub_9_s0
    v_mov_b32 v38, s29
    v_mov_b32 v39, s29
    buffer_store_dwordx4 v[36:39], v25, s[72:75], s30 offen offset:0 sc1
k1pub_9_s0:
    s_bitcmp1_b32 s26, 1
    s_cbranch_scc0 k1pub_9_s1
    v_mov_b32 v42, s29
    v_mov_b32 v43, s29
    buffer_store_dwordx4 v[40:43], v25, s[72:75], s30 offen offset:256 sc1
k1pub_9_s1:
    s_bitcmp1_b32 s26, 2
    s_cbranch_scc0 k1pub_9_s2
    v_mov_b32 v46, s29
    v_mov_b32 v47, s29
    buffer_store_dwordx4 v[44:47], v25, s[72:75], s30 offen offset:512 sc1
k1pub_9_s2:
    s_bitcmp1_b32 s26, 3
    s_cbranch_scc0 k1pub_9_s3
    v_mov_b32 v50, s29
    v_mov_b32 v51, s29
    buffer_store_dwordx4 v[48:51], v25, s[72:75], s30 offen offset:768 sc1
k1pub_9_s3:
    s_bitcmp1_b32 s26, 4
    s_cbranch_scc0 k1pub_9_s4
    v_mov_b32 v54, s29
    v_mov_b32 v55, s29
    buffer_store_dwordx4 v[52:55], v25, s[72:75], s30 offen offset:1024 sc1
k1pub_9_s4:
    s_mov_b64 exec, -1
    s_branch k1pub_9_back
k1_qk_v1:
    s_add_u32 m0, s28, 0
    s_nop 0
    buffer_load_dwordx4 v13, s[8:11], s25 offen lds
    s_add_u32 m0, s27, 0
    s_add_u32 s25, s25, 64
    buffer_load_dwordx4 v10, s[12:15], s24 offen lds
    buffer_load_dwordx4 v11, s[12:15], s24 offen offset:1024 lds
    s_add_u32 s24, s24, 122880
    s_cmp_eq_u32 s25, 1280
    s_cselect_b32 s25, 0, s25
    s_cselect_b32 s24, 0, s24
    v_lshrrev_b32 v2, 4, v1
    v_bfe_u32 v3, v1, 2, 2
    v_and_b32 v4, 3, v1
    v_bfe_u32 v5, v1, 3, 1
    v_lshrrev_b32 v6, 1, v2
    v_lshl_add_u32 v6, v6, 3, v3
    v_mul_u32_u24 v6, 640, v6
    v_and_b32 v7, 1, v2
    v_lshl_add_u32 v6, v7, 5, v6
    v_lshl_add_u32 v6, v4, 3, v6
    s_mul_i32 s4, s37, 320
    v_add_u32 v6, s4, v6
    v_lshlrev_b32 v7, 6, v5
    v_sub_u32 v8, 0, v7
    s_cmp_eq_u32 s37, 0
    s_cselect_b64 vcc, -1, 0
    v_cndmask_b32 v9, v8, v7, vcc
    v_add_u32 v14, v6, v9
    v_sub_u32 v15, v6, v9
    v_add_u32 v16, 61440, v14
    v_add_u32 v17, 61440, v15
    v_and_b32 v2, 31, v1
    v_bfe_u32 v3, v1, 2, 2
    v_lshrrev_b32 v4, 5, v1
    s_lshl_b32 s5, s36, 11
    s_add_u32 s5, s5, 122880
    v_lshlrev_b32 v2, 6, v2
    v_add_u32 v2, s5, v2
    v_xor_b32 v5, v4, v3
    v_lshl_add_u32 v18, v5, 4, v2
    v_xor_b32 v19, 32, v18
    v_min_u32 v2, 319, v0
    v_lshlrev_b32 v23, 2, v2
    v_and_b32 v2, 127, v0
    v_lshlrev_b32 v24, 2, v2
    v_and_b32 v2, 15, v1
    v_lshlrev_b32 v25, 4, v2
    v_and_b32 v2, 31, v1
    v_mov_b32 v3, 0x3f803f80
    v_cmp_eq_u32 vcc, 0, v2
    v_cmp_eq_u32 s[4:5], 17, v2
    s_nop 1
    s_or_b64 vcc, vcc, s[4:5]
    s_nop 1
    v_cndmask_b32 v32, 0, v3, vcc
    v_mov_b32 v33, v32
    v_mov_b32 v34, v32
    v_mov_b32 v35, v32
    v_mov_b32 v36, 0
    s_add_u32 m0, s28, 8192
    s_nop 0
    buffer_load_dwordx4 v13, s[8:11], s25 offen lds
    s_add_u32 m0, s27, 20480
    s_add_u32 s25, s25, 64
    buffer_load_dwordx4 v10, s[12:15], s24 offen lds
    buffer_load_dwordx4 v11, s[12:15], s24 offen offset:1024 lds
    s_add_u32 s24, s24, 122880
    s_cmp_eq_u32 s25, 1280
    s_cselect_b32 s25, 0, s25
    s_cselect_b32 s24, 0, s24
    v_mov_b32 v37, 0
    v_mov_b32 v38, 0
    v_mov_b32 v39, 0
    v_mov_b32 v40, 0
    v_mov_b32 v41, 0
    v_mov_b32 v42, 0
    v_mov_b32 v43, 0
    v_mov_b32 v44, 0
    v_mov_b32 v45, 0
    v_mov_b32 v46, 0
    v_mov_b32 v47, 0
    v_mov_b32 v48, 0
    v_mov_b32 v49, 0
    v_mov_b32 v50, 0
    v_mov_b32 v51, 0
    v_mov_b32 v52, 0
    v_mov_b32 v53, 0
    v_mov_b32 v54, 0
    v_mov_b32 v55, 0
    v_mov_b32 v108, 0
    v_mov_b32 v109, 0
    v_mov_b32 v110, 0
    v_mov_b32 v111, 0
    v_mov_b32 v112, 0
    v_mov_b32 v113, 0
    v_mov_b32 v114, 0
    v_mov_b32 v115, 0
    v_mov_b32 v116, 0
    v_mov_b32 v117, 0
    v_mov_b32 v118, 0
    v_mov_b32 v119, 0
    v_mov_b32 v120, 0
    v_mov_b32 v121, 0
    v_mov_b32 v122, 0
    v_mov_b32 v123, 0
    v_mov_b32 v124, 0
    v_mov_b32 v125, 0
    v_mov_b32 v126, 0
    v_mov_b32 v127, 0
    v_mov_b32 v128, 0
    v_mov_b32 v129, 0
    v_mov_b32 v130, 0
    v_mov_b32 v131, 0
    v_mov_b32 v132, 0
    v_mov_b32 v133, 0
    v_mov_b32 v134, 0
    v_mov_b32 v135, 0
    v_mov_b32 v136, 0
    v_mov_b32 v137, 0
    s_add_u32 m0, s28, 16384
    s_nop 0
    buffer_load_dwordx4 v13, s[8:11], s25 offen lds
    s_add_u32 m0, s27, 40960
    s_add_u32 s25, s25, 64
    buffer_load_dwordx4 v10, s[12:15], s24 offen lds
    buffer_load_dwordx4 v11, s[12:15], s24 offen offset:1024 lds
    s_add_u32 s24, s24, 122880
    s_cmp_eq_u32 s25, 1280
    s_cselect_b32 s25, 0, s25
    s_cselect_b32 s24, 0, s24
    v_mov_b32 v138, 0
    v_mov_b32 v139, 0
    v_mov_b32 v140, 0
    v_mov_b32 v141, 0
    v_mov_b32 v142, 0
    v_mov_b32 v143, 0
    v_mov_b32 v144, 0
    v_mov_b32 v145, 0
    v_mov_b32 v146, 0
    v_mov_b32 v147, 0
    v_mov_b32 v148, 0
    v_mov_b32 v149, 0
    v_mov_b32 v150, 0
    v_mov_b32 v151, 0
    v_mov_b32 v152, 0
    v_mov_b32 v153, 0
    v_mov_b32 v154, 0
    v_mov_b32 v155, 0
    v_mov_b32 v156, 0
    v_mov_b32 v157, 0
    v_mov_b32 v158, 0
    v_mov_b32 v159, 0
    v_mov_b32 v160, 0
    v_mov_b32 v161, 0
    v_mov_b32 v162, 0
    v_mov_b32 v163, 0
    v_mov_b32 v164, 0
    v_mov_b32 v165, 0
    v_mov_b32 v166, 0
    v_mov_b32 v167, 0
    v_mov_b32 v168, 0
    v_mov_b32 v169, 0
    v_mov_b32 v170, 0
    v_mov_b32 v171, 0
    v_mov_b32 v172, 0
    v_mov_b32 v173, 0
    v_mov_b32 v174, 0
    v_mov_b32 v175, 0
    v_mov_b32 v176, 0
    v_mov_b32 v177, 0
    v_mov_b32 v178, 0
    v_mov_b32 v179, 0
    v_mov_b32 v180, 0
    v_mov_b32 v181, 0
    v_mov_b32 v182, 0
    v_mov_b32 v183, 0
    v_mov_b32 v184, 0
    v_mov_b32 v185, 0
    v_mov_b32 v186, 0
    v_mov_b32 v187, 0
    s_mov_b32 s76, s56
    s_mov_b32 s77, s57
    s_mov_b32 s78, 0x100
    s_mov_b32 s79, 0x00020000
    s_add_u32 s72, s58, 0x1800000
    s_addc_u32 s73, s59, 0
    s_mov_b32 s74, 0x100000
    s_mov_b32 s75, 0x00020000
    s_waitcnt vmcnt(6)
    s_barrier
    ds_read_b64_tr_b16 v[56:57], v14 offset:0
    ds_read_b64_tr_b16 v[58:59], v14 offset:2560
    ds_read_b128 v[96:99], v18 offset:0
    ds_read_b64_tr_b16 v[60:61], v15 offset:64
    ds_read_b64_tr_b16 v[62:63], v15 offset:2624
    ds_read_b64_tr_b16 v[64:65], v14 offset:128
    ds_read_b64_tr_b16 v[66:67], v14 offset:2688
    ds_read_b64_tr_b16 v[68:69], v15 offset:192
    ds_read_b64_tr_b16 v[70:71], v15 offset:2752
    ds_read_b64_tr_b16 v[72:73], v14 offset:256
    ds_read_b64_tr_b16 v[74:75], v14 offset:2816
    s_mov_b32 s23, 3
    s_setprio 1
k1_qk_loop1:
    s_waitcnt lgkmcnt(8)
    v_mfma_f32_32x32x16_bf16 v[108:123], v[56:59], v[96:99], v[108:123]
    ds_read_b64_tr_b16 v[76:77], v14 offset:10240
    ds_read_b64_tr_b16 v[78:79], v14 offset:12800
    ds_read_b128 v[100:103], v19 offset:0
    s_waitcnt lgkmcnt(9)
    v_mfma_f32_32x32x16_bf16 v[124:139], v[60:63], v[96:99], v[124:139]
    ds_read_b64_tr_b16 v[80:81], v15 offset:10304
    ds_read_b64_tr_b16 v[82:83], v15 offset:12864
    s_add_u32 m0, s28, 24576
    s_nop 0
    buffer_load_dwordx4 v13, s[8:11], s25 offen lds
    s_waitcnt lgkmcnt(9)
    v_mfma_f32_32x32x16_bf16 v[140:155], v[64:67], v[96:99], v[140:155]
    ds_read_b64_tr_b16 v[84:85], v14 offset:10368
    ds_read_b64_tr_b16 v[86:87], v14 offset:12928
    s_add_u32 m0, s27, 61440
    s_add_u32 s25, s25, 64
    buffer_load_dwordx4 v10, s[12:15], s24 offen lds
    s_waitcnt lgkmcnt(9)
    v_mfma_f32_32x32x16_bf16 v[156:171], v[68:71], v[96:99], v[156:171]
    ds_read_b64_tr_b16 v[88:89], v15 offset:10432
    ds_read_b64_tr_b16 v[90:91], v15 offset:12992
    buffer_load_dwordx4 v11, s[12:15], s24 offen offset:1024 lds
    s_add_u32 s24, s24, 122880
    s_cmp_eq_u32 s25, 1280
    s_cselect_b32 s25, 0, s25
    s_cselect_b32 s24, 0, s24
    s_waitcnt lgkmcnt(9)
    v_mfma_f32_32x32x16_bf16 v[172:187], v[72:75], v[96:99], v[172:187]
    ds_read_b64_tr_b16 v[92:93], v14 offset:10496
    ds_read_b64_tr_b16 v[94:95], v14 offset:13056
    s_cmp_eq_u32 s23, s60
    s_cbranch_scc1 k1cs_12
k1cs_12_back:
    s_waitcnt vmcnt(6)
    s_barrier
    s_waitcnt lgkmcnt(8)
    v_mfma_f32_32x32x16_bf16 v[108:123], v[76:79], v[100:103], v[108:123]
    ds_read_b64_tr_b16 v[56:57], v14 offset:20480
    ds_read_b64_tr_b16 v[58:59], v14 offset:23040
    ds_read_b128 v[96:99], v18 offset:8192
    s_waitcnt lgkmcnt(9)
    v_mfma_f32_32x32x16_bf16 v[124:139], v[80:83], v[100:103], v[124:139]
    ds_read_b64_tr_b16 v[60:61], v15 offset:20544
    ds_read_b64_tr_b16 v[62:63], v15 offset:23104
    s_waitcnt lgkmcnt(9)
    v_mfma_f32_32x32x16_bf16 v[140:155], v[84:87], v[100:103], v[140:155]
    ds_read_b64_tr_b16 v[64:65], v14 offset:20608
    ds_read_b64_tr_b16 v[66:67], v14 offset:23168
    s_waitcnt lgkmcnt(9)
    v_mfma_f32_32x32x16_bf16 v[156:171], v[88:91], v[100:103], v[156:171]
    ds_read_b64_tr_b16 v[68:69], v15 offset:20672
    ds_read_b64_tr_b16 v[70:71], v15 offset:23232
    s_waitcnt lgkmcnt(9)
    v_mfma_f32_32x32x16_bf16 v[172:187], v[92:95], v[100:103], v[172:187]
    ds_read_b64_tr_b16 v[72:73], v14 offset:20736
    ds_read_b64_tr_b16 v[74:75], v14 offset:23296
    s_waitcnt lgkmcnt(8)
    v_mfma_f32_32x32x16_bf16 v[108:123], v[56:59], v[96:99], v[108:123]
    ds_read_b64_tr_b16 v[76:77], v14 offset:30720
    ds_read_b64_tr_b16 v[78:79], v14 offset:33280
    ds_read_b128 v[100:103], v19 offset:8192
    s_waitcnt lgkmcnt(9)
    v_mfma_f32_32x32x16_bf16 v[124:139], v[60:63], v[96:99], v[124:139]
    ds_read_b64_tr_b16 v[80:81], v15 offset:30784
    ds_read_b64_tr_b16 v[82:83], v15 offset:33344
    s_add_u32 m0, s28, 32768
    s_nop 0
    buffer_load_dwordx4 v13, s[8:11], s25 offen lds
    s_waitcnt lgkmcnt(9)
    v_mfma_f32_32x32x16_bf16 v[140:155], v[64:67], v[96:99], v[140:155]
    ds_read_b64_tr_b16 v[84:85], v14 offset:30848
    ds_read_b64_tr_b16 v[86:87], v14 offset:33408
    s_add_u32 m0, s27, 81920
    s_add_u32 s25, s25, 64
    buffer_load_dwordx4 v10, s[12:15], s24 offen lds
    s_waitcnt lgkmcnt(9)
    v_mfma_f32_32x32x16_bf16 v[156:171], v[68:71], v[96:99], v[156:171]
    ds_read_b64_tr_b16 v[88:89], v15 offset:30912
    ds_read_b64_tr_b16 v[90:91], v15 offset:33472
    buffer_load_dwordx4 v11, s[12:15], s24 offen offset:1024 lds
    s_add_u32 s24, s24, 122880
    s_cmp_eq_u32 s25, 1280
    s_cselect_b32 s25, 0, s25
    s_cselect_b32 s24, 0, s24
    s_waitcnt lgkmcnt(9)
    v_mfma_f32_32x32x16_bf16 v[172:187], v[72:75], v[96:99], v[172:187]
    ds_read_b64_tr_b16 v[92:93], v14 offset:30976
    ds_read_b64_tr_b16 v[94:95], v14 offset:33536
    s_cmp_eq_u32 s23, s61
    s_cbranch_scc1 k1cs_13
k1cs_13_back:
    s_waitcnt vmcnt(6)
    s_barrier
    s_waitcnt lgkmcnt(8)
    v_mfma_f32_32x32x16_bf16 v[108:123], v[76:79], v[100:103], v[108:123]
    ds_read_b64_tr_b16 v[56:57], v14 offset:40960
    ds_read_b64_tr_b16 v[58:59], v14 offset:43520
    ds_read_b128 v[96:99], v18 offset:16384
    s_waitcnt lgkmcnt(9)
    v_mfma_f32_32x32x16_bf16 v[124:139], v[80:83], v[100:103], v[124:139]
    ds_read_b64_tr_b16 v[60:61], v15 offset:41024
    ds_read_b64_tr_b16 v[62:63], v15 offset:43584
    s_waitcnt lgkmcnt(9)
    v_mfma_f32_32x32x16_bf16 v[140:155], v[84:87], v[100:103], v[140:155]
    ds_read_b64_tr_b16 v[64:65], v14 offset:41088
    ds_read_b64_tr_b16 v[66:67], v14 offset:43648
    s_waitcnt lgkmcnt(9)
    v_mfma_f32_32x32x16_bf16 v[156:171], v[88:91], v[100:103], v[156:171]
    ds_read_b64_tr_b16 v[68:69], v15 offset:41152
    ds_read_b64_tr_b16 v[70:71], v15 offset:43712
    s_waitcnt lgkmcnt(9)
    v_mfma_f32_32x32x16_bf16 v[172:187], v[92:95], v[100:103], v[172:187]
    ds_read_b64_tr_b16 v[72:73], v14 offset:41216
    ds_read_b64_tr_b16 v[74:75], v14 offset:43776
    s_waitcnt lgkmcnt(8)
    v_mfma_f32_32x32x16_bf16 v[108:123], v[56:59], v[96:99], v[108:123]
    ds_read_b64_tr_b16 v[76:77], v14 offset:51200
    ds_read_b64_tr_b16 v[78:79], v14 offset:53760
    ds_read_b128 v[100:103], v19 offset:16384
    s_waitcnt lgkmcnt(9)
    v_mfma_f32_32x32x16_bf16 v[124:139], v[60:63], v[96:99], v[124:139]
    ds_read_b64_tr_b16 v[80:81], v15 offset:51264
    ds_read_b64_tr_b16 v[82:83], v15 offset:53824
    s_add_u32 m0, s28, 0
    s_nop 0
    buffer_load_dwordx4 v13, s[8:11], s25 offen lds
    s_waitcnt lgkmcnt(9)
    v_mfma_f32_32x32x16_bf16 v[140:155], v[64:67], v[96:99], v[140:155]
    ds_read_b64_tr_b16 v[84:85], v14 offset:51328
    ds_read_b64_tr_b16 v[86:87], v14 offset:53888
    s_add_u32 m0, s27, 0
    s_add_u32 s25, s25, 64
    buffer_load_dwordx4 v10, s[12:15], s24 offen lds
    s_waitcnt lgkmcnt(9)
    v_mfma_f32_32x32x16_bf16 v[156:171], v[68:71], v[96:99], v[156:171]
    ds_read_b64_tr_b16 v[88:89], v15 offset:51392
    ds_read_b64_tr_b16 v[90:91], v15 offset:53952
    buffer_load_dwordx4 v11, s[12:15], s24 offen offset:1024 lds
    s_add_u32 s24, s24, 122880
    s_cmp_eq_u32 s25, 1280
    s_cselect_b32 s25, 0, s25
    s_cselect_b32 s24, 0, s24
    s_waitcnt lgkmcnt(9)
    v_mfma_f32_32x32x16_bf16 v[172:187], v[72:75], v[96:99], v[172:187]
    ds_read_b64_tr_b16 v[92:93], v14 offset:51456
    ds_read_b64_tr_b16 v[94:95], v14 offset:54016
    s_cmp_eq_u32 s23, s62
    s_cbranch_scc1 k1cs_14
k1cs_14_back:
    s_cmp_eq_u32 s23, 3
    s_cbranch_scc0 k1nl_15
    buffer_load_dword v22, off, s[76:79], 0 sc1
k1nl_15:
    s_waitcnt vmcnt(6)
    s_barrier
    s_waitcnt lgkmcnt(8)
    v_mfma_f32_32x32x16_bf16 v[108:123], v[76:79], v[100:103], v[108:123]
    ds_read_b64_tr_b16 v[56:57], v16 offset:0
    ds_read_b64_tr_b16 v[58:59], v16 offset:2560
    ds_read_b128 v[96:99], v18 offset:24576
    s_waitcnt lgkmcnt(9)
    v_mfma_f32_32x32x16_bf16 v[124:139], v[80:83], v[100:103], v[124:139]
    ds_read_b64_tr_b16 v[60:61], v17 offset:64
    ds_read_b64_tr_b16 v[62:63], v17 offset:2624
    s_waitcnt lgkmcnt(9)
    v_mfma_f32_32x32x16_bf16 v[140:155], v[84:87], v[100:103], v[140:155]
    ds_read_b64_tr_b16 v[64:65], v16 offset:128
    ds_read_b64_tr_b16 v[66:67], v16 offset:2688
    s_waitcnt lgkmcnt(9)
    v_mfma_f32_32x32x16_bf16 v[156:171], v[88:91], v[100:103], v[156:171]
    ds_read_b64_tr_b16 v[68:69], v17 offset:192
    ds_read_b64_tr_b16 v[70:71], v17 offset:2752
    s_waitcnt lgkmcnt(9)
    v_mfma_f32_32x32x16_bf16 v[172:187], v[92:95], v[100:103], v[172:187]
    ds_read_b64_tr_b16 v[72:73], v16 offset:256
    ds_read_b64_tr_b16 v[74:75], v16 offset:2816
    s_waitcnt lgkmcnt(8)
    v_mfma_f32_32x32x16_bf16 v[108:123], v[56:59], v[96:99], v[108:123]
    ds_read_b64_tr_b16 v[76:77], v16 offset:10240
    ds_read_b64_tr_b16 v[78:79], v16 offset:12800
    ds_read_b128 v[100:103], v19 offset:24576
    s_waitcnt lgkmcnt(9)
    v_mfma_f32_32x32x16_bf16 v[124:139], v[60:63], v[96:99], v[124:139]
    ds_read_b64_tr_b16 v[80:81], v17 offset:10304
    ds_read_b64_tr_b16 v[82:83], v17 offset:12864
    s_add_u32 m0, s28, 8192
    s_nop 0
    buffer_load_dwordx4 v13, s[8:11], s25 offen lds
    s_waitcnt lgkmcnt(9)
    v_mfma_f32_32x32x16_bf16 v[140:155], v[64:67], v[96:99], v[140:155]
    ds_read_b64_tr_b16 v[84:85], v16 offset:10368
    ds_read_b64_tr_b16 v[86:87], v16 offset:12928
    s_add_u32 m0, s27, 20480
    s_add_u32 s25, s25, 64
    buffer_load_dwordx4 v10, s[12:15], s24 offen lds
    s_waitcnt lgkmcnt(9)
    v_mfma_f32_32x32x16_bf16 v[156:171], v[68:71], v[96:99], v[156:171]
    ds_read_b64_tr_b16 v[88:89], v17 offset:10432
    ds_read_b64_tr_b16 v[90:91], v17 offset:12992
    buffer_load_dwordx4 v11, s[12:15], s24 offen offset:1024 lds
    s_add_u32 s24, s24, 122880
    s_cmp_eq_u32 s25, 1280
    s_cselect_b32 s25, 0, s25
    s_cselect_b32 s24, 0, s24
    s_waitcnt lgkmcnt(9)
    v_mfma_f32_32x32x16_bf16 v[172:187], v[72:75], v[96:99], v[172:187]
    ds_read_b64_tr_b16 v[92:93], v16 offset:10496
    ds_read_b64_tr_b16 v[94:95], v16 offset:13056
    s_cmp_eq_u32 s23, s63
    s_cbranch_scc1 k1cs_16
k1cs_16_back:
    s_waitcnt vmcnt(6)
    s_barrier
    s_waitcnt lgkmcnt(8)
    v_mfma_f32_32x32x16_bf16 v[108:123], v[76:79], v[100:103], v[108:123]
    ds_read_b64_tr_b16 v[56:57], v16 offset:20480
    ds_read_b64_tr_b16 v[58:59], v16 offset:23040
    ds_read_b128 v[96:99], v18 offset:32768
    s_waitcnt lgkmcnt(9)
    v_mfma_f32_32x32x16_bf16 v[124:139], v[80:83], v[100:103], v[124:139]
    ds_read_b64_tr_b16 v[60:61], v17 offset:20544
    ds_read_b64_tr_b16 v[62:63], v17 offset:23104
    s_waitcnt lgkmcnt(9)
    v_mfma_f32_32x32x16_bf16 v[140:155], v[84:87], v[100:103], v[140:155]
    ds_read_b64_tr_b16 v[64:65], v16 offset:20608
    ds_read_b64_tr_b16 v[66:67], v16 offset:23168
    s_waitcnt lgkmcnt(9)
    v_mfma_f32_32x32x16_bf16 v[156:171], v[88:91], v[100:103], v[156:171]
    ds_read_b64_tr_b16 v[68:69], v17 offset:20672
    ds_read_b64_tr_b16 v[70:71], v17 offset:23232
    s_waitcnt lgkmcnt(9)
    v_mfma_f32_32x32x16_bf16 v[172:187], v[92:95], v[100:103], v[172:187]
    ds_read_b64_tr_b16 v[72:73], v16 offset:20736
    ds_read_b64_tr_b16 v[74:75], v16 offset:23296
    s_waitcnt lgkmcnt(8)
    v_mfma_f32_32x32x16_bf16 v[108:123], v[56:59], v[96:99], v[108:123]
    ds_read_b64_tr_b16 v[76:77], v16 offset:30720
    ds_read_b64_tr_b16 v[78:79], v16 offset:33280
    ds_read_b128 v[100:103], v19 offset:32768
    s_waitcnt lgkmcnt(9)
    v_mfma_f32_32x32x16_bf16 v[124:139], v[60:63], v[96:99], v[124:139]
    ds_read_b64_tr_b16 v[80:81], v17 offset:30784
    ds_read_b64_tr_b16 v[82:83], v17 offset:33344
    s_add_u32 m0, s28, 16384
    s_nop 0
    buffer_load_dwordx4 v13, s[8:11], s25 offen lds
    s_waitcnt lgkmcnt(9)
    v_mfma_f32_32x32x16_bf16 v[140:155], v[64:67], v[96:99], v[140:155]
    ds_read_b64_tr_b16 v[84:85], v16 offset:30848
    ds_read_b64_tr_b16 v[86:87], v16 offset:33408
    s_add_u32 m0, s27, 40960
    s_add_u32 s25, s25, 64
    buffer_load_dwordx4 v10, s[12:15], s24 offen lds
    s_waitcnt lgkmcnt(9)
    v_mfma_f32_32x32x16_bf16 v[156:171], v[68:71], v[96:99], v[156:171]
    ds_read_b64_tr_b16 v[88:89], v17 offset:30912
    ds_read_b64_tr_b16 v[90:91], v17 offset:33472
    buffer_load_dwordx4 v11, s[12:15], s24 offen offset:1024 lds
    s_add_u32 s24, s24, 122880
    s_cmp_eq_u32 s25, 1280
    s_cselect_b32 s25, 0, s25
    s_cselect_b32 s24, 0, s24
    s_waitcnt lgkmcnt(9)
    v_mfma_f32_32x32x16_bf16 v[172:187], v[72:75], v[96:99], v[172:187]
    ds_read_b64_tr_b16 v[92:93], v16 offset:30976
    ds_read_b64_tr_b16 v[94:95], v16 offset:33536
    s_cmp_eq_u32 s23, s64
    s_cbranch_scc1 k1cs_17
k1cs_17_back:
    s_waitcnt vmcnt(6)
    s_barrier
    s_cmp_eq_u32 s23, 3
    s_cbranch_scc1 k1pub_18
k1pub_18_back:
    s_waitcnt lgkmcnt(8)
    v_mfma_f32_32x32x16_bf16 v[108:123], v[76:79], v[100:103], v[108:123]
    ds_read_b64_tr_b16 v[56:57], v14 offset:0
    ds_read_b64_tr_b16 v[58:59], v14 offset:2560
    ds_read_b128 v[96:99], v18 offset:0
    s_waitcnt lgkmcnt(9)
    v_mfma_f32_32x32x16_bf16 v[124:139], v[80:83], v[100:103], v[124:139]
    ds_read_b64_tr_b16 v[60:61], v15 offset:64
    ds_read_b64_tr_b16 v[62:63], v15 offset:2624
    s_waitcnt lgkmcnt(9)
    v_mfma_f32_32x32x16_bf16 v[140:155], v[84:87], v[100:103], v[140:155]
    ds_read_b64_tr_b16 v[64:65], v14 offset:128
    ds_read_b64_tr_b16 v[66:67], v14 offset:2688
    s_waitcnt lgkmcnt(9)
    v_mfma_f32_32x32x16_bf16 v[156:171], v[88:91], v[100:103], v[156:171]
    ds_read_b64_tr_b16 v[68:69], v15 offset:192
    ds_read_b64_tr_b16 v[70:71], v15 offset:2752
    s_waitcnt lgkmcnt(9)
    v_mfma_f32_32x32x16_bf16 v[172:187], v[92:95], v[100:103], v[172:187]
    ds_read_b64_tr_b16 v[72:73], v14 offset:256
    ds_read_b64_tr_b16 v[74:75], v14 offset:2816
    s_sub_u32 s23, s23, 1
    s_cmp_lg_u32 s23, 0
    s_cbranch_scc1 k1_qk_loop1
    s_waitcnt lgkmcnt(8)
    v_mfma_f32_32x32x16_bf16 v[108:123], v[56:59], v[96:99], v[108:123]
    ds_read_b64_tr_b16 v[76:77], v14 offset:10240
    ds_read_b64_tr_b16 v[78:79], v14 offset:12800
    ds_read_b128 v[100:103], v19 offset:0
    s_waitcnt lgkmcnt(9)
    v_mfma_f32_32x32x16_bf16 v[124:139], v[60:63], v[96:99], v[124:139]
    ds_read_b64_tr_b16 v[80:81], v15 offset:10304
    ds_read_b64_tr_b16 v[82:83], v15 offset:12864
    s_add_u32 m0, s28, 24576
    s_nop 0
    buffer_load_dwordx4 v13, s[8:11], s25 offen lds
    s_waitcnt lgkmcnt(9)
    v_mfma_f32_32x32x16_bf16 v[140:155], v[64:67], v[96:99], v[140:155]
    ds_read_b64_tr_b16 v[84:85], v14 offset:10368
    ds_read_b64_tr_b16 v[86:87], v14 offset:12928
    s_add_u32 m0, s27, 61440
    s_add_u32 s25, s25, 64
    buffer_load_dwordx4 v10, s[12:15], s24 offen lds
    s_waitcnt lgkmcnt(9)
    v_mfma_f32_32x32x16_bf16 v[156:171], v[68:71], v[96:99], v[156:171]
    ds_read_b64_tr_b16 v[88:89], v15 offset:10432
    ds_read_b64_tr_b16 v[90:91], v15 offset:12992
    buffer_load_dwordx4 v11, s[12:15], s24 offen offset:1024 lds
    s_add_u32 s24, s24, 122880
    s_cmp_eq_u32 s25, 1280
    s_cselect_b32 s25, 0, s25
    s_cselect_b32 s24, 0, s24
    s_waitcnt lgkmcnt(9)
    v_mfma_f32_32x32x16_bf16 v[172:187], v[72:75], v[96:99], v[172:187]
    ds_read_b64_tr_b16 v[92:93], v14 offset:10496
    ds_read_b64_tr_b16 v[94:95], v14 offset:13056
    s_waitcnt vmcnt(6)
    s_barrier
    s_waitcnt lgkmcnt(8)
    v_mfma_f32_32x32x16_bf16 v[108:123], v[76:79], v[100:103], v[108:123]
    ds_read_b64_tr_b16 v[56:57], v14 offset:20480
    ds_read_b64_tr_b16 v[58:59], v14 offset:23040
    ds_read_b128 v[96:99], v18 offset:8192
    s_waitcnt lgkmcnt(9)
    v_mfma_f32_32x32x16_bf16 v[124:139], v[80:83], v[100:103], v[124:139]
    ds_read_b64_tr_b16 v[60:61], v15 offset:20544
    ds_read_b64_tr_b16 v[62:63], v15 offset:23104
    s_waitcnt lgkmcnt(9)
    v_mfma_f32_32x32x16_bf16 v[140:155], v[84:87], v[100:103], v[140:155]
    ds_read_b64_tr_b16 v[64:65], v14 offset:20608
    ds_read_b64_tr_b16 v[66:67], v14 offset:23168
    s_waitcnt lgkmcnt(9)
    v_mfma_f32_32x32x16_bf16 v[156:171], v[88:91], v[100:103], v[156:171]
    ds_read_b64_tr_b16 v[68:69], v15 offset:20672
    ds_read_b64_tr_b16 v[70:71], v15 offset:23232
    s_waitcnt lgkmcnt(9)
    v_mfma_f32_32x32x16_bf16 v[172:187], v[92:95], v[100:103], v[172:187]
    ds_read_b64_tr_b16 v[72:73], v14 offset:20736
    ds_read_b64_tr_b16 v[74:75], v14 offset:23296
    s_waitcnt lgkmcnt(8)
    v_mfma_f32_32x32x16_bf16 v[108:123], v[56:59], v[96:99], v[108:123]
    ds_read_b64_tr_b16 v[76:77], v14 offset:30720
    ds_read_b64_tr_b16 v[78:79], v14 offset:33280
    ds_read_b128 v[100:103], v19 offset:8192
    s_waitcnt lgkmcnt(9)
    v_mfma_f32_32x32x16_bf16 v[124:139], v[60:63], v[96:99], v[124:139]
    ds_read_b64_tr_b16 v[80:81], v15 offset:30784
    ds_read_b64_tr_b16 v[82:83], v15 offset:33344
    s_add_u32 m0, s28, 32768
    s_nop 0
    buffer_load_dwordx4 v13, s[8:11], s25 offen lds
    s_waitcnt lgkmcnt(9)
    v_mfma_f32_32x32x16_bf16 v[140:155], v[64:67], v[96:99], v[140:155]
    ds_read_b64_tr_b16 v[84:85], v14 offset:30848
    ds_read_b64_tr_b16 v[86:87], v14 offset:33408
    s_add_u32 m0, s27, 81920
    s_add_u32 s25, s25, 64
    buffer_load_dwordx4 v10, s[12:15], s24 offen lds
    s_waitcnt lgkmcnt(9)
    v_mfma_f32_32x32x16_bf16 v[156:171], v[68:71], v[96:99], v[156:171]
    ds_read_b64_tr_b16 v[88:89], v15 offset:30912
    ds_read_b64_tr_b16 v[90:91], v15 offset:33472
    buffer_load_dwordx4 v11, s[12:15], s24 offen offset:1024 lds
    s_add_u32 s24, s24, 122880
    s_cmp_eq_u32 s25, 1280
    s_cselect_b32 s25, 0, s25
    s_cselect_b32 s24, 0, s24
    s_waitcnt lgkmcnt(9)
    v_mfma_f32_32x32x16_bf16 v[172:187], v[72:75], v[96:99], v[172:187]
    ds_read_b64_tr_b16 v[92:93], v14 offset:30976
    ds_read_b64_tr_b16 v[94:95], v14 offset:33536
    s_waitcnt vmcnt(6)
    s_barrier
    s_waitcnt lgkmcnt(8)
    v_mfma_f32_32x32x16_bf16 v[108:123], v[76:79], v[100:103], v[108:123]
    ds_read_b64_tr_b16 v[56:57], v14 offset:40960
    ds_read_b64_tr_b16 v[58:59], v14 offset:43520
    ds_read_b128 v[96:99], v18 offset:16384
    s_waitcnt lgkmcnt(9)
    v_mfma_f32_32x32x16_bf16 v[124:139], v[80:83], v[100:103], v[124:139]
    ds_read_b64_tr_b16 v[60:61], v15 offset:41024
    ds_read_b64_tr_b16 v[62:63], v15 offset:43584
    s_waitcnt lgkmcnt(9)
    v_mfma_f32_32x32x16_bf16 v[140:155], v[84:87], v[100:103], v[140:155]
    ds_read_b64_tr_b16 v[64:65], v14 offset:41088
    ds_read_b64_tr_b16 v[66:67], v14 offset:43648
    s_waitcnt lgkmcnt(9)
    v_mfma_f32_32x32x16_bf16 v[156:171], v[88:91], v[100:103], v[156:171]
    ds_read_b64_tr_b16 v[68:69], v15 offset:41152
    ds_read_b64_tr_b16 v[70:71], v15 offset:43712
    s_waitcnt lgkmcnt(9)
    v_mfma_f32_32x32x16_bf16 v[172:187], v[92:95], v[100:103], v[172:187]
    ds_read_b64_tr_b16 v[72:73], v14 offset:41216
    ds_read_b64_tr_b16 v[74:75], v14 offset:43776
    s_waitcnt lgkmcnt(8)
    v_mfma_f32_32x32x16_bf16 v[108:123], v[56:59], v[96:99], v[108:123]
    ds_read_b64_tr_b16 v[76:77], v14 offset:51200
    ds_read_b64_tr_b16 v[78:79], v14 offset:53760
    ds_read_b128 v[100:103], v19 offset:16384
    s_waitcnt lgkmcnt(9)
    v_mfma_f32_32x32x16_bf16 v[124:139], v[60:63], v[96:99], v[124:139]
    ds_read_b64_tr_b16 v[80:81], v15 offset:51264
    ds_read_b64_tr_b16 v[82:83], v15 offset:53824
    s_waitcnt lgkmcnt(9)
    v_mfma_f32_32x32x16_bf16 v[140:155], v[64:67], v[96:99], v[140:155]
    ds_read_b64_tr_b16 v[84:85], v14 offset:51328
    ds_read_b64_tr_b16 v[86:87], v14 offset:53888
    s_waitcnt lgkmcnt(9)
    v_mfma_f32_32x32x16_bf16 v[156:171], v[68:71], v[96:99], v[156:171]
    ds_read_b64_tr_b16 v[88:89], v15 offset:51392
    ds_read_b64_tr_b16 v[90:91], v15 offset:53952
    s_waitcnt lgkmcnt(9)
    v_mfma_f32_32x32x16_bf16 v[172:187], v[72:75], v[96:99], v[172:187]
    ds_read_b64_tr_b16 v[92:93], v14 offset:51456
    ds_read_b64_tr_b16 v[94:95], v14 offset:54016
    s_waitcnt vmcnt(3)
    s_barrier
    s_waitcnt lgkmcnt(8)
    v_mfma_f32_32x32x16_bf16 v[108:123], v[76:79], v[100:103], v[108:123]
    ds_read_b64_tr_b16 v[56:57], v16 offset:0
    ds_read_b64_tr_b16 v[58:59], v16 offset:2560
    ds_read_b128 v[96:99], v18 offset:24576
    s_waitcnt lgkmcnt(9)
    v_mfma_f32_32x32x16_bf16 v[124:139], v[80:83], v[100:103], v[124:139]
    ds_read_b64_tr_b16 v[60:61], v17 offset:64
    ds_read_b64_tr_b16 v[62:63], v17 offset:2624
    s_waitcnt lgkmcnt(9)
    v_mfma_f32_32x32x16_bf16 v[140:155], v[84:87], v[100:103], v[140:155]
    ds_read_b64_tr_b16 v[64:65], v16 offset:128
    ds_read_b64_tr_b16 v[66:67], v16 offset:2688
    s_waitcnt lgkmcnt(9)
    v_mfma_f32_32x32x16_bf16 v[156:171], v[88:91], v[100:103], v[156:171]
    ds_read_b64_tr_b16 v[68:69], v17 offset:192
    ds_read_b64_tr_b16 v[70:71], v17 offset:2752
    s_waitcnt lgkmcnt(9)
    v_mfma_f32_32x32x16_bf16 v[172:187], v[92:95], v[100:103], v[172:187]
    ds_read_b64_tr_b16 v[72:73], v16 offset:256
    ds_read_b64_tr_b16 v[74:75], v16 offset:2816
    s_waitcnt lgkmcnt(8)
    v_mfma_f32_32x32x16_bf16 v[108:123], v[56:59], v[96:99], v[108:123]
    ds_read_b64_tr_b16 v[76:77], v16 offset:10240
    ds_read_b64_tr_b16 v[78:79], v16 offset:12800
    ds_read_b128 v[100:103], v19 offset:24576
    s_waitcnt lgkmcnt(9)
    v_mfma_f32_32x32x16_bf16 v[124:139], v[60:63], v[96:99], v[124:139]
    ds_read_b64_tr_b16 v[80:81], v17 offset:10304
    ds_read_b64_tr_b16 v[82:83], v17 offset:12864
    s_waitcnt lgkmcnt(9)
    v_mfma_f32_32x32x16_bf16 v[140:155], v[64:67], v[96:99], v[140:155]
    ds_read_b64_tr_b16 v[84:85], v16 offset:10368
    ds_read_b64_tr_b16 v[86:87], v16 offset:12928
    s_waitcnt lgkmcnt(9)
    v_mfma_f32_32x32x16_bf16 v[156:171], v[68:71], v[96:99], v[156:171]
    ds_read_b64_tr_b16 v[88:89], v17 offset:10432
    ds_read_b64_tr_b16 v[90:91], v17 offset:12992
    s_waitcnt lgkmcnt(9)
    v_mfma_f32_32x32x16_bf16 v[172:187], v[72:75], v[96:99], v[172:187]
    ds_read_b64_tr_b16 v[92:93], v16 offset:10496
    ds_read_b64_tr_b16 v[94:95], v16 offset:13056
    v_lshlrev_b32 v3, 1, v23
    v_lshlrev_b32 v4, 2, v24
    s_mul_i32 s4, s21, 3072
    s_lshl_b32 s5, s20, 11
    s_add_u32 s5, s5, 65536
    buffer_load_dwordx2 v[20:21], v3, s[72:75], s4 offen sc1
    buffer_load_dwordx4 v[28:31], v4, s[72:75], s5 offen sc1
    s_waitcnt vmcnt(2)
    s_barrier
    s_waitcnt lgkmcnt(8)
    v_mfma_f32_32x32x16_bf16 v[108:123], v[76:79], v[100:103], v[108:123]
    ds_read_b64_tr_b16 v[56:57], v16 offset:20480
    ds_read_b64_tr_b16 v[58:59], v16 offset:23040
    ds_read_b128 v[96:99], v18 offset:32768
    s_waitcnt lgkmcnt(9)
    v_mfma_f32_32x32x16_bf16 v[124:139], v[80:83], v[100:103], v[124:139]
    ds_read_b64_tr_b16 v[60:61], v17 offset:20544
    ds_read_b64_tr_b16 v[62:63], v17 offset:23104
    s_waitcnt lgkmcnt(9)
    v_mfma_f32_32x32x16_bf16 v[140:155], v[84:87], v[100:103], v[140:155]
    ds_read_b64_tr_b16 v[64:65], v16 offset:20608
    ds_read_b64_tr_b16 v[66:67], v16 offset:23168
    s_waitcnt lgkmcnt(9)
    v_mfma_f32_32x32x16_bf16 v[156:171], v[88:91], v[100:103], v[156:171]
    ds_read_b64_tr_b16 v[68:69], v17 offset:20672
    ds_read_b64_tr_b16 v[70:71], v17 offset:23232
    s_waitcnt lgkmcnt(9)
    v_mfma_f32_32x32x16_bf16 v[172:187], v[92:95], v[100:103], v[172:187]
    ds_read_b64_tr_b16 v[72:73], v16 offset:20736
    ds_read_b64_tr_b16 v[74:75], v16 offset:23296
    s_waitcnt lgkmcnt(8)
    v_mfma_f32_32x32x16_bf16 v[108:123], v[56:59], v[96:99], v[108:123]
    ds_read_b64_tr_b16 v[76:77], v16 offset:30720
    ds_read_b64_tr_b16 v[78:79], v16 offset:33280
    ds_read_b128 v[100:103], v19 offset:32768
    s_waitcnt lgkmcnt(9)
    v_mfma_f32_32x32x16_bf16 v[124:139], v[60:63], v[96:99], v[124:139]
    ds_read_b64_tr_b16 v[80:81], v17 offset:30784
    ds_read_b64_tr_b16 v[82:83], v17 offset:33344
    s_waitcnt lgkmcnt(9)
    v_mfma_f32_32x32x16_bf16 v[140:155], v[64:67], v[96:99], v[140:155]
    ds_read_b64_tr_b16 v[84:85], v16 offset:30848
    ds_read_b64_tr_b16 v[86:87], v16 offset:33408
    s_waitcnt lgkmcnt(9)
    v_mfma_f32_32x32x16_bf16 v[156:171], v[68:71], v[96:99], v[156:171]
    ds_read_b64_tr_b16 v[88:89], v17 offset:30912
    ds_read_b64_tr_b16 v[90:91], v17 offset:33472
    s_waitcnt lgkmcnt(9)
    v_mfma_f32_32x32x16_bf16 v[172:187], v[72:75], v[96:99], v[172:187]
    ds_read_b64_tr_b16 v[92:93], v16 offset:30976
    ds_read_b64_tr_b16 v[94:95], v16 offset:33536
    s_waitcnt lgkmcnt(8)
    v_mfma_f32_32x32x16_bf16 v[108:123], v[76:79], v[100:103], v[108:123]
    s_waitcnt lgkmcnt(6)
    v_mfma_f32_32x32x16_bf16 v[124:139], v[80:83], v[100:103], v[124:139]
    s_waitcnt lgkmcnt(4)
    v_mfma_f32_32x32x16_bf16 v[140:155], v[84:87], v[100:103], v[140:155]
    s_waitcnt vmcnt(0)
    v_cmp_ne_u32 vcc, s29, v21
    v_cmp_ne_u32 s[6:7], s29, v30
    s_nop 1
    s_or_b64 vcc, vcc, s[6:7]
    s_cbranch_vccnz k1retry_19
k1back_20:
    ds_write_b32 v23, v20 offset:0
    ds_write_b32 v24, v28 offset:1536
    ds_write_b32 v24, v29 offset:2048
    s_waitcnt lgkmcnt(5)
    v_mfma_f32_32x32x16_bf16 v[156:171], v[88:91], v[100:103], v[156:171]
    s_waitcnt lgkmcnt(3)
    v_mfma_f32_32x32x16_bf16 v[172:187], v[92:95], v[100:103], v[172:187]
    s_waitcnt lgkmcnt(0)
    s_barrier
    s_branch k1_qk_epi
k1retry_19:
    s_mov_b32 s23, 200000
k1retry_19_l:
    s_sleep 2
    v_lshlrev_b32 v3, 1, v23
    v_lshlrev_b32 v4, 2, v24
    s_mul_i32 s4, s21, 3072
    s_lshl_b32 s5, s20, 11
    s_add_u32 s5, s5, 65536
    buffer_load_dwordx2 v[20:21], v3, s[72:75], s4 offen sc1
    buffer_load_dwordx4 v[28:31], v4, s[72:75], s5 offen sc1
    s_waitcnt vmcnt(0)
    v_cmp_ne_u32 vcc, s29, v21
    v_cmp_ne_u32 s[6:7], s29, v30
    s_nop 1
    s_or_b64 vcc, vcc, s[6:7]
    s_cbranch_vccz k1back_20
    s_sub_u32 s23, s23, 1
    s_cmp_lg_u32 s23, 0
    s_cbranch_scc1 k1retry_19_l
    s_branch k1back_20
k1cs_12:
    s_waitcnt lgkmcnt(0)
    s_bitcmp1_b32 s26, 0
    s_cbranch_scc0 k1cs_12_s0
    v_mfma_f32_16x16x32_bf16 v[36:39], v[32:35], v[56:59], v[36:39]
    v_mfma_f32_16x16x32_bf16 v[36:39], v[32:35], v[76:79], v[36:39]
k1cs_12_s0:
    s_bitcmp1_b32 s26, 1
    s_cbranch_scc0 k1cs_12_s1
    v_mfma_f32_16x16x32_bf16 v[40:43], v[32:35], v[60:63], v[40:43]
    v_mfma_f32_16x16x32_bf16 v[40:43], v[32:35], v[80:83], v[40:43]
k1cs_12_s1:
    s_bitcmp1_b32 s26, 2
    s_cbranch_scc0 k1cs_12_s2
    v_mfma_f32_16x16x32_bf16 v[44:47], v[32:35], v[64:67], v[44:47]
    v_mfma_f32_16x16x32_bf16 v[44:47], v[32:35], v[84:87], v[44:47]
k1cs_12_s2:
    s_bitcmp1_b32 s26, 3
    s_cbranch_scc0 k1cs_12_s3
    v_mfma_f32_16x16x32_bf16 v[48:51], v[32:35], v[68:71], v[48:51]
    v_mfma_f32_16x16x32_bf16 v[48:51], v[32:35], v[88:91], v[48:51]
k1cs_12_s3:
    s_bitcmp1_b32 s26, 4
    s_cbranch_scc0 k1cs_12_s4
    v_mfma_f32_16x16x32_bf16 v[52:55], v[32:35], v[72:75], v[52:55]
    v_mfma_f32_16x16x32_bf16 v[52:55], v[32:35], v[92:95], v[52:55]
k1cs_12_s4:
    s_branch k1cs_12_back
k1cs_13:
    s_waitcnt lgkmcnt(0)
    s_bitcmp1_b32 s26, 0
    s_cbranch_scc0 k1cs_13_s0
    v_mfma_f32_16x16x32_bf16 v[36:39], v[32:35], v[56:59], v[36:39]
    v_mfma_f32_16x16x32_bf16 v[36:39], v[32:35], v[76:79], v[36:39]
k1cs_13_s0:
    s_bitcmp1_b32 s26, 1
    s_cbranch_scc0 k1cs_13_s1
    v_mfma_f32_16x16x32_bf16 v[40:43], v[32:35], v[60:63], v[40:43]
    v_mfma_f32_16x16x32_bf16 v[40:43], v[32:35], v[80:83], v[40:43]
k1cs_13_s1:
    s_bitcmp1_b32 s26, 2
    s_cbranch_scc0 k1cs_13_s2
    v_mfma_f32_16x16x32_bf16 v[44:47], v[32:35], v[64:67], v[44:47]
    v_mfma_f32_16x16x32_bf16 v[44:47], v[32:35], v[84:87], v[44:47]
k1cs_13_s2:
    s_bitcmp1_b32 s26, 3
    s_cbranch_scc0 k1cs_13_s3
    v_mfma_f32_16x16x32_bf16 v[48:51], v[32:35], v[68:71], v[48:51]
    v_mfma_f32_16x16x32_bf16 v[48:51], v[32:35], v[88:91], v[48:51]
k1cs_13_s3:
    s_bitcmp1_b32 s26, 4
    s_cbranch_scc0 k1cs_13_s4
    v_mfma_f32_16x16x32_bf16 v[52:55], v[32:35], v[72:75], v[52:55]
    v_mfma_f32_16x16x32_bf16 v[52:55], v[32:35], v[92:95], v[52:55]
k1cs_13_s4:
    s_branch k1cs_13_back
k1cs_14:
    s_waitcnt lgkmcnt(0)
    s_bitcmp1_b32 s26, 0
    s_cbranch_scc0 k1cs_14_s0
    v_mfma_f32_16x16x32_bf16 v[36:39], v[32:35], v[56:59], v[36:39]
    v_mfma_f32_16x16x32_bf16 v[36:39], v[32:35], v[76:79], v[36:39]
k1cs_14_s0:
    s_bitcmp1_b32 s26, 1
    s_cbranch_scc0 k1cs_14_s1
    v_mfma_f32_16x16x32_bf16 v[40:43], v[32:35], v[60:63], v[40:43]
    v_mfma_f32_16x16x32_bf16 v[40:43], v[32:35], v[80:83], v[40:43]
k1cs_14_s1:
    s_bitcmp1_b32 s26, 2
    s_cbranch_scc0 k1cs_14_s2
    v_mfma_f32_16x16x32_bf16 v[44:47], v[32:35], v[64:67], v[44:47]
    v_mfma_f32_16x16x32_bf16 v[44:47], v[32:35], v[84:87], v[44:47]
k1cs_14_s2:
    s_bitcmp1_b32 s26, 3
    s_cbranch_scc0 k1cs_14_s3
    v_mfma_f32_16x16x32_bf16 v[48:51], v[32:35], v[68:71], v[48:51]
    v_mfma_f32_16x16x32_bf16 v[48:51], v[32:35], v[88:91], v[48:51]
k1cs_14_s3:
    s_bitcmp1_b32 s26, 4
    s_cbranch_scc0 k1cs_14_s4
    v_mfma_f32_16x16x32_bf16 v[52:55], v[32:35], v[72:75], v[52:55]
    v_mfma_f32_16x16x32_bf16 v[52:55], v[32:35], v[92:95], v[52:55]
k1cs_14_s4:
    s_branch k1cs_14_back
k1cs_16:
    s_waitcnt lgkmcnt(0)
    s_bitcmp1_b32 s26, 0
    s_cbranch_scc0 k1cs_16_s0
    v_mfma_f32_16x16x32_bf16 v[36:39], v[32:35], v[56:59], v[36:39]
    v_mfma_f32_16x16x32_bf16 v[36:39], v[32:35], v[76:79], v[36:39]
k1cs_16_s0:
    s_bitcmp1_b32 s26, 1
    s_cbranch_scc0 k1cs_16_s1
    v_mfma_f32_16x16x32_bf16 v[40:43], v[32:35], v[60:63], v[40:43]
    v_mfma_f32_16x16x32_bf16 v[40:43], v[32:35], v[80:83], v[40:43]
k1cs_16_s1:
    s_bitcmp1_b32 s26, 2
    s_cbranch_scc0 k1cs_16_s2
    v_mfma_f32_16x16x32_bf16 v[44:47], v[32:35], v[64:67], v[44:47]
    v_mfma_f32_16x16x32_bf16 v[44:47], v[32:35], v[84:87], v[44:47]
k1cs_16_s2:
    s_bitcmp1_b32 s26, 3
    s_cbranch_scc0 k1cs_16_s3
    v_mfma_f32_16x16x32_bf16 v[48:51], v[32:35], v[68:71], v[48:51]
    v_mfma_f32_16x16x32_bf16 v[48:51], v[32:35], v[88:91], v[48:51]
k1cs_16_s3:
    s_bitcmp1_b32 s26, 4
    s_cbranch_scc0 k1cs_16_s4
    v_mfma_f32_16x16x32_bf16 v[52:55], v[32:35], v[72:75], v[52:55]
    v_mfma_f32_16x16x32_bf16 v[52:55], v[32:35], v[92:95], v[52:55]
k1cs_16_s4:
    s_branch k1cs_16_back
k1cs_17:
    s_waitcnt lgkmcnt(0)
    s_bitcmp1_b32 s26, 0
    s_cbranch_scc0 k1cs_17_s0
    v_mfma_f32_16x16x32_bf16 v[36:39], v[32:35], v[56:59], v[36:39]
    v_mfma_f32_16x16x32_bf16 v[36:39], v[32:35], v[76:79], v[36:39]
k1cs_17_s0:
    s_bitcmp1_b32 s26, 1
    s_cbranch_scc0 k1cs_17_s1
    v_mfma_f32_16x16x32_bf16 v[40:43], v[32:35], v[60:63], v[40:43]
    v_mfma_f32_16x16x32_bf16 v[40:43], v[32:35], v[80:83], v[40:43]
k1cs_17_s1:
    s_bitcmp1_b32 s26, 2
    s_cbranch_scc0 k1cs_17_s2
    v_mfma_f32_16x16x32_bf16 v[44:47], v[32:35], v[64:67], v[44:47]
    v_mfma_f32_16x16x32_bf16 v[44:47], v[32:35], v[84:87], v[44:47]
k1cs_17_s2:
    s_bitcmp1_b32 s26, 3
    s_cbranch_scc0 k1cs_17_s3
    v_mfma_f32_16x16x32_bf16 v[48:51], v[32:35], v[68:71], v[48:51]
    v_mfma_f32_16x16x32_bf16 v[48:51], v[32:35], v[88:91], v[48:51]
k1cs_17_s3:
    s_bitcmp1_b32 s26, 4
    s_cbranch_scc0 k1cs_17_s4
    v_mfma_f32_16x16x32_bf16 v[52:55], v[32:35], v[72:75], v[52:55]
    v_mfma_f32_16x16x32_bf16 v[52:55], v[32:35], v[92:95], v[52:55]
k1cs_17_s4:
    s_branch k1cs_17_back
k1pub_18:
    s_nop 7
    s_mov_b32 s4, 200000
k1pub_18_n:
    v_readfirstlane_b32 s29, v22
    s_cmp_lg_u32 s29, 0
    s_cbranch_scc1 k1pub_18_ok
    s_sleep 2
    buffer_load_dword v22, off, s[76:79], 0 sc1
    s_waitcnt vmcnt(0)
    s_sub_u32 s4, s4, 1
    s_cmp_lg_u32 s4, 0
    s_cbranch_scc1 k1pub_18_n
k1pub_18_ok:
    s_mov_b64 exec, 0xffff
    s_bitcmp1_b32 s26, 0
    s_cbranch_scc0 k1pub_18_s0
    v_mov_b32 v38, s29
    v_mov_b32 v39, s29
    buffer_store_dwordx4 v[36:39], v25, s[72:75], s30 offen offset:0 sc1
k1pub_18_s0:
    s_bitcmp1_b32 s26, 1
    s_cbranch_scc0 k1pub_18_s1
    v_mov_b32 v42, s29
    v_mov_b32 v43, s29
    buffer_store_dwordx4 v[40:43], v25, s[72:75], s30 offen offset:256 sc1
k1pub_18_s1:
    s_bitcmp1_b32 s26, 2
    s_cbranch_scc0 k1pub_18_s2
    v_mov_b32 v46, s29
    v_mov_b32 v47, s29
    buffer_store_dwordx4 v[44:47], v25, s[72:75], s30 offen offset:512 sc1
k1pub_18_s2:
    s_bitcmp1_b32 s26, 3
    s_cbranch_scc0 k1pub_18_s3
    v_mov_b32 v50, s29
    v_mov_b32 v51, s29
    buffer_store_dwordx4 v[48:51], v25, s[72:75], s30 offen offset:768 sc1
k1pub_18_s3:
    s_bitcmp1_b32 s26, 4
    s_cbranch_scc0 k1pub_18_s4
    v_mov_b32 v54, s29
    v_mov_b32 v55, s29
    buffer_store_dwordx4 v[52:55], v25, s[72:75], s30 offen offset:1024 sc1
k1pub_18_s4:
    s_mov_b64 exec, -1
    s_branch k1pub_18_back
k1_qk_epi:
    s_setprio 0
    v_and_b32 v2, 31, v1
    s_lshl_b32 s4, s36, 5
    v_add_u32 v2, s4, v2
    v_lshlrev_b32 v2, 2, v2
    ds_read_b32 v188, v2 offset:2048
    ds_read_b32 v189, v2 offset:1536
    v_lshrrev_b32 v4, 5, v1
    s_mul_i32 s4, s37, 640
    v_lshlrev_b32 v5, 4, v4
    v_add_u32 v5, s4, v5
    ds_read_b128 v[56:59], v5 offset:0
    ds_read_b128 v[60:63], v5 offset:32
    ds_read_b128 v[64:67], v5 offset:64
    ds_read_b128 v[68:71], v5 offset:96
    ds_read_b128 v[72:75], v5 offset:128
    ds_read_b128 v[76:79], v5 offset:160
    ds_read_b128 v[80:83], v5 offset:192
    ds_read_b128 v[84:87], v5 offset:224
    s_mov_b32 s6, 0xa00000
    s_cmp_ge_u32 s21, 2
    s_cselect_b32 s4, 0xd00000, s6
    s_cselect_b32 s5, 1.0, 0x3ea52b5c
    s_add_u32 s16, s58, s4
    s_addc_u32 s17, s59, 0
    s_mov_b32 s18, 0x280000
    s_mov_b32 s19, 0x00020000
    s_mov_b32 s31, s5
    s_and_b32 s4, s21, 1
    s_lshl_b32 s4, s4, 3
    s_lshl_b32 s5, s37, 2
    s_add_u32 s4, s4, s5
    s_lshl_b32 s4, s4, 6
    s_lshl_b32 s5, s20, 2
    s_add_u32 s4, s4, s5
    s_add_u32 s4, s4, s36
    s_mul_i32 s4, s4, 2560
    v_lshlrev_b32 v6, 4, v1
    v_add_u32 v6, s4, v6
    v_lshlrev_b32 v7, 3, v1
    v_add_u32 v7, s4, v7
    v_add_u32 v7, 2048, v7
    s_waitcnt lgkmcnt(8)
    v_mul_f32 v189, s31, v189
    s_waitcnt lgkmcnt(7)
    v_pk_fma_f32 v[108:109], v[188:189], v[56:57], v[108:109] op_sel:[0,0,0] op_sel_hi:[0,1,1]
    v_pk_fma_f32 v[110:111], v[188:189], v[58:59], v[110:111] op_sel:[0,0,0] op_sel_hi:[0,1,1]
    s_waitcnt lgkmcnt(6)
    v_pk_fma_f32 v[112:113], v[188:189], v[60:61], v[112:113] op_sel:[0,0,0] op_sel_hi:[0,1,1]
    v_pk_fma_f32 v[114:115], v[188:189], v[62:63], v[114:115] op_sel:[0,0,0] op_sel_hi:[0,1,1]
    s_waitcnt lgkmcnt(5)
    v_pk_fma_f32 v[116:117], v[188:189], v[64:65], v[116:117] op_sel:[0,0,0] op_sel_hi:[0,1,1]
    v_pk_fma_f32 v[118:119], v[188:189], v[66:67], v[118:119] op_sel:[0,0,0] op_sel_hi:[0,1,1]
    s_waitcnt lgkmcnt(4)
    v_pk_fma_f32 v[120:121], v[188:189], v[68:69], v[120:121] op_sel:[0,0,0] op_sel_hi:[0,1,1]
    v_pk_fma_f32 v[122:123], v[188:189], v[70:71], v[122:123] op_sel:[0,0,0] op_sel_hi:[0,1,1]
    ds_read_b128 v[56:59], v5 offset:256
    ds_read_b128 v[60:63], v5 offset:288
    ds_read_b128 v[64:67], v5 offset:320
    ds_read_b128 v[68:71], v5 offset:352
    v_pk_mul_f32 v[108:109], v[188:189], v[108:109] op_sel:[1,0] op_sel_hi:[1,1]
    v_pk_mul_f32 v[110:111], v[188:189], v[110:111] op_sel:[1,0] op_sel_hi:[1,1]
    v_pk_mul_f32 v[112:113], v[188:189], v[112:113] op_sel:[1,0] op_sel_hi:[1,1]
    v_pk_mul_f32 v[114:115], v[188:189], v[114:115] op_sel:[1,0] op_sel_hi:[1,1]
    v_pk_mul_f32 v[116:117], v[188:189], v[116:117] op_sel:[1,0] op_sel_hi:[1,1]
    v_pk_mul_f32 v[118:119], v[188:189], v[118:119] op_sel:[1,0] op_sel_hi:[1,1]
    v_pk_mul_f32 v[120:121], v[188:189], v[120:121] op_sel:[1,0] op_sel_hi:[1,1]
    v_pk_mul_f32 v[122:123], v[188:189], v[122:123] op_sel:[1,0] op_sel_hi:[1,1]
    v_cvt_pk_bf16_f32 v192, v108, v109
    v_cvt_pk_bf16_f32 v193, v110, v111
    v_cvt_pk_bf16_f32 v194, v112, v113
    v_cvt_pk_bf16_f32 v195, v114, v115
    v_cvt_pk_bf16_f32 v200, v116, v117
    v_cvt_pk_bf16_f32 v201, v118, v119
    v_cvt_pk_bf16_f32 v196, v120, v121
    v_cvt_pk_bf16_f32 v197, v122, v123
    s_waitcnt lgkmcnt(7)
    v_pk_fma_f32 v[124:125], v[188:189], v[72:73], v[124:125] op_sel:[0,0,0] op_sel_hi:[0,1,1]
    v_pk_fma_f32 v[126:127], v[188:189], v[74:75], v[126:127] op_sel:[0,0,0] op_sel_hi:[0,1,1]
    s_waitcnt lgkmcnt(6)
    v_pk_fma_f32 v[128:129], v[188:189], v[76:77], v[128:129] op_sel:[0,0,0] op_sel_hi:[0,1,1]
    v_pk_fma_f32 v[130:131], v[188:189], v[78:79], v[130:131] op_sel:[0,0,0] op_sel_hi:[0,1,1]
    s_waitcnt lgkmcnt(5)
    v_pk_fma_f32 v[132:133], v[188:189], v[80:81], v[132:133] op_sel:[0,0,0] op_sel_hi:[0,1,1]
    v_pk_fma_f32 v[134:135], v[188:189], v[82:83], v[134:135] op_sel:[0,0,0] op_sel_hi:[0,1,1]
    s_waitcnt lgkmcnt(4)
    v_pk_fma_f32 v[136:137], v[188:189], v[84:85], v[136:137] op_sel:[0,0,0] op_sel_hi:[0,1,1]
    v_pk_fma_f32 v[138:139], v[188:189], v[86:87], v[138:139] op_sel:[0,0,0] op_sel_hi:[0,1,1]
    ds_read_b128 v[72:75], v5 offset:384
    ds_read_b128 v[76:79], v5 offset:416
    ds_read_b128 v[80:83], v5 offset:448
    ds_read_b128 v[84:87], v5 offset:480
    v_pk_mul_f32 v[124:125], v[188:189], v[124:125] op_sel:[1,0] op_sel_hi:[1,1]
    v_pk_mul_f32 v[126:127], v[188:189], v[126:127] op_sel:[1,0] op_sel_hi:[1,1]
    v_pk_mul_f32 v[128:129], v[188:189], v[128:129] op_sel:[1,0] op_sel_hi:[1,1]
    v_pk_mul_f32 v[130:131], v[188:189], v[130:131] op_sel:[1,0] op_sel_hi:[1,1]
    v_pk_mul_f32 v[132:133], v[188:189], v[132:133] op_sel:[1,0] op_sel_hi:[1,1]
    v_pk_mul_f32 v[134:135], v[188:189], v[134:135] op_sel:[1,0] op_sel_hi:[1,1]
    v_pk_mul_f32 v[136:137], v[188:189], v[136:137] op_sel:[1,0] op_sel_hi:[1,1]
    v_pk_mul_f32 v[138:139], v[188:189], v[138:139] op_sel:[1,0] op_sel_hi:[1,1]
    v_cvt_pk_bf16_f32 v198, v124, v125
    v_cvt_pk_bf16_f32 v199, v126, v127
    s_mov_b32 s7, 0
    buffer_store_dwordx4 v[192:195], v6, s[16:19], s7 offen sc1
    buffer_store_dwordx4 v[196:199], v6, s[16:19], s7 offen offset:1024 sc1
    buffer_store_dwordx2 v[200:201], v7, s[16:19], s7 offen sc1
    v_cvt_pk_bf16_f32 v202, v128, v129
    v_cvt_pk_bf16_f32 v203, v130, v131
    v_cvt_pk_bf16_f32 v204, v132, v133
    v_cvt_pk_bf16_f32 v205, v134, v135
    v_cvt_pk_bf16_f32 v210, v136, v137
    v_cvt_pk_bf16_f32 v211, v138, v139
    s_waitcnt lgkmcnt(7)
    v_pk_fma_f32 v[140:141], v[188:189], v[56:57], v[140:141] op_sel:[0,0,0] op_sel_hi:[0,1,1]
    v_pk_fma_f32 v[142:143], v[188:189], v[58:59], v[142:143] op_sel:[0,0,0] op_sel_hi:[0,1,1]
    s_waitcnt lgkmcnt(6)
    v_pk_fma_f32 v[144:145], v[188:189], v[60:61], v[144:145] op_sel:[0,0,0] op_sel_hi:[0,1,1]
    v_pk_fma_f32 v[146:147], v[188:189], v[62:63], v[146:147] op_sel:[0,0,0] op_sel_hi:[0,1,1]
    s_waitcnt lgkmcnt(5)
    v_pk_fma_f32 v[148:149], v[188:189], v[64:65], v[148:149] op_sel:[0,0,0] op_sel_hi:[0,1,1]
    v_pk_fma_f32 v[150:151], v[188:189], v[66:67], v[150:151] op_sel:[0,0,0] op_sel_hi:[0,1,1]
    s_waitcnt lgkmcnt(4)
    v_pk_fma_f32 v[152:153], v[188:189], v[68:69], v[152:153] op_sel:[0,0,0] op_sel_hi:[0,1,1]
    v_pk_fma_f32 v[154:155], v[188:189], v[70:71], v[154:155] op_sel:[0,0,0] op_sel_hi:[0,1,1]
    ds_read_b128 v[56:59], v5 offset:512
    ds_read_b128 v[60:63], v5 offset:544
    ds_read_b128 v[64:67], v5 offset:576
    ds_read_b128 v[68:71], v5 offset:608
    v_pk_mul_f32 v[140:141], v[188:189], v[140:141] op_sel:[1,0] op_sel_hi:[1,1]
    v_pk_mul_f32 v[142:143], v[188:189], v[142:143] op_sel:[1,0] op_sel_hi:[1,1]
    v_pk_mul_f32 v[144:145], v[188:189], v[144:145] op_sel:[1,0] op_sel_hi:[1,1]
    v_pk_mul_f32 v[146:147], v[188:189], v[146:147] op_sel:[1,0] op_sel_hi:[1,1]
    v_pk_mul_f32 v[148:149], v[188:189], v[148:149] op_sel:[1,0] op_sel_hi:[1,1]
    v_pk_mul_f32 v[150:151], v[188:189], v[150:151] op_sel:[1,0] op_sel_hi:[1,1]
    v_pk_mul_f32 v[152:153], v[188:189], v[152:153] op_sel:[1,0] op_sel_hi:[1,1]
    v_pk_mul_f32 v[154:155], v[188:189], v[154:155] op_sel:[1,0] op_sel_hi:[1,1]
    v_cvt_pk_bf16_f32 v206, v140, v141
    v_cvt_pk_bf16_f32 v207, v142, v143
    v_cvt_pk_bf16_f32 v208, v144, v145
    v_cvt_pk_bf16_f32 v209, v146, v147
    s_mov_b32 s7, 163840
    buffer_store_dwordx4 v[202:205], v6, s[16:19], s7 offen sc1
    buffer_store_dwordx4 v[206:209], v6, s[16:19], s7 offen offset:1024 sc1
    buffer_store_dwordx2 v[210:211], v7, s[16:19], s7 offen sc1
    v_cvt_pk_bf16_f32 v212, v148, v149
    v_cvt_pk_bf16_f32 v213, v150, v151
    v_cvt_pk_bf16_f32 v214, v152, v153
    v_cvt_pk_bf16_f32 v215, v154, v155
    s_waitcnt lgkmcnt(7)
    v_pk_fma_f32 v[156:157], v[188:189], v[72:73], v[156:157] op_sel:[0,0,0] op_sel_hi:[0,1,1]
    v_pk_fma_f32 v[158:159], v[188:189], v[74:75], v[158:159] op_sel:[0,0,0] op_sel_hi:[0,1,1]
    s_waitcnt lgkmcnt(6)
    v_pk_fma_f32 v[160:161], v[188:189], v[76:77], v[160:161] op_sel:[0,0,0] op_sel_hi:[0,1,1]
    v_pk_fma_f32 v[162:163], v[188:189], v[78:79], v[162:163] op_sel:[0,0,0] op_sel_hi:[0,1,1]
    s_waitcnt lgkmcnt(5)
    v_pk_fma_f32 v[164:165], v[188:189], v[80:81], v[164:165] op_sel:[0,0,0] op_sel_hi:[0,1,1]
    v_pk_fma_f32 v[166:167], v[188:189], v[82:83], v[166:167] op_sel:[0,0,0] op_sel_hi:[0,1,1]
    s_waitcnt lgkmcnt(4)
    v_pk_fma_f32 v[168:169], v[188:189], v[84:85], v[168:169] op_sel:[0,0,0] op_sel_hi:[0,1,1]
    v_pk_fma_f32 v[170:171], v[188:189], v[86:87], v[170:171] op_sel:[0,0,0] op_sel_hi:[0,1,1]
    v_pk_mul_f32 v[156:157], v[188:189], v[156:157] op_sel:[1,0] op_sel_hi:[1,1]
    v_pk_mul_f32 v[158:159], v[188:189], v[158:159] op_sel:[1,0] op_sel_hi:[1,1]
    v_pk_mul_f32 v[160:161], v[188:189], v[160:161] op_sel:[1,0] op_sel_hi:[1,1]
    v_pk_mul_f32 v[162:163], v[188:189], v[162:163] op_sel:[1,0] op_sel_hi:[1,1]
    v_pk_mul_f32 v[164:165], v[188:189], v[164:165] op_sel:[1,0] op_sel_hi:[1,1]
    v_pk_mul_f32 v[166:167], v[188:189], v[166:167] op_sel:[1,0] op_sel_hi:[1,1]
    v_pk_mul_f32 v[168:169], v[188:189], v[168:169] op_sel:[1,0] op_sel_hi:[1,1]
    v_pk_mul_f32 v[170:171], v[188:189], v[170:171] op_sel:[1,0] op_sel_hi:[1,1]
    v_cvt_pk_bf16_f32 v220, v156, v157
    v_cvt_pk_bf16_f32 v221, v158, v159
    v_cvt_pk_bf16_f32 v216, v160, v161
    v_cvt_pk_bf16_f32 v217, v162, v163
    v_cvt_pk_bf16_f32 v218, v164, v165
    v_cvt_pk_bf16_f32 v219, v166, v167
    s_mov_b32 s7, 327680
    buffer_store_dwordx4 v[212:215], v6, s[16:19], s7 offen sc1
    buffer_store_dwordx4 v[216:219], v6, s[16:19], s7 offen offset:1024 sc1
    buffer_store_dwordx2 v[220:221], v7, s[16:19], s7 offen sc1
    v_cvt_pk_bf16_f32 v222, v168, v169
    v_cvt_pk_bf16_f32 v223, v170, v171
    s_waitcnt lgkmcnt(3)
    v_pk_fma_f32 v[172:173], v[188:189], v[56:57], v[172:173] op_sel:[0,0,0] op_sel_hi:[0,1,1]
    v_pk_fma_f32 v[174:175], v[188:189], v[58:59], v[174:175] op_sel:[0,0,0] op_sel_hi:[0,1,1]
    s_waitcnt lgkmcnt(2)
    v_pk_fma_f32 v[176:177], v[188:189], v[60:61], v[176:177] op_sel:[0,0,0] op_sel_hi:[0,1,1]
    v_pk_fma_f32 v[178:179], v[188:189], v[62:63], v[178:179] op_sel:[0,0,0] op_sel_hi:[0,1,1]
    s_waitcnt lgkmcnt(1)
    v_pk_fma_f32 v[180:181], v[188:189], v[64:65], v[180:181] op_sel:[0,0,0] op_sel_hi:[0,1,1]
    v_pk_fma_f32 v[182:183], v[188:189], v[66:67], v[182:183] op_sel:[0,0,0] op_sel_hi:[0,1,1]
    s_waitcnt lgkmcnt(0)
    v_pk_fma_f32 v[184:185], v[188:189], v[68:69], v[184:185] op_sel:[0,0,0] op_sel_hi:[0,1,1]
    v_pk_fma_f32 v[186:187], v[188:189], v[70:71], v[186:187] op_sel:[0,0,0] op_sel_hi:[0,1,1]
    v_pk_mul_f32 v[172:173], v[188:189], v[172:173] op_sel:[1,0] op_sel_hi:[1,1]
    v_pk_mul_f32 v[174:175], v[188:189], v[174:175] op_sel:[1,0] op_sel_hi:[1,1]
    v_pk_mul_f32 v[176:177], v[188:189], v[176:177] op_sel:[1,0] op_sel_hi:[1,1]
    v_pk_mul_f32 v[178:179], v[188:189], v[178:179] op_sel:[1,0] op_sel_hi:[1,1]
    v_pk_mul_f32 v[180:181], v[188:189], v[180:181] op_sel:[1,0] op_sel_hi:[1,1]
    v_pk_mul_f32 v[182:183], v[188:189], v[182:183] op_sel:[1,0] op_sel_hi:[1,1]
    v_pk_mul_f32 v[184:185], v[188:189], v[184:185] op_sel:[1,0] op_sel_hi:[1,1]
    v_pk_mul_f32 v[186:187], v[188:189], v[186:187] op_sel:[1,0] op_sel_hi:[1,1]
    v_cvt_pk_bf16_f32 v224, v172, v173
    v_cvt_pk_bf16_f32 v225, v174, v175
    v_cvt_pk_bf16_f32 v230, v176, v177
    v_cvt_pk_bf16_f32 v231, v178, v179
    v_cvt_pk_bf16_f32 v226, v180, v181
    v_cvt_pk_bf16_f32 v227, v182, v183
    v_cvt_pk_bf16_f32 v228, v184, v185
    v_cvt_pk_bf16_f32 v229, v186, v187
    s_mov_b32 s7, 491520
    buffer_store_dwordx4 v[222:225], v6, s[16:19], s7 offen sc1
    buffer_store_dwordx4 v[226:229], v6, s[16:19], s7 offen offset:1024 sc1
    buffer_store_dwordx2 v[230:231], v7, s[16:19], s7 offen sc1
    s_waitcnt vmcnt(0)
    s_barrier
    s_cmp_lg_u32 s22, 0
    s_cbranch_scc1 pub_21
    s_lshl_b32 s4, s21, 4
    s_add_u32 s4, s4, s20
    s_lshl_b32 s4, s4, 7
    s_add_u32 s4, s4, 0xe0000
    v_mov_b32 v2, s29
    s_mov_b64 exec, 1
    buffer_store_dword v2, off, s[72:75], s4 sc1
    s_mov_b64 exec, -1
pub_21:
    s_branch p2_entry
k1_v:
    s_and_b32 s36, s22, 3
    s_lshr_b32 s37, s22, 2
    s_mul_i32 s4, s22, 3
    s_lshl_b32 s5, s22, 1
    s_add_u32 s5, s5, 4
    s_cmp_ge_u32 s22, 4
    s_cselect_b32 s4, s5, s4
    s_lshl_b32 s27, s4, 10
    s_lshl_b32 s4, s4, 6
    s_mul_i32 s34, s21, 640
    v_add_u32 v6, s4, v1
    s_mov_b32 s4, 1639
    s_mov_b32 s5, 3840
    v_add_u32 v2, 0, v6
    v_mul_lo_u32 v3, v2, s4
    v_lshrrev_b32 v3, 16, v3
    v_mul_u32_u24 v4, 40, v3
    v_sub_u32 v4, v2, v4
    v_bfe_u32 v5, v3, 1, 1
    v_lshlrev_b32 v5, 2, v5
    v_xor_b32 v4, v4, v5
    v_mul_lo_u32 v3, v3, s5
    v_lshl_add_u32 v3, v4, 4, v3
    v_add_u32 v3, s34, v3
    v_subrev_u32 v10, 0, v3
    v_add_u32 v2, 64, v6
    v_mul_lo_u32 v3, v2, s4
    v_lshrrev_b32 v3, 16, v3
    v_mul_u32_u24 v4, 40, v3
    v_sub_u32 v4, v2, v4
    v_bfe_u32 v5, v3, 1, 1
    v_lshlrev_b32 v5, 2, v5
    v_xor_b32 v4, v4, v5
    v_mul_lo_u32 v3, v3, s5
    v_lshl_add_u32 v3, v4, 4, v3
    v_add_u32 v3, s34, v3
    v_subrev_u32 v11, 1024, v3
    v_add_u32 v2, 128, v6
    v_mul_lo_u32 v3, v2, s4
    v_lshrrev_b32 v3, 16, v3
    v_mul_u32_u24 v4, 40, v3
    v_sub_u32 v4, v2, v4
    v_bfe_u32 v5, v3, 1, 1
    v_lshlrev_b32 v5, 2, v5
    v_xor_b32 v4, v4, v5
    v_mul_lo_u32 v3, v3, s5
    v_lshl_add_u32 v3, v4, 4, v3
    v_add_u32 v3, s34, v3
    v_subrev_u32 v12, 2048, v3
    s_lshl_b32 s4, s20, 7
    s_lshl_b32 s5, s22, 4
    s_add_u32 s4, s4, s5
    s_mul_i32 s4, s4, 1280
    v_lshrrev_b32 v2, 2, v1
    v_bfe_u32 v3, v1, 4, 2
    v_and_b32 v4, 3, v1
    v_xor_b32 v4, v4, v3
    v_mul_u32_u24 v2, 1280, v2
    v_lshl_add_u32 v2, v4, 4, v2
    v_add_u32 v13, s4, v2
    s_lshl_b32 s28, s22, 10
    s_add_u32 s28, s28, 122880
    s_lshr_b32 s6, s20, 2
    s_mul_i32 s6, s6, 5
    s_and_b32 s4, s20, 3
    s_cmp_eq_u32 s4, 0
    s_cselect_b32 s5, 4, 99
    s_mul_i32 s24, s6, 122880
    s_lshl_b32 s25, s6, 6
    s_mov_b32 s60, 99
    s_cmp_eq_u32 s4, 0
    s_cselect_b32 s60, 3, s60
    s_cmp_eq_u32 s4, 5
    s_cselect_b32 s60, 2, s60
    s_cmp_eq_u32 s5, 0
    s_cselect_b32 s60, 3, s60
    s_cmp_eq_u32 s5, 5
    s_cselect_b32 s60, 2, s60
    s_mov_b32 s61, 99
    s_cmp_eq_u32 s4, 1
    s_cselect_b32 s61, 3, s61
    s_cmp_eq_u32 s4, 6
    s_cselect_b32 s61, 2, s61
    s_cmp_eq_u32 s5, 1
    s_cselect_b32 s61, 3, s61
    s_cmp_eq_u32 s5, 6
    s_cselect_b32 s61, 2, s61
    s_mov_b32 s62, 99
    s_cmp_eq_u32 s4, 2
    s_cselect_b32 s62, 3, s62
    s_cmp_eq_u32 s4, 7
    s_cselect_b32 s62, 2, s62
    s_cmp_eq_u32 s5, 2
    s_cselect_b32 s62, 3, s62
    s_cmp_eq_u32 s5, 7
    s_cselect_b32 s62, 2, s62
    s_mov_b32 s63, 99
    s_cmp_eq_u32 s4, 3
    s_cselect_b32 s63, 3, s63
    s_cmp_eq_u32 s4, 8
    s_cselect_b32 s63, 2, s63
    s_cmp_eq_u32 s5, 3
    s_cselect_b32 s63, 3, s63
    s_cmp_eq_u32 s5, 8
    s_cselect_b32 s63, 2, s63
    s_mov_b32 s64, 99
    s_cmp_eq_u32 s4, 4
    s_cselect_b32 s64, 3, s64
    s_cmp_eq_u32 s4, 9
    s_cselect_b32 s64, 2, s64
    s_cmp_eq_u32 s5, 4
    s_cselect_b32 s64, 3, s64
    s_cmp_eq_u32 s5, 9
    s_cselect_b32 s64, 2, s64
    s_lshl_b32 s5, s21, 4
    s_add_u32 s4, s20, s5
    s_mul_i32 s4, s4, 12
    s_mul_i32 s5, s37, 5
    s_add_u32 s4, s4, s5
    s_lshl_b32 s4, s4, 8
    s_add_u32 s30, s4, 131072
    s_lshl_b32 s26, 1, s36
    s_cmp_eq_u32 s36, 0
    s_cselect_b32 s26, 17, s26
    s_waitcnt lgkmcnt(0)
    s_mov_b32 s8, s40
    s_mov_b32 s9, s41
    s_mov_b32 s10, 0x280000
    s_mov_b32 s11, 0x00020000
    s_mov_b32 s12, s42
    s_mov_b32 s13, s43
    s_mov_b32 s14, 0x258000
    s_mov_b32 s15, 0x00020000
    s_cmp_ge_u32 s22, 4
    s_cbranch_scc1 k1_v_v1
    s_add_u32 m0, s28, 0
    s_nop 0
    buffer_load_dwordx4 v13, s[8:11], s25 offen lds
    s_add_u32 m0, s27, 0
    s_add_u32 s25, s25, 64
    buffer_load_dwordx4 v10, s[12:15], s24 offen lds
    buffer_load_dwordx4 v11, s[12:15], s24 offen offset:1024 lds
    buffer_load_dwordx4 v12, s[12:15], s24 offen offset:2048 lds
    s_add_u32 s24, s24, 122880
    s_cmp_eq_u32 s25, 1280
    s_cselect_b32 s25, 0, s25
    s_cselect_b32 s24, 0, s24
    v_lshrrev_b32 v2, 4, v1
    v_bfe_u32 v3, v1, 2, 2
    v_and_b32 v4, 3, v1
    v_bfe_u32 v5, v1, 3, 1
    v_lshrrev_b32 v6, 1, v2
    v_lshl_add_u32 v6, v6, 3, v3
    v_mul_u32_u24 v6, 640, v6
    v_and_b32 v7, 1, v2
    v_lshl_add_u32 v6, v7, 5, v6
    v_lshl_add_u32 v6, v4, 3, v6
    s_mul_i32 s4, s37, 320
    v_add_u32 v6, s4, v6
    v_lshlrev_b32 v7, 6, v5
    v_sub_u32 v8, 0, v7
    s_cmp_eq_u32 s37, 0
    s_cselect_b64 vcc, -1, 0
    v_cndmask_b32 v9, v8, v7, vcc
    v_add_u32 v14, v6, v9
    v_sub_u32 v15, v6, v9
    v_add_u32 v16, 61440, v14
    v_add_u32 v17, 61440, v15
    v_and_b32 v2, 31, v1
    v_bfe_u32 v3, v1, 2, 2
    v_lshrrev_b32 v4, 5, v1
    s_lshl_b32 s5, s36, 11
    s_add_u32 s5, s5, 122880
    v_lshlrev_b32 v2, 6, v2
    v_add_u32 v2, s5, v2
    v_xor_b32 v5, v4, v3
    v_lshl_add_u32 v18, v5, 4, v2
    v_xor_b32 v19, 32, v18
    v_min_u32 v2, 319, v0
    v_lshlrev_b32 v23, 2, v2
    v_and_b32 v2, 127, v0
    v_lshlrev_b32 v24, 2, v2
    v_and_b32 v2, 15, v1
    v_lshlrev_b32 v25, 4, v2
    s_add_u32 m0, s28, 8192
    s_nop 0
    buffer_load_dwordx4 v13, s[8:11], s25 offen lds
    s_add_u32 m0, s27, 20480
    s_add_u32 s25, s25, 64
    buffer_load_dwordx4 v10, s[12:15], s24 offen lds
    buffer_load_dwordx4 v11, s[12:15], s24 offen offset:1024 lds
    buffer_load_dwordx4 v12, s[12:15], s24 offen offset:2048 lds
    s_add_u32 s24, s24, 122880
    s_cmp_eq_u32 s25, 1280
    s_cselect_b32 s25, 0, s25
    s_cselect_b32 s24, 0, s24
    v_and_b32 v2, 31, v1
    v_mov_b32 v3, 0x3f803f80
    v_cmp_eq_u32 vcc, 0, v2
    v_cmp_eq_u32 s[4:5], 17, v2
    s_nop 1
    s_or_b64 vcc, vcc, s[4:5]
    s_nop 1
    v_cndmask_b32 v32, 0, v3, vcc
    v_mov_b32 v33, v32
    v_mov_b32 v34, v32
    v_mov_b32 v35, v32
    v_mov_b32 v36, 0
    v_mov_b32 v37, 0
    v_mov_b32 v38, 0
    v_mov_b32 v39, 0
    v_mov_b32 v40, 0
    v_mov_b32 v41, 0
    v_mov_b32 v42, 0
    v_mov_b32 v43, 0
    v_mov_b32 v44, 0
    v_mov_b32 v45, 0
    v_mov_b32 v46, 0
    v_mov_b32 v47, 0
    v_mov_b32 v48, 0
    v_mov_b32 v49, 0
    v_mov_b32 v50, 0
    v_mov_b32 v51, 0
    v_mov_b32 v52, 0
    v_mov_b32 v53, 0
    v_mov_b32 v54, 0
    v_mov_b32 v55, 0
    v_mov_b32 v108, 0
    v_mov_b32 v109, 0
    v_mov_b32 v110, 0
    v_mov_b32 v111, 0
    v_mov_b32 v112, 0
    v_mov_b32 v113, 0
    s_add_u32 m0, s28, 16384
    s_nop 0
    buffer_load_dwordx4 v13, s[8:11], s25 offen lds
    s_add_u32 m0, s27, 40960
    s_add_u32 s25, s25, 64
    buffer_load_dwordx4 v10, s[12:15], s24 offen lds
    buffer_load_dwordx4 v11, s[12:15], s24 offen offset:1024 lds
    buffer_load_dwordx4 v12, s[12:15], s24 offen offset:2048 lds
    s_add_u32 s24, s24, 122880
    s_cmp_eq_u32 s25, 1280
    s_cselect_b32 s25, 0, s25
    s_cselect_b32 s24, 0, s24
    v_mov_b32 v114, 0
    v_mov_b32 v115, 0
    v_mov_b32 v116, 0
    v_mov_b32 v117, 0
    v_mov_b32 v118, 0
    v_mov_b32 v119, 0
    v_mov_b32 v120, 0
    v_mov_b32 v121, 0
    v_mov_b32 v122, 0
    v_mov_b32 v123, 0
    v_mov_b32 v124, 0
    v_mov_b32 v125, 0
    v_mov_b32 v126, 0
    v_mov_b32 v127, 0
    v_mov_b32 v128, 0
    v_mov_b32 v129, 0
    v_mov_b32 v130, 0
    v_mov_b32 v131, 0
    v_mov_b32 v132, 0
    v_mov_b32 v133, 0
    v_mov_b32 v134, 0
    v_mov_b32 v135, 0
    v_mov_b32 v136, 0
    v_mov_b32 v137, 0
    v_mov_b32 v138, 0
    v_mov_b32 v139, 0
    v_mov_b32 v140, 0
    v_mov_b32 v141, 0
    v_mov_b32 v142, 0
    v_mov_b32 v143, 0
    v_mov_b32 v144, 0
    v_mov_b32 v145, 0
    v_mov_b32 v146, 0
    v_mov_b32 v147, 0
    v_mov_b32 v148, 0
    v_mov_b32 v149, 0
    v_mov_b32 v150, 0
    s_add_u32 m0, s28, 24576
    s_nop 0
    buffer_load_dwordx4 v13, s[8:11], s25 offen lds
    s_add_u32 m0, s27, 61440
    s_add_u32 s25, s25, 64
    buffer_load_dwordx4 v10, s[12:15], s24 offen lds
    buffer_load_dwordx4 v11, s[12:15], s24 offen offset:1024 lds
    buffer_load_dwordx4 v12, s[12:15], s24 offen offset:2048 lds
    s_add_u32 s24, s24, 122880
    s_cmp_eq_u32 s25, 1280
    s_cselect_b32 s25, 0, s25
    s_cselect_b32 s24, 0, s24
    v_mov_b32 v151, 0
    v_mov_b32 v152, 0
    v_mov_b32 v153, 0
    v_mov_b32 v154, 0
    v_mov_b32 v155, 0
    v_mov_b32 v156, 0
    v_mov_b32 v157, 0
    v_mov_b32 v158, 0
    v_mov_b32 v159, 0
    v_mov_b32 v160, 0
    v_mov_b32 v161, 0
    v_mov_b32 v162, 0
    v_mov_b32 v163, 0
    v_mov_b32 v164, 0
    v_mov_b32 v165, 0
    v_mov_b32 v166, 0
    v_mov_b32 v167, 0
    v_mov_b32 v168, 0
    v_mov_b32 v169, 0
    v_mov_b32 v170, 0
    v_mov_b32 v171, 0
    v_mov_b32 v172, 0
    v_mov_b32 v173, 0
    v_mov_b32 v174, 0
    v_mov_b32 v175, 0
    v_mov_b32 v176, 0
    v_mov_b32 v177, 0
    v_mov_b32 v178, 0
    v_mov_b32 v179, 0
    v_mov_b32 v180, 0
    v_mov_b32 v181, 0
    v_mov_b32 v182, 0
    v_mov_b32 v183, 0
    v_mov_b32 v184, 0
    v_mov_b32 v185, 0
    v_mov_b32 v186, 0
    v_mov_b32 v187, 0
    s_mov_b32 s76, s56
    s_mov_b32 s77, s57
    s_mov_b32 s78, 0x100
    s_mov_b32 s79, 0x00020000
    s_add_u32 s72, s58, 0x1800000
    s_addc_u32 s73, s59, 0
    s_mov_b32 s74, 0x100000
    s_mov_b32 s75, 0x00020000
    s_waitcnt vmcnt(12)
    s_barrier
    ds_read_b64_tr_b16 v[56:57], v14 offset:0
    ds_read_b64_tr_b16 v[58:59], v14 offset:2560
    ds_read_b128 v[96:99], v18 offset:0
    ds_read_b64_tr_b16 v[60:61], v15 offset:64
    ds_read_b64_tr_b16 v[62:63], v15 offset:2624
    ds_read_b64_tr_b16 v[64:65], v14 offset:128
    ds_read_b64_tr_b16 v[66:67], v14 offset:2688
    ds_read_b64_tr_b16 v[68:69], v15 offset:192
    ds_read_b64_tr_b16 v[70:71], v15 offset:2752
    ds_read_b64_tr_b16 v[72:73], v14 offset:256
    ds_read_b64_tr_b16 v[74:75], v14 offset:2816
    s_mov_b32 s23, 3
k1_v_loop0:
    s_waitcnt lgkmcnt(8)
    v_mfma_f32_32x32x16_bf16 v[108:123], v[96:99], v[56:59], v[108:123]
    ds_read_b64_tr_b16 v[76:77], v14 offset:10240
    ds_read_b64_tr_b16 v[78:79], v14 offset:12800
    ds_read_b128 v[100:103], v19 offset:0
    s_waitcnt lgkmcnt(9)
    v_mfma_f32_32x32x16_bf16 v[124:139], v[96:99], v[60:63], v[124:139]
    ds_read_b64_tr_b16 v[80:81], v15 offset:10304
    ds_read_b64_tr_b16 v[82:83], v15 offset:12864
    s_waitcnt lgkmcnt(9)
    v_mfma_f32_32x32x16_bf16 v[140:155], v[96:99], v[64:67], v[140:155]
    ds_read_b64_tr_b16 v[84:85], v14 offset:10368
    ds_read_b64_tr_b16 v[86:87], v14 offset:12928
    s_waitcnt lgkmcnt(9)
    v_mfma_f32_32x32x16_bf16 v[156:171], v[96:99], v[68:71], v[156:171]
    ds_read_b64_tr_b16 v[88:89], v15 offset:10432
    ds_read_b64_tr_b16 v[90:91], v15 offset:12992
    s_waitcnt lgkmcnt(9)
    v_mfma_f32_32x32x16_bf16 v[172:187], v[96:99], v[72:75], v[172:187]
    ds_read_b64_tr_b16 v[92:93], v14 offset:10496
    ds_read_b64_tr_b16 v[94:95], v14 offset:13056
    s_cmp_eq_u32 s23, s60
    s_cbranch_scc1 k1cs_22
k1cs_22_back:
    s_waitcnt vmcnt(8)
    s_barrier
    s_cmp_eq_u32 s23, 1
    s_cbranch_scc1 k1dg_23
k1dg_23_back:
    s_waitcnt lgkmcnt(8)
    v_mfma_f32_32x32x16_bf16 v[108:123], v[100:103], v[76:79], v[108:123]
    ds_read_b64_tr_b16 v[56:57], v14 offset:20480
    ds_read_b64_tr_b16 v[58:59], v14 offset:23040
    ds_read_b128 v[96:99], v18 offset:8192
    s_waitcnt lgkmcnt(9)
    v_mfma_f32_32x32x16_bf16 v[124:139], v[100:103], v[80:83], v[124:139]
    ds_read_b64_tr_b16 v[60:61], v15 offset:20544
    ds_read_b64_tr_b16 v[62:63], v15 offset:23104
    s_add_u32 m0, s28, 32768
    s_nop 0
    buffer_load_dwordx4 v13, s[8:11], s25 offen lds
    s_waitcnt lgkmcnt(9)
    v_mfma_f32_32x32x16_bf16 v[140:155], v[100:103], v[84:87], v[140:155]
    ds_read_b64_tr_b16 v[64:65], v14 offset:20608
    ds_read_b64_tr_b16 v[66:67], v14 offset:23168
    s_add_u32 m0, s27, 81920
    s_add_u32 s25, s25, 64
    buffer_load_dwordx4 v10, s[12:15], s24 offen lds
    s_waitcnt lgkmcnt(9)
    v_mfma_f32_32x32x16_bf16 v[156:171], v[100:103], v[88:91], v[156:171]
    ds_read_b64_tr_b16 v[68:69], v15 offset:20672
    ds_read_b64_tr_b16 v[70:71], v15 offset:23232
    buffer_load_dwordx4 v11, s[12:15], s24 offen offset:1024 lds
    s_waitcnt lgkmcnt(9)
    v_mfma_f32_32x32x16_bf16 v[172:187], v[100:103], v[92:95], v[172:187]
    ds_read_b64_tr_b16 v[72:73], v14 offset:20736
    ds_read_b64_tr_b16 v[74:75], v14 offset:23296
    buffer_load_dwordx4 v12, s[12:15], s24 offen offset:2048 lds
    s_add_u32 s24, s24, 122880
    s_cmp_eq_u32 s25, 1280
    s_cselect_b32 s25, 0, s25
    s_cselect_b32 s24, 0, s24
    s_waitcnt lgkmcnt(8)
    v_mfma_f32_32x32x16_bf16 v[108:123], v[96:99], v[56:59], v[108:123]
    ds_read_b64_tr_b16 v[76:77], v14 offset:30720
    ds_read_b64_tr_b16 v[78:79], v14 offset:33280
    ds_read_b128 v[100:103], v19 offset:8192
    s_waitcnt lgkmcnt(9)
    v_mfma_f32_32x32x16_bf16 v[124:139], v[96:99], v[60:63], v[124:139]
    ds_read_b64_tr_b16 v[80:81], v15 offset:30784
    ds_read_b64_tr_b16 v[82:83], v15 offset:33344
    s_waitcnt lgkmcnt(9)
    v_mfma_f32_32x32x16_bf16 v[140:155], v[96:99], v[64:67], v[140:155]
    ds_read_b64_tr_b16 v[84:85], v14 offset:30848
    ds_read_b64_tr_b16 v[86:87], v14 offset:33408
    s_waitcnt lgkmcnt(9)
    v_mfma_f32_32x32x16_bf16 v[156:171], v[96:99], v[68:71], v[156:171]
    ds_read_b64_tr_b16 v[88:89], v15 offset:30912
    ds_read_b64_tr_b16 v[90:91], v15 offset:33472
    s_waitcnt lgkmcnt(9)
    v_mfma_f32_32x32x16_bf16 v[172:187], v[96:99], v[72:75], v[172:187]
    ds_read_b64_tr_b16 v[92:93], v14 offset:30976
    ds_read_b64_tr_b16 v[94:95], v14 offset:33536
    s_cmp_eq_u32 s23, s61
    s_cbranch_scc1 k1cs_24
k1cs_24_back:
    s_waitcnt vmcnt(8)
    s_barrier
    s_waitcnt lgkmcnt(8)
    v_mfma_f32_32x32x16_bf16 v[108:123], v[100:103], v[76:79], v[108:123]
    ds_read_b64_tr_b16 v[56:57], v14 offset:40960
    ds_read_b64_tr_b16 v[58:59], v14 offset:43520
    ds_read_b128 v[96:99], v18 offset:16384
    s_waitcnt lgkmcnt(9)
    v_mfma_f32_32x32x16_bf16 v[124:139], v[100:103], v[80:83], v[124:139]
    ds_read_b64_tr_b16 v[60:61], v15 offset:41024
    ds_read_b64_tr_b16 v[62:63], v15 offset:43584
    s_add_u32 m0, s28, 0
    s_nop 0
    buffer_load_dwordx4 v13, s[8:11], s25 offen lds
    s_waitcnt lgkmcnt(9)
    v_mfma_f32_32x32x16_bf16 v[140:155], v[100:103], v[84:87], v[140:155]
    ds_read_b64_tr_b16 v[64:65], v14 offset:41088
    ds_read_b64_tr_b16 v[66:67], v14 offset:43648
    s_add_u32 m0, s27, 0
    s_add_u32 s25, s25, 64
    buffer_load_dwordx4 v10, s[12:15], s24 offen lds
    s_waitcnt lgkmcnt(9)
    v_mfma_f32_32x32x16_bf16 v[156:171], v[100:103], v[88:91], v[156:171]
    ds_read_b64_tr_b16 v[68:69], v15 offset:41152
    ds_read_b64_tr_b16 v[70:71], v15 offset:43712
    buffer_load_dwordx4 v11, s[12:15], s24 offen offset:1024 lds
    s_waitcnt lgkmcnt(9)
    v_mfma_f32_32x32x16_bf16 v[172:187], v[100:103], v[92:95], v[172:187]
    ds_read_b64_tr_b16 v[72:73], v14 offset:41216
    ds_read_b64_tr_b16 v[74:75], v14 offset:43776
    buffer_load_dwordx4 v12, s[12:15], s24 offen offset:2048 lds
    s_add_u32 s24, s24, 122880
    s_cmp_eq_u32 s25, 1280
    s_cselect_b32 s25, 0, s25
    s_cselect_b32 s24, 0, s24
    s_waitcnt lgkmcnt(8)
    v_mfma_f32_32x32x16_bf16 v[108:123], v[96:99], v[56:59], v[108:123]
    ds_read_b64_tr_b16 v[76:77], v14 offset:51200
    ds_read_b64_tr_b16 v[78:79], v14 offset:53760
    ds_read_b128 v[100:103], v19 offset:16384
    s_waitcnt lgkmcnt(9)
    v_mfma_f32_32x32x16_bf16 v[124:139], v[96:99], v[60:63], v[124:139]
    ds_read_b64_tr_b16 v[80:81], v15 offset:51264
    ds_read_b64_tr_b16 v[82:83], v15 offset:53824
    s_waitcnt lgkmcnt(9)
    v_mfma_f32_32x32x16_bf16 v[140:155], v[96:99], v[64:67], v[140:155]
    ds_read_b64_tr_b16 v[84:85], v14 offset:51328
    ds_read_b64_tr_b16 v[86:87], v14 offset:53888
    s_waitcnt lgkmcnt(9)
    v_mfma_f32_32x32x16_bf16 v[156:171], v[96:99], v[68:71], v[156:171]
    ds_read_b64_tr_b16 v[88:89], v15 offset:51392
    ds_read_b64_tr_b16 v[90:91], v15 offset:53952
    s_waitcnt lgkmcnt(9)
    v_mfma_f32_32x32x16_bf16 v[172:187], v[96:99], v[72:75], v[172:187]
    ds_read_b64_tr_b16 v[92:93], v14 offset:51456
    ds_read_b64_tr_b16 v[94:95], v14 offset:54016
    s_cmp_eq_u32 s23, s62
    s_cbranch_scc1 k1cs_25
k1cs_25_back:
    s_cmp_eq_u32 s23, 3
    s_cbranch_scc0 k1nl_26
    buffer_load_dword v22, off, s[76:79], 0 sc1
k1nl_26:
    s_waitcnt vmcnt(8)
    s_barrier
    s_cmp_eq_u32 s23, 1
    s_cbranch_scc1 k1dg_27
k1dg_27_back:
    s_waitcnt lgkmcnt(8)
    v_mfma_f32_32x32x16_bf16 v[108:123], v[100:103], v[76:79], v[108:123]
    ds_read_b64_tr_b16 v[56:57], v16 offset:0
    ds_read_b64_tr_b16 v[58:59], v16 offset:2560
    ds_read_b128 v[96:99], v18 offset:24576
    s_waitcnt lgkmcnt(9)
    v_mfma_f32_32x32x16_bf16 v[124:139], v[100:103], v[80:83], v[124:139]
    ds_read_b64_tr_b16 v[60:61], v17 offset:64
    ds_read_b64_tr_b16 v[62:63], v17 offset:2624
    s_add_u32 m0, s28, 8192
    s_nop 0
    buffer_load_dwordx4 v13, s[8:11], s25 offen lds
    s_waitcnt lgkmcnt(9)
    v_mfma_f32_32x32x16_bf16 v[140:155], v[100:103], v[84:87], v[140:155]
    ds_read_b64_tr_b16 v[64:65], v16 offset:128
    ds_read_b64_tr_b16 v[66:67], v16 offset:2688
    s_add_u32 m0, s27, 20480
    s_add_u32 s25, s25, 64
    buffer_load_dwordx4 v10, s[12:15], s24 offen lds
    s_waitcnt lgkmcnt(9)
    v_mfma_f32_32x32x16_bf16 v[156:171], v[100:103], v[88:91], v[156:171]
    ds_read_b64_tr_b16 v[68:69], v17 offset:192
    ds_read_b64_tr_b16 v[70:71], v17 offset:2752
    buffer_load_dwordx4 v11, s[12:15], s24 offen offset:1024 lds
    s_waitcnt lgkmcnt(9)
    v_mfma_f32_32x32x16_bf16 v[172:187], v[100:103], v[92:95], v[172:187]
    ds_read_b64_tr_b16 v[72:73], v16 offset:256
    ds_read_b64_tr_b16 v[74:75], v16 offset:2816
    buffer_load_dwordx4 v12, s[12:15], s24 offen offset:2048 lds
    s_add_u32 s24, s24, 122880
    s_cmp_eq_u32 s25, 1280
    s_cselect_b32 s25, 0, s25
    s_cselect_b32 s24, 0, s24
    s_waitcnt lgkmcnt(8)
    v_mfma_f32_32x32x16_bf16 v[108:123], v[96:99], v[56:59], v[108:123]
    ds_read_b64_tr_b16 v[76:77], v16 offset:10240
    ds_read_b64_tr_b16 v[78:79], v16 offset:12800
    ds_read_b128 v[100:103], v19 offset:24576
    s_waitcnt lgkmcnt(9)
    v_mfma_f32_32x32x16_bf16 v[124:139], v[96:99], v[60:63], v[124:139]
    ds_read_b64_tr_b16 v[80:81], v17 offset:10304
    ds_read_b64_tr_b16 v[82:83], v17 offset:12864
    s_waitcnt lgkmcnt(9)
    v_mfma_f32_32x32x16_bf16 v[140:155], v[96:99], v[64:67], v[140:155]
    ds_read_b64_tr_b16 v[84:85], v16 offset:10368
    ds_read_b64_tr_b16 v[86:87], v16 offset:12928
    s_waitcnt lgkmcnt(9)
    v_mfma_f32_32x32x16_bf16 v[156:171], v[96:99], v[68:71], v[156:171]
    ds_read_b64_tr_b16 v[88:89], v17 offset:10432
    ds_read_b64_tr_b16 v[90:91], v17 offset:12992
    s_waitcnt lgkmcnt(9)
    v_mfma_f32_32x32x16_bf16 v[172:187], v[96:99], v[72:75], v[172:187]
    ds_read_b64_tr_b16 v[92:93], v16 offset:10496
    ds_read_b64_tr_b16 v[94:95], v16 offset:13056
    s_cmp_eq_u32 s23, s63
    s_cbranch_scc1 k1cs_28
k1cs_28_back:
    s_waitcnt vmcnt(8)
    s_barrier
    s_waitcnt lgkmcnt(8)
    v_mfma_f32_32x32x16_bf16 v[108:123], v[100:103], v[76:79], v[108:123]
    ds_read_b64_tr_b16 v[56:57], v16 offset:20480
    ds_read_b64_tr_b16 v[58:59], v16 offset:23040
    ds_read_b128 v[96:99], v18 offset:32768
    s_waitcnt lgkmcnt(9)
    v_mfma_f32_32x32x16_bf16 v[124:139], v[100:103], v[80:83], v[124:139]
    ds_read_b64_tr_b16 v[60:61], v17 offset:20544
    ds_read_b64_tr_b16 v[62:63], v17 offset:23104
    s_add_u32 m0, s28, 16384
    s_nop 0
    buffer_load_dwordx4 v13, s[8:11], s25 offen lds
    s_waitcnt lgkmcnt(9)
    v_mfma_f32_32x32x16_bf16 v[140:155], v[100:103], v[84:87], v[140:155]
    ds_read_b64_tr_b16 v[64:65], v16 offset:20608
    ds_read_b64_tr_b16 v[66:67], v16 offset:23168
    s_add_u32 m0, s27, 40960
    s_add_u32 s25, s25, 64
    buffer_load_dwordx4 v10, s[12:15], s24 offen lds
    s_waitcnt lgkmcnt(9)
    v_mfma_f32_32x32x16_bf16 v[156:171], v[100:103], v[88:91], v[156:171]
    ds_read_b64_tr_b16 v[68:69], v17 offset:20672
    ds_read_b64_tr_b16 v[70:71], v17 offset:23232
    buffer_load_dwordx4 v11, s[12:15], s24 offen offset:1024 lds
    s_waitcnt lgkmcnt(9)
    v_mfma_f32_32x32x16_bf16 v[172:187], v[100:103], v[92:95], v[172:187]
    ds_read_b64_tr_b16 v[72:73], v16 offset:20736
    ds_read_b64_tr_b16 v[74:75], v16 offset:23296
    buffer_load_dwordx4 v12, s[12:15], s24 offen offset:2048 lds
    s_add_u32 s24, s24, 122880
    s_cmp_eq_u32 s25, 1280
    s_cselect_b32 s25, 0, s25
    s_cselect_b32 s24, 0, s24
    s_waitcnt lgkmcnt(8)
    v_mfma_f32_32x32x16_bf16 v[108:123], v[96:99], v[56:59], v[108:123]
    ds_read_b64_tr_b16 v[76:77], v16 offset:30720
    ds_read_b64_tr_b16 v[78:79], v16 offset:33280
    ds_read_b128 v[100:103], v19 offset:32768
    s_waitcnt lgkmcnt(9)
    v_mfma_f32_32x32x16_bf16 v[124:139], v[96:99], v[60:63], v[124:139]
    ds_read_b64_tr_b16 v[80:81], v17 offset:30784
    ds_read_b64_tr_b16 v[82:83], v17 offset:33344
    s_waitcnt lgkmcnt(9)
    v_mfma_f32_32x32x16_bf16 v[140:155], v[96:99], v[64:67], v[140:155]
    ds_read_b64_tr_b16 v[84:85], v16 offset:30848
    ds_read_b64_tr_b16 v[86:87], v16 offset:33408
    s_waitcnt lgkmcnt(9)
    v_mfma_f32_32x32x16_bf16 v[156:171], v[96:99], v[68:71], v[156:171]
    ds_read_b64_tr_b16 v[88:89], v17 offset:30912
    ds_read_b64_tr_b16 v[90:91], v17 offset:33472
    s_waitcnt lgkmcnt(9)
    v_mfma_f32_32x32x16_bf16 v[172:187], v[96:99], v[72:75], v[172:187]
    ds_read_b64_tr_b16 v[92:93], v16 offset:30976
    ds_read_b64_tr_b16 v[94:95], v16 offset:33536
    s_cmp_eq_u32 s23, s64
    s_cbranch_scc1 k1cs_29
k1cs_29_back:
    s_waitcnt vmcnt(8)
    s_barrier
    s_cmp_eq_u32 s23, 3
    s_cbranch_scc1 k1pub_30
k1pub_30_back:
    s_waitcnt lgkmcnt(8)
    v_mfma_f32_32x32x16_bf16 v[108:123], v[100:103], v[76:79], v[108:123]
    ds_read_b64_tr_b16 v[56:57], v14 offset:0
    ds_read_b64_tr_b16 v[58:59], v14 offset:2560
    ds_read_b128 v[96:99], v18 offset:0
    s_waitcnt lgkmcnt(9)
    v_mfma_f32_32x32x16_bf16 v[124:139], v[100:103], v[80:83], v[124:139]
    ds_read_b64_tr_b16 v[60:61], v15 offset:64
    ds_read_b64_tr_b16 v[62:63], v15 offset:2624
    s_add_u32 m0, s28, 24576
    s_nop 0
    buffer_load_dwordx4 v13, s[8:11], s25 offen lds
    s_waitcnt lgkmcnt(9)
    v_mfma_f32_32x32x16_bf16 v[140:155], v[100:103], v[84:87], v[140:155]
    ds_read_b64_tr_b16 v[64:65], v14 offset:128
    ds_read_b64_tr_b16 v[66:67], v14 offset:2688
    s_add_u32 m0, s27, 61440
    s_add_u32 s25, s25, 64
    buffer_load_dwordx4 v10, s[12:15], s24 offen lds
    s_waitcnt lgkmcnt(9)
    v_mfma_f32_32x32x16_bf16 v[156:171], v[100:103], v[88:91], v[156:171]
    ds_read_b64_tr_b16 v[68:69], v15 offset:192
    ds_read_b64_tr_b16 v[70:71], v15 offset:2752
    buffer_load_dwordx4 v11, s[12:15], s24 offen offset:1024 lds
    s_waitcnt lgkmcnt(9)
    v_mfma_f32_32x32x16_bf16 v[172:187], v[100:103], v[92:95], v[172:187]
    ds_read_b64_tr_b16 v[72:73], v14 offset:256
    ds_read_b64_tr_b16 v[74:75], v14 offset:2816
    buffer_load_dwordx4 v12, s[12:15], s24 offen offset:2048 lds
    s_add_u32 s24, s24, 122880
    s_cmp_eq_u32 s25, 1280
    s_cselect_b32 s25, 0, s25
    s_cselect_b32 s24, 0, s24
    s_sub_u32 s23, s23, 1
    s_cmp_lg_u32 s23, 0
    s_cbranch_scc1 k1_v_loop0
    s_waitcnt lgkmcnt(8)
    v_mfma_f32_32x32x16_bf16 v[108:123], v[96:99], v[56:59], v[108:123]
    ds_read_b64_tr_b16 v[76:77], v14 offset:10240
    ds_read_b64_tr_b16 v[78:79], v14 offset:12800
    ds_read_b128 v[100:103], v19 offset:0
    s_waitcnt lgkmcnt(9)
    v_mfma_f32_32x32x16_bf16 v[124:139], v[96:99], v[60:63], v[124:139]
    ds_read_b64_tr_b16 v[80:81], v15 offset:10304
    ds_read_b64_tr_b16 v[82:83], v15 offset:12864
    s_waitcnt lgkmcnt(9)
    v_mfma_f32_32x32x16_bf16 v[140:155], v[96:99], v[64:67], v[140:155]
    ds_read_b64_tr_b16 v[84:85], v14 offset:10368
    ds_read_b64_tr_b16 v[86:87], v14 offset:12928
    s_waitcnt lgkmcnt(9)
    v_mfma_f32_32x32x16_bf16 v[156:171], v[96:99], v[68:71], v[156:171]
    ds_read_b64_tr_b16 v[88:89], v15 offset:10432
    ds_read_b64_tr_b16 v[90:91], v15 offset:12992
    s_waitcnt lgkmcnt(9)
    v_mfma_f32_32x32x16_bf16 v[172:187], v[96:99], v[72:75], v[172:187]
    ds_read_b64_tr_b16 v[92:93], v14 offset:10496
    ds_read_b64_tr_b16 v[94:95], v14 offset:13056
    s_waitcnt vmcnt(8)
    s_barrier
    s_waitcnt lgkmcnt(8)
    v_mfma_f32_32x32x16_bf16 v[108:123], v[100:103], v[76:79], v[108:123]
    ds_read_b64_tr_b16 v[56:57], v14 offset:20480
    ds_read_b64_tr_b16 v[58:59], v14 offset:23040
    ds_read_b128 v[96:99], v18 offset:8192
    s_waitcnt lgkmcnt(9)
    v_mfma_f32_32x32x16_bf16 v[124:139], v[100:103], v[80:83], v[124:139]
    ds_read_b64_tr_b16 v[60:61], v15 offset:20544
    ds_read_b64_tr_b16 v[62:63], v15 offset:23104
    s_add_u32 m0, s28, 32768
    s_nop 0
    buffer_load_dwordx4 v13, s[8:11], s25 offen lds
    s_waitcnt lgkmcnt(9)
    v_mfma_f32_32x32x16_bf16 v[140:155], v[100:103], v[84:87], v[140:155]
    ds_read_b64_tr_b16 v[64:65], v14 offset:20608
    ds_read_b64_tr_b16 v[66:67], v14 offset:23168
    s_add_u32 m0, s27, 81920
    s_add_u32 s25, s25, 64
    buffer_load_dwordx4 v10, s[12:15], s24 offen lds
    s_waitcnt lgkmcnt(9)
    v_mfma_f32_32x32x16_bf16 v[156:171], v[100:103], v[88:91], v[156:171]
    ds_read_b64_tr_b16 v[68:69], v15 offset:20672
    ds_read_b64_tr_b16 v[70:71], v15 offset:23232
    buffer_load_dwordx4 v11, s[12:15], s24 offen offset:1024 lds
    s_waitcnt lgkmcnt(9)
    v_mfma_f32_32x32x16_bf16 v[172:187], v[100:103], v[92:95], v[172:187]
    ds_read_b64_tr_b16 v[72:73], v14 offset:20736
    ds_read_b64_tr_b16 v[74:75], v14 offset:23296
    buffer_load_dwordx4 v12, s[12:15], s24 offen offset:2048 lds
    s_add_u32 s24, s24, 122880
    s_cmp_eq_u32 s25, 1280
    s_cselect_b32 s25, 0, s25
    s_cselect_b32 s24, 0, s24
    s_waitcnt lgkmcnt(8)
    v_mfma_f32_32x32x16_bf16 v[108:123], v[96:99], v[56:59], v[108:123]
    ds_read_b64_tr_b16 v[76:77], v14 offset:30720
    ds_read_b64_tr_b16 v[78:79], v14 offset:33280
    ds_read_b128 v[100:103], v19 offset:8192
    s_waitcnt lgkmcnt(9)
    v_mfma_f32_32x32x16_bf16 v[124:139], v[96:99], v[60:63], v[124:139]
    ds_read_b64_tr_b16 v[80:81], v15 offset:30784
    ds_read_b64_tr_b16 v[82:83], v15 offset:33344
    s_waitcnt lgkmcnt(9)
    v_mfma_f32_32x32x16_bf16 v[140:155], v[96:99], v[64:67], v[140:155]
    ds_read_b64_tr_b16 v[84:85], v14 offset:30848
    ds_read_b64_tr_b16 v[86:87], v14 offset:33408
    s_waitcnt lgkmcnt(9)
    v_mfma_f32_32x32x16_bf16 v[156:171], v[96:99], v[68:71], v[156:171]
    ds_read_b64_tr_b16 v[88:89], v15 offset:30912
    ds_read_b64_tr_b16 v[90:91], v15 offset:33472
    s_waitcnt lgkmcnt(9)
    v_mfma_f32_32x32x16_bf16 v[172:187], v[96:99], v[72:75], v[172:187]
    ds_read_b64_tr_b16 v[92:93], v14 offset:30976
    ds_read_b64_tr_b16 v[94:95], v14 offset:33536
    s_waitcnt vmcnt(8)
    s_barrier
    s_waitcnt lgkmcnt(8)
    v_mfma_f32_32x32x16_bf16 v[108:123], v[100:103], v[76:79], v[108:123]
    ds_read_b64_tr_b16 v[56:57], v14 offset:40960
    ds_read_b64_tr_b16 v[58:59], v14 offset:43520
    ds_read_b128 v[96:99], v18 offset:16384
    s_waitcnt lgkmcnt(9)
    v_mfma_f32_32x32x16_bf16 v[124:139], v[100:103], v[80:83], v[124:139]
    ds_read_b64_tr_b16 v[60:61], v15 offset:41024
    ds_read_b64_tr_b16 v[62:63], v15 offset:43584
    s_waitcnt lgkmcnt(9)
    v_mfma_f32_32x32x16_bf16 v[140:155], v[100:103], v[84:87], v[140:155]
    ds_read_b64_tr_b16 v[64:65], v14 offset:41088
    ds_read_b64_tr_b16 v[66:67], v14 offset:43648
    s_waitcnt lgkmcnt(9)
    v_mfma_f32_32x32x16_bf16 v[156:171], v[100:103], v[88:91], v[156:171]
    ds_read_b64_tr_b16 v[68:69], v15 offset:41152
    ds_read_b64_tr_b16 v[70:71], v15 offset:43712
    s_waitcnt lgkmcnt(9)
    v_mfma_f32_32x32x16_bf16 v[172:187], v[100:103], v[92:95], v[172:187]
    ds_read_b64_tr_b16 v[72:73], v14 offset:41216
    ds_read_b64_tr_b16 v[74:75], v14 offset:43776
    s_waitcnt lgkmcnt(8)
    v_mfma_f32_32x32x16_bf16 v[108:123], v[96:99], v[56:59], v[108:123]
    ds_read_b64_tr_b16 v[76:77], v14 offset:51200
    ds_read_b64_tr_b16 v[78:79], v14 offset:53760
    ds_read_b128 v[100:103], v19 offset:16384
    s_waitcnt lgkmcnt(9)
    v_mfma_f32_32x32x16_bf16 v[124:139], v[96:99], v[60:63], v[124:139]
    ds_read_b64_tr_b16 v[80:81], v15 offset:51264
    ds_read_b64_tr_b16 v[82:83], v15 offset:53824
    s_waitcnt lgkmcnt(9)
    v_mfma_f32_32x32x16_bf16 v[140:155], v[96:99], v[64:67], v[140:155]
    ds_read_b64_tr_b16 v[84:85], v14 offset:51328
    ds_read_b64_tr_b16 v[86:87], v14 offset:53888
    s_waitcnt lgkmcnt(9)
    v_mfma_f32_32x32x16_bf16 v[156:171], v[96:99], v[68:71], v[156:171]
    ds_read_b64_tr_b16 v[88:89], v15 offset:51392
    ds_read_b64_tr_b16 v[90:91], v15 offset:53952
    s_waitcnt lgkmcnt(9)
    v_mfma_f32_32x32x16_bf16 v[172:187], v[96:99], v[72:75], v[172:187]
    ds_read_b64_tr_b16 v[92:93], v14 offset:51456
    ds_read_b64_tr_b16 v[94:95], v14 offset:54016
    s_waitcnt vmcnt(4)
    s_barrier
    s_waitcnt lgkmcnt(8)
    v_mfma_f32_32x32x16_bf16 v[108:123], v[100:103], v[76:79], v[108:123]
    ds_read_b64_tr_b16 v[56:57], v16 offset:0
    ds_read_b64_tr_b16 v[58:59], v16 offset:2560
    ds_read_b128 v[96:99], v18 offset:24576
    s_waitcnt lgkmcnt(9)
    v_mfma_f32_32x32x16_bf16 v[124:139], v[100:103], v[80:83], v[124:139]
    ds_read_b64_tr_b16 v[60:61], v17 offset:64
    ds_read_b64_tr_b16 v[62:63], v17 offset:2624
    s_waitcnt lgkmcnt(9)
    v_mfma_f32_32x32x16_bf16 v[140:155], v[100:103], v[84:87], v[140:155]
    ds_read_b64_tr_b16 v[64:65], v16 offset:128
    ds_read_b64_tr_b16 v[66:67], v16 offset:2688
    s_waitcnt lgkmcnt(9)
    v_mfma_f32_32x32x16_bf16 v[156:171], v[100:103], v[88:91], v[156:171]
    ds_read_b64_tr_b16 v[68:69], v17 offset:192
    ds_read_b64_tr_b16 v[70:71], v17 offset:2752
    s_waitcnt lgkmcnt(9)
    v_mfma_f32_32x32x16_bf16 v[172:187], v[100:103], v[92:95], v[172:187]
    ds_read_b64_tr_b16 v[72:73], v16 offset:256
    ds_read_b64_tr_b16 v[74:75], v16 offset:2816
    s_waitcnt lgkmcnt(8)
    v_mfma_f32_32x32x16_bf16 v[108:123], v[96:99], v[56:59], v[108:123]
    ds_read_b64_tr_b16 v[76:77], v16 offset:10240
    ds_read_b64_tr_b16 v[78:79], v16 offset:12800
    ds_read_b128 v[100:103], v19 offset:24576
    s_waitcnt lgkmcnt(9)
    v_mfma_f32_32x32x16_bf16 v[124:139], v[96:99], v[60:63], v[124:139]
    ds_read_b64_tr_b16 v[80:81], v17 offset:10304
    ds_read_b64_tr_b16 v[82:83], v17 offset:12864
    s_waitcnt lgkmcnt(9)
    v_mfma_f32_32x32x16_bf16 v[140:155], v[96:99], v[64:67], v[140:155]
    ds_read_b64_tr_b16 v[84:85], v16 offset:10368
    ds_read_b64_tr_b16 v[86:87], v16 offset:12928
    s_waitcnt lgkmcnt(9)
    v_mfma_f32_32x32x16_bf16 v[156:171], v[96:99], v[68:71], v[156:171]
    ds_read_b64_tr_b16 v[88:89], v17 offset:10432
    ds_read_b64_tr_b16 v[90:91], v17 offset:12992
    s_waitcnt lgkmcnt(9)
    v_mfma_f32_32x32x16_bf16 v[172:187], v[96:99], v[72:75], v[172:187]
    ds_read_b64_tr_b16 v[92:93], v16 offset:10496
    ds_read_b64_tr_b16 v[94:95], v16 offset:13056
    v_lshlrev_b32 v3, 1, v23
    v_lshlrev_b32 v4, 2, v24
    s_mul_i32 s4, s21, 3072
    s_lshl_b32 s5, s20, 11
    s_add_u32 s5, s5, 65536
    buffer_load_dwordx2 v[20:21], v3, s[72:75], s4 offen sc1
    buffer_load_dwordx4 v[28:31], v4, s[72:75], s5 offen sc1
    s_waitcnt vmcnt(2)
    s_barrier
    s_waitcnt lgkmcnt(8)
    v_mfma_f32_32x32x16_bf16 v[108:123], v[100:103], v[76:79], v[108:123]
    ds_read_b64_tr_b16 v[56:57], v16 offset:20480
    ds_read_b64_tr_b16 v[58:59], v16 offset:23040
    ds_read_b128 v[96:99], v18 offset:32768
    s_waitcnt lgkmcnt(9)
    v_mfma_f32_32x32x16_bf16 v[124:139], v[100:103], v[80:83], v[124:139]
    ds_read_b64_tr_b16 v[60:61], v17 offset:20544
    ds_read_b64_tr_b16 v[62:63], v17 offset:23104
    s_waitcnt lgkmcnt(9)
    v_mfma_f32_32x32x16_bf16 v[140:155], v[100:103], v[84:87], v[140:155]
    ds_read_b64_tr_b16 v[64:65], v16 offset:20608
    ds_read_b64_tr_b16 v[66:67], v16 offset:23168
    s_waitcnt lgkmcnt(9)
    v_mfma_f32_32x32x16_bf16 v[156:171], v[100:103], v[88:91], v[156:171]
    ds_read_b64_tr_b16 v[68:69], v17 offset:20672
    ds_read_b64_tr_b16 v[70:71], v17 offset:23232
    s_waitcnt lgkmcnt(9)
    v_mfma_f32_32x32x16_bf16 v[172:187], v[100:103], v[92:95], v[172:187]
    ds_read_b64_tr_b16 v[72:73], v16 offset:20736
    ds_read_b64_tr_b16 v[74:75], v16 offset:23296
    s_waitcnt lgkmcnt(8)
    v_mfma_f32_32x32x16_bf16 v[108:123], v[96:99], v[56:59], v[108:123]
    ds_read_b64_tr_b16 v[76:77], v16 offset:30720
    ds_read_b64_tr_b16 v[78:79], v16 offset:33280
    ds_read_b128 v[100:103], v19 offset:32768
    s_waitcnt lgkmcnt(9)
    v_mfma_f32_32x32x16_bf16 v[124:139], v[96:99], v[60:63], v[124:139]
    ds_read_b64_tr_b16 v[80:81], v17 offset:30784
    ds_read_b64_tr_b16 v[82:83], v17 offset:33344
    s_waitcnt lgkmcnt(9)
    v_mfma_f32_32x32x16_bf16 v[140:155], v[96:99], v[64:67], v[140:155]
    ds_read_b64_tr_b16 v[84:85], v16 offset:30848
    ds_read_b64_tr_b16 v[86:87], v16 offset:33408
    s_waitcnt lgkmcnt(9)
    v_mfma_f32_32x32x16_bf16 v[156:171], v[96:99], v[68:71], v[156:171]
    ds_read_b64_tr_b16 v[88:89], v17 offset:30912
    ds_read_b64_tr_b16 v[90:91], v17 offset:33472
    s_waitcnt lgkmcnt(9)
    v_mfma_f32_32x32x16_bf16 v[172:187], v[96:99], v[72:75], v[172:187]
    ds_read_b64_tr_b16 v[92:93], v16 offset:30976
    ds_read_b64_tr_b16 v[94:95], v16 offset:33536
    s_waitcnt lgkmcnt(8)
    v_mfma_f32_32x32x16_bf16 v[108:123], v[100:103], v[76:79], v[108:123]
    s_waitcnt lgkmcnt(6)
    v_mfma_f32_32x32x16_bf16 v[124:139], v[100:103], v[80:83], v[124:139]
    s_waitcnt lgkmcnt(4)
    v_mfma_f32_32x32x16_bf16 v[140:155], v[100:103], v[84:87], v[140:155]
    s_waitcnt vmcnt(0)
    v_cmp_ne_u32 vcc, s29, v21
    v_cmp_ne_u32 s[6:7], s29, v30
    s_nop 1
    s_or_b64 vcc, vcc, s[6:7]
    s_cbranch_vccnz k1retry_31
k1back_32:
    ds_write_b32 v23, v20 offset:0
    ds_write_b32 v24, v28 offset:1536
    ds_write_b32 v24, v29 offset:2048
    s_waitcnt lgkmcnt(5)
    v_mfma_f32_32x32x16_bf16 v[156:171], v[100:103], v[88:91], v[156:171]
    s_waitcnt lgkmcnt(3)
    v_mfma_f32_32x32x16_bf16 v[172:187], v[100:103], v[92:95], v[172:187]
    s_waitcnt lgkmcnt(0)
    s_barrier
    s_branch k1_v_epi
k1retry_31:
    s_mov_b32 s23, 200000
k1retry_31_l:
    s_sleep 2
    v_lshlrev_b32 v3, 1, v23
    v_lshlrev_b32 v4, 2, v24
    s_mul_i32 s4, s21, 3072
    s_lshl_b32 s5, s20, 11
    s_add_u32 s5, s5, 65536
    buffer_load_dwordx2 v[20:21], v3, s[72:75], s4 offen sc1
    buffer_load_dwordx4 v[28:31], v4, s[72:75], s5 offen sc1
    s_waitcnt vmcnt(0)
    v_cmp_ne_u32 vcc, s29, v21
    v_cmp_ne_u32 s[6:7], s29, v30
    s_nop 1
    s_or_b64 vcc, vcc, s[6:7]
    s_cbranch_vccz k1back_32
    s_sub_u32 s23, s23, 1
    s_cmp_lg_u32 s23, 0
    s_cbranch_scc1 k1retry_31_l
    s_branch k1back_32
k1cs_22:
    s_waitcnt lgkmcnt(0)
    s_bitcmp1_b32 s26, 0
    s_cbranch_scc0 k1cs_22_s0
    v_mfma_f32_16x16x32_bf16 v[36:39], v[32:35], v[56:59], v[36:39]
    v_mfma_f32_16x16x32_bf16 v[36:39], v[32:35], v[76:79], v[36:39]
k1cs_22_s0:
    s_bitcmp1_b32 s26, 1
    s_cbranch_scc0 k1cs_22_s1
    v_mfma_f32_16x16x32_bf16 v[40:43], v[32:35], v[60:63], v[40:43]
    v_mfma_f32_16x16x32_bf16 v[40:43], v[32:35], v[80:83], v[40:43]
k1cs_22_s1:
    s_bitcmp1_b32 s26, 2
    s_cbranch_scc0 k1cs_22_s2
    v_mfma_f32_16x16x32_bf16 v[44:47], v[32:35], v[64:67], v[44:47]
    v_mfma_f32_16x16x32_bf16 v[44:47], v[32:35], v[84:87], v[44:47]
k1cs_22_s2:
    s_bitcmp1_b32 s26, 3
    s_cbranch_scc0 k1cs_22_s3
    v_mfma_f32_16x16x32_bf16 v[48:51], v[32:35], v[68:71], v[48:51]
    v_mfma_f32_16x16x32_bf16 v[48:51], v[32:35], v[88:91], v[48:51]
k1cs_22_s3:
    s_bitcmp1_b32 s26, 4
    s_cbranch_scc0 k1cs_22_s4
    v_mfma_f32_16x16x32_bf16 v[52:55], v[32:35], v[72:75], v[52:55]
    v_mfma_f32_16x16x32_bf16 v[52:55], v[32:35], v[92:95], v[52:55]
k1cs_22_s4:
    s_branch k1cs_22_back
k1dg_23:
    s_cmp_ge_u32 s22, 3
    s_cbranch_scc1 k1dg_23_back
    v_lshrrev_b32 v2, 4, v1
    s_lshl_b32 s4, s22, 2
    v_add_u32 v2, s4, v2
    v_min_u32 v2, 9, v2
    s_mul_i32 s4, s20, 10
    v_add_u32 v2, s4, v2
    v_and_b32 v3, 15, v1
    v_mul_u32_u24 v3, 3072, v3
    v_lshl_add_u32 v3, v2, 4, v3
    s_mul_i32 s5, s21, 49152
    s_add_u32 s5, s5, 131072
    buffer_load_dwordx4 v[28:31], v3, s[72:75], s5 offen sc1
    s_branch k1dg_23_back
k1cs_24:
    s_waitcnt lgkmcnt(0)
    s_bitcmp1_b32 s26, 0
    s_cbranch_scc0 k1cs_24_s0
    v_mfma_f32_16x16x32_bf16 v[36:39], v[32:35], v[56:59], v[36:39]
    v_mfma_f32_16x16x32_bf16 v[36:39], v[32:35], v[76:79], v[36:39]
k1cs_24_s0:
    s_bitcmp1_b32 s26, 1
    s_cbranch_scc0 k1cs_24_s1
    v_mfma_f32_16x16x32_bf16 v[40:43], v[32:35], v[60:63], v[40:43]
    v_mfma_f32_16x16x32_bf16 v[40:43], v[32:35], v[80:83], v[40:43]
k1cs_24_s1:
    s_bitcmp1_b32 s26, 2
    s_cbranch_scc0 k1cs_24_s2
    v_mfma_f32_16x16x32_bf16 v[44:47], v[32:35], v[64:67], v[44:47]
    v_mfma_f32_16x16x32_bf16 v[44:47], v[32:35], v[84:87], v[44:47]
k1cs_24_s2:
    s_bitcmp1_b32 s26, 3
    s_cbranch_scc0 k1cs_24_s3
    v_mfma_f32_16x16x32_bf16 v[48:51], v[32:35], v[68:71], v[48:51]
    v_mfma_f32_16x16x32_bf16 v[48:51], v[32:35], v[88:91], v[48:51]
k1cs_24_s3:
    s_bitcmp1_b32 s26, 4
    s_cbranch_scc0 k1cs_24_s4
    v_mfma_f32_16x16x32_bf16 v[52:55], v[32:35], v[72:75], v[52:55]
    v_mfma_f32_16x16x32_bf16 v[52:55], v[32:35], v[92:95], v[52:55]
k1cs_24_s4:
    s_branch k1cs_24_back
k1cs_25:
    s_waitcnt lgkmcnt(0)
    s_bitcmp1_b32 s26, 0
    s_cbranch_scc0 k1cs_25_s0
    v_mfma_f32_16x16x32_bf16 v[36:39], v[32:35], v[56:59], v[36:39]
    v_mfma_f32_16x16x32_bf16 v[36:39], v[32:35], v[76:79], v[36:39]
k1cs_25_s0:
    s_bitcmp1_b32 s26, 1
    s_cbranch_scc0 k1cs_25_s1
    v_mfma_f32_16x16x32_bf16 v[40:43], v[32:35], v[60:63], v[40:43]
    v_mfma_f32_16x16x32_bf16 v[40:43], v[32:35], v[80:83], v[40:43]
k1cs_25_s1:
    s_bitcmp1_b32 s26, 2
    s_cbranch_scc0 k1cs_25_s2
    v_mfma_f32_16x16x32_bf16 v[44:47], v[32:35], v[64:67], v[44:47]
    v_mfma_f32_16x16x32_bf16 v[44:47], v[32:35], v[84:87], v[44:47]
k1cs_25_s2:
    s_bitcmp1_b32 s26, 3
    s_cbranch_scc0 k1cs_25_s3
    v_mfma_f32_16x16x32_bf16 v[48:51], v[32:35], v[68:71], v[48:51]
    v_mfma_f32_16x16x32_bf16 v[48:51], v[32:35], v[88:91], v[48:51]
k1cs_25_s3:
    s_bitcmp1_b32 s26, 4
    s_cbranch_scc0 k1cs_25_s4
    v_mfma_f32_16x16x32_bf16 v[52:55], v[32:35], v[72:75], v[52:55]
    v_mfma_f32_16x16x32_bf16 v[52:55], v[32:35], v[92:95], v[52:55]
k1cs_25_s4:
    s_branch k1cs_25_back
k1dg_27:
    s_cmp_ge_u32 s22, 3
    s_cbranch_scc1 k1dg_27_back
    s_mov_b32 s4, 200000
k1dg_27_l:
    v_cmp_ne_u32 vcc, s29, v30
    s_nop 1
    s_cbranch_vccz k1dg_27_ok
    s_sleep 2
    s_mul_i32 s5, s21, 49152
    s_add_u32 s5, s5, 131072
    buffer_load_dwordx4 v[28:31], v3, s[72:75], s5 offen sc1
    s_waitcnt vmcnt(0)
    s_sub_u32 s4, s4, 1
    s_cmp_lg_u32 s4, 0
    s_cbranch_scc1 k1dg_27_l
k1dg_27_ok:
    s_nop 1
    v_add_f32_dpp v28, v28, v28 row_ror:8 row_mask:0xf bank_mask:0xf
    v_add_f32_dpp v29, v29, v29 row_ror:8 row_mask:0xf bank_mask:0xf
    s_nop 1
    v_add_f32_dpp v28, v28, v28 row_ror:4 row_mask:0xf bank_mask:0xf
    v_add_f32_dpp v29, v29, v29 row_ror:4 row_mask:0xf bank_mask:0xf
    s_nop 1
    v_add_f32_dpp v28, v28, v28 row_ror:2 row_mask:0xf bank_mask:0xf
    v_add_f32_dpp v29, v29, v29 row_ror:2 row_mask:0xf bank_mask:0xf
    s_nop 1
    v_add_f32_dpp v28, v28, v28 row_ror:1 row_mask:0xf bank_mask:0xf
    v_add_f32_dpp v29, v29, v29 row_ror:1 row_mask:0xf bank_mask:0xf
    v_lshrrev_b32 v4, 4, v2
    v_and_b32 v5, 15, v2
    v_lshlrev_b32 v5, 3, v5
    v_lshl_add_u32 v5, v4, 8, v5
    v_mov_b32 v30, v29
    v_mov_b32 v29, s29
    v_mov_b32 v31, s29
    s_mul_i32 s4, s21, 3072
    s_mov_b32 exec_lo, 0x00010001
    s_mov_b32 exec_hi, 0x00010001
    buffer_store_dwordx2 v[28:29], v5, s[72:75], s4 offen sc1
    buffer_store_dwordx2 v[30:31], v5, s[72:75], s4 offen offset:128 sc1
    s_mov_b64 exec, -1
    s_branch k1dg_27_back
k1cs_28:
    s_waitcnt lgkmcnt(0)
    s_bitcmp1_b32 s26, 0
    s_cbranch_scc0 k1cs_28_s0
    v_mfma_f32_16x16x32_bf16 v[36:39], v[32:35], v[56:59], v[36:39]
    v_mfma_f32_16x16x32_bf16 v[36:39], v[32:35], v[76:79], v[36:39]
k1cs_28_s0:
    s_bitcmp1_b32 s26, 1
    s_cbranch_scc0 k1cs_28_s1
    v_mfma_f32_16x16x32_bf16 v[40:43], v[32:35], v[60:63], v[40:43]
    v_mfma_f32_16x16x32_bf16 v[40:43], v[32:35], v[80:83], v[40:43]
k1cs_28_s1:
    s_bitcmp1_b32 s26, 2
    s_cbranch_scc0 k1cs_28_s2
    v_mfma_f32_16x16x32_bf16 v[44:47], v[32:35], v[64:67], v[44:47]
    v_mfma_f32_16x16x32_bf16 v[44:47], v[32:35], v[84:87], v[44:47]
k1cs_28_s2:
    s_bitcmp1_b32 s26, 3
    s_cbranch_scc0 k1cs_28_s3
    v_mfma_f32_16x16x32_bf16 v[48:51], v[32:35], v[68:71], v[48:51]
    v_mfma_f32_16x16x32_bf16 v[48:51], v[32:35], v[88:91], v[48:51]
k1cs_28_s3:
    s_bitcmp1_b32 s26, 4
    s_cbranch_scc0 k1cs_28_s4
    v_mfma_f32_16x16x32_bf16 v[52:55], v[32:35], v[72:75], v[52:55]
    v_mfma_f32_16x16x32_bf16 v[52:55], v[32:35], v[92:95], v[52:55]
k1cs_28_s4:
    s_branch k1cs_28_back
k1cs_29:
    s_waitcnt lgkmcnt(0)
    s_bitcmp1_b32 s26, 0
    s_cbranch_scc0 k1cs_29_s0
    v_mfma_f32_16x16x32_bf16 v[36:39], v[32:35], v[56:59], v[36:39]
    v_mfma_f32_16x16x32_bf16 v[36:39], v[32:35], v[76:79], v[36:39]
k1cs_29_s0:
    s_bitcmp1_b32 s26, 1
    s_cbranch_scc0 k1cs_29_s1
    v_mfma_f32_16x16x32_bf16 v[40:43], v[32:35], v[60:63], v[40:43]
    v_mfma_f32_16x16x32_bf16 v[40:43], v[32:35], v[80:83], v[40:43]
k1cs_29_s1:
    s_bitcmp1_b32 s26, 2
    s_cbranch_scc0 k1cs_29_s2
    v_mfma_f32_16x16x32_bf16 v[44:47], v[32:35], v[64:67], v[44:47]
    v_mfma_f32_16x16x32_bf16 v[44:47], v[32:35], v[84:87], v[44:47]
k1cs_29_s2:
    s_bitcmp1_b32 s26, 3
    s_cbranch_scc0 k1cs_29_s3
    v_mfma_f32_16x16x32_bf16 v[48:51], v[32:35], v[68:71], v[48:51]
    v_mfma_f32_16x16x32_bf16 v[48:51], v[32:35], v[88:91], v[48:51]
k1cs_29_s3:
    s_bitcmp1_b32 s26, 4
    s_cbranch_scc0 k1cs_29_s4
    v_mfma_f32_16x16x32_bf16 v[52:55], v[32:35], v[72:75], v[52:55]
    v_mfma_f32_16x16x32_bf16 v[52:55], v[32:35], v[92:95], v[52:55]
k1cs_29_s4:
    s_branch k1cs_29_back
k1pub_30:
    s_nop 7
    s_mov_b32 s4, 200000
k1pub_30_n:
    v_readfirstlane_b32 s29, v22
    s_cmp_lg_u32 s29, 0
    s_cbranch_scc1 k1pub_30_ok
    s_sleep 2
    buffer_load_dword v22, off, s[76:79], 0 sc1
    s_waitcnt vmcnt(0)
    s_sub_u32 s4, s4, 1
    s_cmp_lg_u32 s4, 0
    s_cbranch_scc1 k1pub_30_n
k1pub_30_ok:
    s_mov_b64 exec, 0xffff
    s_bitcmp1_b32 s26, 0
    s_cbranch_scc0 k1pub_30_s0
    v_mov_b32 v38, s29
    v_mov_b32 v39, s29
    buffer_store_dwordx4 v[36:39], v25, s[72:75], s30 offen offset:0 sc1
k1pub_30_s0:
    s_bitcmp1_b32 s26, 1
    s_cbranch_scc0 k1pub_30_s1
    v_mov_b32 v42, s29
    v_mov_b32 v43, s29
    buffer_store_dwordx4 v[40:43], v25, s[72:75], s30 offen offset:256 sc1
k1pub_30_s1:
    s_bitcmp1_b32 s26, 2
    s_cbranch_scc0 k1pub_30_s2
    v_mov_b32 v46, s29
    v_mov_b32 v47, s29
    buffer_store_dwordx4 v[44:47], v25, s[72:75], s30 offen offset:512 sc1
k1pub_30_s2:
    s_bitcmp1_b32 s26, 3
    s_cbranch_scc0 k1pub_30_s3
    v_mov_b32 v50, s29
    v_mov_b32 v51, s29
    buffer_store_dwordx4 v[48:51], v25, s[72:75], s30 offen offset:768 sc1
k1pub_30_s3:
    s_bitcmp1_b32 s26, 4
    s_cbranch_scc0 k1pub_30_s4
    v_mov_b32 v54, s29
    v_mov_b32 v55, s29
    buffer_store_dwordx4 v[52:55], v25, s[72:75], s30 offen offset:1024 sc1
k1pub_30_s4:
    s_mov_b64 exec, -1
    s_branch k1pub_30_back
k1_v_v1:
    s_add_u32 m0, s28, 0
    s_nop 0
    buffer_load_dwordx4 v13, s[8:11], s25 offen lds
    s_add_u32 m0, s27, 0
    s_add_u32 s25, s25, 64
    buffer_load_dwordx4 v10, s[12:15], s24 offen lds
    buffer_load_dwordx4 v11, s[12:15], s24 offen offset:1024 lds
    s_add_u32 s24, s24, 122880
    s_cmp_eq_u32 s25, 1280
    s_cselect_b32 s25, 0, s25
    s_cselect_b32 s24, 0, s24
    v_lshrrev_b32 v2, 4, v1
    v_bfe_u32 v3, v1, 2, 2
    v_and_b32 v4, 3, v1
    v_bfe_u32 v5, v1, 3, 1
    v_lshrrev_b32 v6, 1, v2
    v_lshl_add_u32 v6, v6, 3, v3
    v_mul_u32_u24 v6, 640, v6
    v_and_b32 v7, 1, v2
    v_lshl_add_u32 v6, v7, 5, v6
    v_lshl_add_u32 v6, v4, 3, v6
    s_mul_i32 s4, s37, 320
    v_add_u32 v6, s4, v6
    v_lshlrev_b32 v7, 6, v5
    v_sub_u32 v8, 0, v7
    s_cmp_eq_u32 s37, 0
    s_cselect_b64 vcc, -1, 0
    v_cndmask_b32 v9, v8, v7, vcc
    v_add_u32 v14, v6, v9
    v_sub_u32 v15, v6, v9
    v_add_u32 v16, 61440, v14
    v_add_u32 v17, 61440, v15
    v_and_b32 v2, 31, v1
    v_bfe_u32 v3, v1, 2, 2
    v_lshrrev_b32 v4, 5, v1
    s_lshl_b32 s5, s36, 11
    s_add_u32 s5, s5, 122880
    v_lshlrev_b32 v2, 6, v2
    v_add_u32 v2, s5, v2
    v_xor_b32 v5, v4, v3
    v_lshl_add_u32 v18, v5, 4, v2
    v_xor_b32 v19, 32, v18
    v_min_u32 v2, 319, v0
    v_lshlrev_b32 v23, 2, v2
    v_and_b32 v2, 127, v0
    v_lshlrev_b32 v24, 2, v2
    v_and_b32 v2, 15, v1
    v_lshlrev_b32 v25, 4, v2
    v_and_b32 v2, 31, v1
    v_mov_b32 v3, 0x3f803f80
    v_cmp_eq_u32 vcc, 0, v2
    v_cmp_eq_u32 s[4:5], 17, v2
    s_nop 1
    s_or_b64 vcc, vcc, s[4:5]
    s_nop 1
    v_cndmask_b32 v32, 0, v3, vcc
    v_mov_b32 v33, v32
    v_mov_b32 v34, v32
    v_mov_b32 v35, v32
    v_mov_b32 v36, 0
    s_add_u32 m0, s28, 8192
    s_nop 0
    buffer_load_dwordx4 v13, s[8:11], s25 offen lds
    s_add_u32 m0, s27, 20480
    s_add_u32 s25, s25, 64
    buffer_load_dwordx4 v10, s[12:15], s24 offen lds
    buffer_load_dwordx4 v11, s[12:15], s24 offen offset:1024 lds
    s_add_u32 s24, s24, 122880
    s_cmp_eq_u32 s25, 1280
    s_cselect_b32 s25, 0, s25
    s_cselect_b32 s24, 0, s24
    v_mov_b32 v37, 0
    v_mov_b32 v38, 0
    v_mov_b32 v39, 0
    v_mov_b32 v40, 0
    v_mov_b32 v41, 0
    v_mov_b32 v42, 0
    v_mov_b32 v43, 0
    v_mov_b32 v44, 0
    v_mov_b32 v45, 0
    v_mov_b32 v46, 0
    v_mov_b32 v47, 0
    v_mov_b32 v48, 0
    v_mov_b32 v49, 0
    v_mov_b32 v50, 0
    v_mov_b32 v51, 0
    v_mov_b32 v52, 0
    v_mov_b32 v53, 0
    v_mov_b32 v54, 0
    v_mov_b32 v55, 0
    v_mov_b32 v108, 0
    v_mov_b32 v109, 0
    v_mov_b32 v110, 0
    v_mov_b32 v111, 0
    v_mov_b32 v112, 0
    v_mov_b32 v113, 0
    v_mov_b32 v114, 0
    v_mov_b32 v115, 0
    v_mov_b32 v116, 0
    v_mov_b32 v117, 0
    v_mov_b32 v118, 0
    v_mov_b32 v119, 0
    v_mov_b32 v120, 0
    v_mov_b32 v121, 0
    v_mov_b32 v122, 0
    v_mov_b32 v123, 0
    v_mov_b32 v124, 0
    v_mov_b32 v125, 0
    v_mov_b32 v126, 0
    v_mov_b32 v127, 0
    v_mov_b32 v128, 0
    v_mov_b32 v129, 0
    v_mov_b32 v130, 0
    v_mov_b32 v131, 0
    v_mov_b32 v132, 0
    v_mov_b32 v133, 0
    v_mov_b32 v134, 0
    v_mov_b32 v135, 0
    v_mov_b32 v136, 0
    v_mov_b32 v137, 0
    s_add_u32 m0, s28, 16384
    s_nop 0
    buffer_load_dwordx4 v13, s[8:11], s25 offen lds
    s_add_u32 m0, s27, 40960
    s_add_u32 s25, s25, 64
    buffer_load_dwordx4 v10, s[12:15], s24 offen lds
    buffer_load_dwordx4 v11, s[12:15], s24 offen offset:1024 lds
    s_add_u32 s24, s24, 122880
    s_cmp_eq_u32 s25, 1280
    s_cselect_b32 s25, 0, s25
    s_cselect_b32 s24, 0, s24
    v_mov_b32 v138, 0
    v_mov_b32 v139, 0
    v_mov_b32 v140, 0
    v_mov_b32 v141, 0
    v_mov_b32 v142, 0
    v_mov_b32 v143, 0
    v_mov_b32 v144, 0
    v_mov_b32 v145, 0
    v_mov_b32 v146, 0
    v_mov_b32 v147, 0
    v_mov_b32 v148, 0
    v_mov_b32 v149, 0
    v_mov_b32 v150, 0
    v_mov_b32 v151, 0
    v_mov_b32 v152, 0
    v_mov_b32 v153, 0
    v_mov_b32 v154, 0
    v_mov_b32 v155, 0
    v_mov_b32 v156, 0
    v_mov_b32 v157, 0
    v_mov_b32 v158, 0
    v_mov_b32 v159, 0
    v_mov_b32 v160, 0
    v_mov_b32 v161, 0
    v_mov_b32 v162, 0
    v_mov_b32 v163, 0
    v_mov_b32 v164, 0
    v_mov_b32 v165, 0
    v_mov_b32 v166, 0
    v_mov_b32 v167, 0
    v_mov_b32 v168, 0
    v_mov_b32 v169, 0
    v_mov_b32 v170, 0
    v_mov_b32 v171, 0
    v_mov_b32 v172, 0
    v_mov_b32 v173, 0
    v_mov_b32 v174, 0
    v_mov_b32 v175, 0
    v_mov_b32 v176, 0
    v_mov_b32 v177, 0
    v_mov_b32 v178, 0
    v_mov_b32 v179, 0
    v_mov_b32 v180, 0
    v_mov_b32 v181, 0
    v_mov_b32 v182, 0
    v_mov_b32 v183, 0
    v_mov_b32 v184, 0
    v_mov_b32 v185, 0
    v_mov_b32 v186, 0
    v_mov_b32 v187, 0
    s_mov_b32 s76, s56
    s_mov_b32 s77, s57
    s_mov_b32 s78, 0x100
    s_mov_b32 s79, 0x00020000
    s_add_u32 s72, s58, 0x1800000
    s_addc_u32 s73, s59, 0
    s_mov_b32 s74, 0x100000
    s_mov_b32 s75, 0x00020000
    s_waitcnt vmcnt(6)
    s_barrier
    ds_read_b64_tr_b16 v[56:57], v14 offset:0
    ds_read_b64_tr_b16 v[58:59], v14 offset:2560
    ds_read_b128 v[96:99], v18 offset:0
    ds_read_b64_tr_b16 v[60:61], v15 offset:64
    ds_read_b64_tr_b16 v[62:63], v15 offset:2624
    ds_read_b64_tr_b16 v[64:65], v14 offset:128
    ds_read_b64_tr_b16 v[66:67], v14 offset:2688
    ds_read_b64_tr_b16 v[68:69], v15 offset:192
    ds_read_b64_tr_b16 v[70:71], v15 offset:2752
    ds_read_b64_tr_b16 v[72:73], v14 offset:256
    ds_read_b64_tr_b16 v[74:75], v14 offset:2816
    s_mov_b32 s23, 3
    s_setprio 1
k1_v_loop1:
    s_waitcnt lgkmcnt(8)
    v_mfma_f32_32x32x16_bf16 v[108:123], v[96:99], v[56:59], v[108:123]
    ds_read_b64_tr_b16 v[76:77], v14 offset:10240
    ds_read_b64_tr_b16 v[78:79], v14 offset:12800
    ds_read_b128 v[100:103], v19 offset:0
    s_waitcnt lgkmcnt(9)
    v_mfma_f32_32x32x16_bf16 v[124:139], v[96:99], v[60:63], v[124:139]
    ds_read_b64_tr_b16 v[80:81], v15 offset:10304
    ds_read_b64_tr_b16 v[82:83], v15 offset:12864
    s_add_u32 m0, s28, 24576
    s_nop 0
    buffer_load_dwordx4 v13, s[8:11], s25 offen lds
    s_waitcnt lgkmcnt(9)
    v_mfma_f32_32x32x16_bf16 v[140:155], v[96:99], v[64:67], v[140:155]
    ds_read_b64_tr_b16 v[84:85], v14 offset:10368
    ds_read_b64_tr_b16 v[86:87], v14 offset:12928
    s_add_u32 m0, s27, 61440
    s_add_u32 s25, s25, 64
    buffer_load_dwordx4 v10, s[12:15], s24 offen lds
    s_waitcnt lgkmcnt(9)
    v_mfma_f32_32x32x16_bf16 v[156:171], v[96:99], v[68:71], v[156:171]
    ds_read_b64_tr_b16 v[88:89], v15 offset:10432
    ds_read_b64_tr_b16 v[90:91], v15 offset:12992
    buffer_load_dwordx4 v11, s[12:15], s24 offen offset:1024 lds
    s_add_u32 s24, s24, 122880
    s_cmp_eq_u32 s25, 1280
    s_cselect_b32 s25, 0, s25
    s_cselect_b32 s24, 0, s24
    s_waitcnt lgkmcnt(9)
    v_mfma_f32_32x32x16_bf16 v[172:187], v[96:99], v[72:75], v[172:187]
    ds_read_b64_tr_b16 v[92:93], v14 offset:10496
    ds_read_b64_tr_b16 v[94:95], v14 offset:13056
    s_cmp_eq_u32 s23, s60
    s_cbranch_scc1 k1cs_33
k1cs_33_back:
    s_waitcnt vmcnt(6)
    s_barrier
    s_waitcnt lgkmcnt(8)
    v_mfma_f32_32x32x16_bf16 v[108:123], v[100:103], v[76:79], v[108:123]
    ds_read_b64_tr_b16 v[56:57], v14 offset:20480
    ds_read_b64_tr_b16 v[58:59], v14 offset:23040
    ds_read_b128 v[96:99], v18 offset:8192
    s_waitcnt lgkmcnt(9)
    v_mfma_f32_32x32x16_bf16 v[124:139], v[100:103], v[80:83], v[124:139]
    ds_read_b64_tr_b16 v[60:61], v15 offset:20544
    ds_read_b64_tr_b16 v[62:63], v15 offset:23104
    s_waitcnt lgkmcnt(9)
    v_mfma_f32_32x32x16_bf16 v[140:155], v[100:103], v[84:87], v[140:155]
    ds_read_b64_tr_b16 v[64:65], v14 offset:20608
    ds_read_b64_tr_b16 v[66:67], v14 offset:23168
    s_waitcnt lgkmcnt(9)
    v_mfma_f32_32x32x16_bf16 v[156:171], v[100:103], v[88:91], v[156:171]
    ds_read_b64_tr_b16 v[68:69], v15 offset:20672
    ds_read_b64_tr_b16 v[70:71], v15 offset:23232
    s_waitcnt lgkmcnt(9)
    v_mfma_f32_32x32x16_bf16 v[172:187], v[100:103], v[92:95], v[172:187]
    ds_read_b64_tr_b16 v[72:73], v14 offset:20736
    ds_read_b64_tr_b16 v[74:75], v14 offset:23296
    s_waitcnt lgkmcnt(8)
    v_mfma_f32_32x32x16_bf16 v[108:123], v[96:99], v[56:59], v[108:123]
    ds_read_b64_tr_b16 v[76:77], v14 offset:30720
    ds_read_b64_tr_b16 v[78:79], v14 offset:33280
    ds_read_b128 v[100:103], v19 offset:8192
    s_waitcnt lgkmcnt(9)
    v_mfma_f32_32x32x16_bf16 v[124:139], v[96:99], v[60:63], v[124:139]
    ds_read_b64_tr_b16 v[80:81], v15 offset:30784
    ds_read_b64_tr_b16 v[82:83], v15 offset:33344
    s_add_u32 m0, s28, 32768
    s_nop 0
    buffer_load_dwordx4 v13, s[8:11], s25 offen lds
    s_waitcnt lgkmcnt(9)
    v_mfma_f32_32x32x16_bf16 v[140:155], v[96:99], v[64:67], v[140:155]
    ds_read_b64_tr_b16 v[84:85], v14 offset:30848
    ds_read_b64_tr_b16 v[86:87], v14 offset:33408
    s_add_u32 m0, s27, 81920
    s_add_u32 s25, s25, 64
    buffer_load_dwordx4 v10, s[12:15], s24 offen lds
    s_waitcnt lgkmcnt(9)
    v_mfma_f32_32x32x16_bf16 v[156:171], v[96:99], v[68:71], v[156:171]
    ds_read_b64_tr_b16 v[88:89], v15 offset:30912
    ds_read_b64_tr_b16 v[90:91], v15 offset:33472
    buffer_load_dwordx4 v11, s[12:15], s24 offen offset:1024 lds
    s_add_u32 s24, s24, 122880
    s_cmp_eq_u32 s25, 1280
    s_cselect_b32 s25, 0, s25
    s_cselect_b32 s24, 0, s24
    s_waitcnt lgkmcnt(9)
    v_mfma_f32_32x32x16_bf16 v[172:187], v[96:99], v[72:75], v[172:187]
    ds_read_b64_tr_b16 v[92:93], v14 offset:30976
    ds_read_b64_tr_b16 v[94:95], v14 offset:33536
    s_cmp_eq_u32 s23, s61
    s_cbranch_scc1 k1cs_34
k1cs_34_back:
    s_waitcnt vmcnt(6)
    s_barrier
    s_waitcnt lgkmcnt(8)
    v_mfma_f32_32x32x16_bf16 v[108:123], v[100:103], v[76:79], v[108:123]
    ds_read_b64_tr_b16 v[56:57], v14 offset:40960
    ds_read_b64_tr_b16 v[58:59], v14 offset:43520
    ds_read_b128 v[96:99], v18 offset:16384
    s_waitcnt lgkmcnt(9)
    v_mfma_f32_32x32x16_bf16 v[124:139], v[100:103], v[80:83], v[124:139]
    ds_read_b64_tr_b16 v[60:61], v15 offset:41024
    ds_read_b64_tr_b16 v[62:63], v15 offset:43584
    s_waitcnt lgkmcnt(9)
    v_mfma_f32_32x32x16_bf16 v[140:155], v[100:103], v[84:87], v[140:155]
    ds_read_b64_tr_b16 v[64:65], v14 offset:41088
    ds_read_b64_tr_b16 v[66:67], v14 offset:43648
    s_waitcnt lgkmcnt(9)
    v_mfma_f32_32x32x16_bf16 v[156:171], v[100:103], v[88:91], v[156:171]
    ds_read_b64_tr_b16 v[68:69], v15 offset:41152
    ds_read_b64_tr_b16 v[70:71], v15 offset:43712
    s_waitcnt lgkmcnt(9)
    v_mfma_f32_32x32x16_bf16 v[172:187], v[100:103], v[92:95], v[172:187]
    ds_read_b64_tr_b16 v[72:73], v14 offset:41216
    ds_read_b64_tr_b16 v[74:75], v14 offset:43776
    s_waitcnt lgkmcnt(8)
    v_mfma_f32_32x32x16_bf16 v[108:123], v[96:99], v[56:59], v[108:123]
    ds_read_b64_tr_b16 v[76:77], v14 offset:51200
    ds_read_b64_tr_b16 v[78:79], v14 offset:53760
    ds_read_b128 v[100:103], v19 offset:16384
    s_waitcnt lgkmcnt(9)
    v_mfma_f32_32x32x16_bf16 v[124:139], v[96:99], v[60:63], v[124:139]
    ds_read_b64_tr_b16 v[80:81], v15 offset:51264
    ds_read_b64_tr_b16 v[82:83], v15 offset:53824
    s_add_u32 m0, s28, 0
    s_nop 0
    buffer_load_dwordx4 v13, s[8:11], s25 offen lds
    s_waitcnt lgkmcnt(9)
    v_mfma_f32_32x32x16_bf16 v[140:155], v[96:99], v[64:67], v[140:155]
    ds_read_b64_tr_b16 v[84:85], v14 offset:51328
    ds_read_b64_tr_b16 v[86:87], v14 offset:53888
    s_add_u32 m0, s27, 0
    s_add_u32 s25, s25, 64
    buffer_load_dwordx4 v10, s[12:15], s24 offen lds
    s_waitcnt lgkmcnt(9)
    v_mfma_f32_32x32x16_bf16 v[156:171], v[96:99], v[68:71], v[156:171]
    ds_read_b64_tr_b16 v[88:89], v15 offset:51392
    ds_read_b64_tr_b16 v[90:91], v15 offset:53952
    buffer_load_dwordx4 v11, s[12:15], s24 offen offset:1024 lds
    s_add_u32 s24, s24, 122880
    s_cmp_eq_u32 s25, 1280
    s_cselect_b32 s25, 0, s25
    s_cselect_b32 s24, 0, s24
    s_waitcnt lgkmcnt(9)
    v_mfma_f32_32x32x16_bf16 v[172:187], v[96:99], v[72:75], v[172:187]
    ds_read_b64_tr_b16 v[92:93], v14 offset:51456
    ds_read_b64_tr_b16 v[94:95], v14 offset:54016
    s_cmp_eq_u32 s23, s62
    s_cbranch_scc1 k1cs_35
k1cs_35_back:
    s_cmp_eq_u32 s23, 3
    s_cbranch_scc0 k1nl_36
    buffer_load_dword v22, off, s[76:79], 0 sc1
k1nl_36:
    s_waitcnt vmcnt(6)
    s_barrier
    s_waitcnt lgkmcnt(8)
    v_mfma_f32_32x32x16_bf16 v[108:123], v[100:103], v[76:79], v[108:123]
    ds_read_b64_tr_b16 v[56:57], v16 offset:0
    ds_read_b64_tr_b16 v[58:59], v16 offset:2560
    ds_read_b128 v[96:99], v18 offset:24576
    s_waitcnt lgkmcnt(9)
    v_mfma_f32_32x32x16_bf16 v[124:139], v[100:103], v[80:83], v[124:139]
    ds_read_b64_tr_b16 v[60:61], v17 offset:64
    ds_read_b64_tr_b16 v[62:63], v17 offset:2624
    s_waitcnt lgkmcnt(9)
    v_mfma_f32_32x32x16_bf16 v[140:155], v[100:103], v[84:87], v[140:155]
    ds_read_b64_tr_b16 v[64:65], v16 offset:128
    ds_read_b64_tr_b16 v[66:67], v16 offset:2688
    s_waitcnt lgkmcnt(9)
    v_mfma_f32_32x32x16_bf16 v[156:171], v[100:103], v[88:91], v[156:171]
    ds_read_b64_tr_b16 v[68:69], v17 offset:192
    ds_read_b64_tr_b16 v[70:71], v17 offset:2752
    s_waitcnt lgkmcnt(9)
    v_mfma_f32_32x32x16_bf16 v[172:187], v[100:103], v[92:95], v[172:187]
    ds_read_b64_tr_b16 v[72:73], v16 offset:256
    ds_read_b64_tr_b16 v[74:75], v16 offset:2816
    s_waitcnt lgkmcnt(8)
    v_mfma_f32_32x32x16_bf16 v[108:123], v[96:99], v[56:59], v[108:123]
    ds_read_b64_tr_b16 v[76:77], v16 offset:10240
    ds_read_b64_tr_b16 v[78:79], v16 offset:12800
    ds_read_b128 v[100:103], v19 offset:24576
    s_waitcnt lgkmcnt(9)
    v_mfma_f32_32x32x16_bf16 v[124:139], v[96:99], v[60:63], v[124:139]
    ds_read_b64_tr_b16 v[80:81], v17 offset:10304
    ds_read_b64_tr_b16 v[82:83], v17 offset:12864
    s_add_u32 m0, s28, 8192
    s_nop 0
    buffer_load_dwordx4 v13, s[8:11], s25 offen lds
    s_waitcnt lgkmcnt(9)
    v_mfma_f32_32x32x16_bf16 v[140:155], v[96:99], v[64:67], v[140:155]
    ds_read_b64_tr_b16 v[84:85], v16 offset:10368
    ds_read_b64_tr_b16 v[86:87], v16 offset:12928
    s_add_u32 m0, s27, 20480
    s_add_u32 s25, s25, 64
    buffer_load_dwordx4 v10, s[12:15], s24 offen lds
    s_waitcnt lgkmcnt(9)
    v_mfma_f32_32x32x16_bf16 v[156:171], v[96:99], v[68:71], v[156:171]
    ds_read_b64_tr_b16 v[88:89], v17 offset:10432
    ds_read_b64_tr_b16 v[90:91], v17 offset:12992
    buffer_load_dwordx4 v11, s[12:15], s24 offen offset:1024 lds
    s_add_u32 s24, s24, 122880
    s_cmp_eq_u32 s25, 1280
    s_cselect_b32 s25, 0, s25
    s_cselect_b32 s24, 0, s24
    s_waitcnt lgkmcnt(9)
    v_mfma_f32_32x32x16_bf16 v[172:187], v[96:99], v[72:75], v[172:187]
    ds_read_b64_tr_b16 v[92:93], v16 offset:10496
    ds_read_b64_tr_b16 v[94:95], v16 offset:13056
    s_cmp_eq_u32 s23, s63
    s_cbranch_scc1 k1cs_37
k1cs_37_back:
    s_waitcnt vmcnt(6)
    s_barrier
    s_waitcnt lgkmcnt(8)
    v_mfma_f32_32x32x16_bf16 v[108:123], v[100:103], v[76:79], v[108:123]
    ds_read_b64_tr_b16 v[56:57], v16 offset:20480
    ds_read_b64_tr_b16 v[58:59], v16 offset:23040
    ds_read_b128 v[96:99], v18 offset:32768
    s_waitcnt lgkmcnt(9)
    v_mfma_f32_32x32x16_bf16 v[124:139], v[100:103], v[80:83], v[124:139]
    ds_read_b64_tr_b16 v[60:61], v17 offset:20544
    ds_read_b64_tr_b16 v[62:63], v17 offset:23104
    s_waitcnt lgkmcnt(9)
    v_mfma_f32_32x32x16_bf16 v[140:155], v[100:103], v[84:87], v[140:155]
    ds_read_b64_tr_b16 v[64:65], v16 offset:20608
    ds_read_b64_tr_b16 v[66:67], v16 offset:23168
    s_waitcnt lgkmcnt(9)
    v_mfma_f32_32x32x16_bf16 v[156:171], v[100:103], v[88:91], v[156:171]
    ds_read_b64_tr_b16 v[68:69], v17 offset:20672
    ds_read_b64_tr_b16 v[70:71], v17 offset:23232
    s_waitcnt lgkmcnt(9)
    v_mfma_f32_32x32x16_bf16 v[172:187], v[100:103], v[92:95], v[172:187]
    ds_read_b64_tr_b16 v[72:73], v16 offset:20736
    ds_read_b64_tr_b16 v[74:75], v16 offset:23296
    s_waitcnt lgkmcnt(8)
    v_mfma_f32_32x32x16_bf16 v[108:123], v[96:99], v[56:59], v[108:123]
    ds_read_b64_tr_b16 v[76:77], v16 offset:30720
    ds_read_b64_tr_b16 v[78:79], v16 offset:33280
    ds_read_b128 v[100:103], v19 offset:32768
    s_waitcnt lgkmcnt(9)
    v_mfma_f32_32x32x16_bf16 v[124:139], v[96:99], v[60:63], v[124:139]
    ds_read_b64_tr_b16 v[80:81], v17 offset:30784
    ds_read_b64_tr_b16 v[82:83], v17 offset:33344
    s_add_u32 m0, s28, 16384
    s_nop 0
    buffer_load_dwordx4 v13, s[8:11], s25 offen lds
    s_waitcnt lgkmcnt(9)
    v_mfma_f32_32x32x16_bf16 v[140:155], v[96:99], v[64:67], v[140:155]
    ds_read_b64_tr_b16 v[84:85], v16 offset:30848
    ds_read_b64_tr_b16 v[86:87], v16 offset:33408
    s_add_u32 m0, s27, 40960
    s_add_u32 s25, s25, 64
    buffer_load_dwordx4 v10, s[12:15], s24 offen lds
    s_waitcnt lgkmcnt(9)
    v_mfma_f32_32x32x16_bf16 v[156:171], v[96:99], v[68:71], v[156:171]
    ds_read_b64_tr_b16 v[88:89], v17 offset:30912
    ds_read_b64_tr_b16 v[90:91], v17 offset:33472
    buffer_load_dwordx4 v11, s[12:15], s24 offen offset:1024 lds
    s_add_u32 s24, s24, 122880
    s_cmp_eq_u32 s25, 1280
    s_cselect_b32 s25, 0, s25
    s_cselect_b32 s24, 0, s24
    s_waitcnt lgkmcnt(9)
    v_mfma_f32_32x32x16_bf16 v[172:187], v[96:99], v[72:75], v[172:187]
    ds_read_b64_tr_b16 v[92:93], v16 offset:30976
    ds_read_b64_tr_b16 v[94:95], v16 offset:33536
    s_cmp_eq_u32 s23, s64
    s_cbranch_scc1 k1cs_38
k1cs_38_back:
    s_waitcnt vmcnt(6)
    s_barrier
    s_cmp_eq_u32 s23, 3
    s_cbranch_scc1 k1pub_39
k1pub_39_back:
    s_waitcnt lgkmcnt(8)
    v_mfma_f32_32x32x16_bf16 v[108:123], v[100:103], v[76:79], v[108:123]
    ds_read_b64_tr_b16 v[56:57], v14 offset:0
    ds_read_b64_tr_b16 v[58:59], v14 offset:2560
    ds_read_b128 v[96:99], v18 offset:0
    s_waitcnt lgkmcnt(9)
    v_mfma_f32_32x32x16_bf16 v[124:139], v[100:103], v[80:83], v[124:139]
    ds_read_b64_tr_b16 v[60:61], v15 offset:64
    ds_read_b64_tr_b16 v[62:63], v15 offset:2624
    s_waitcnt lgkmcnt(9)
    v_mfma_f32_32x32x16_bf16 v[140:155], v[100:103], v[84:87], v[140:155]
    ds_read_b64_tr_b16 v[64:65], v14 offset:128
    ds_read_b64_tr_b16 v[66:67], v14 offset:2688
    s_waitcnt lgkmcnt(9)
    v_mfma_f32_32x32x16_bf16 v[156:171], v[100:103], v[88:91], v[156:171]
    ds_read_b64_tr_b16 v[68:69], v15 offset:192
    ds_read_b64_tr_b16 v[70:71], v15 offset:2752
    s_waitcnt lgkmcnt(9)
    v_mfma_f32_32x32x16_bf16 v[172:187], v[100:103], v[92:95], v[172:187]
    ds_read_b64_tr_b16 v[72:73], v14 offset:256
    ds_read_b64_tr_b16 v[74:75], v14 offset:2816
    s_sub_u32 s23, s23, 1
    s_cmp_lg_u32 s23, 0
    s_cbranch_scc1 k1_v_loop1
    s_waitcnt lgkmcnt(8)
    v_mfma_f32_32x32x16_bf16 v[108:123], v[96:99], v[56:59], v[108:123]
    ds_read_b64_tr_b16 v[76:77], v14 offset:10240
    ds_read_b64_tr_b16 v[78:79], v14 offset:12800
    ds_read_b128 v[100:103], v19 offset:0
    s_waitcnt lgkmcnt(9)
    v_mfma_f32_32x32x16_bf16 v[124:139], v[96:99], v[60:63], v[124:139]
    ds_read_b64_tr_b16 v[80:81], v15 offset:10304
    ds_read_b64_tr_b16 v[82:83], v15 offset:12864
    s_add_u32 m0, s28, 24576
    s_nop 0
    buffer_load_dwordx4 v13, s[8:11], s25 offen lds
    s_waitcnt lgkmcnt(9)
    v_mfma_f32_32x32x16_bf16 v[140:155], v[96:99], v[64:67], v[140:155]
    ds_read_b64_tr_b16 v[84:85], v14 offset:10368
    ds_read_b64_tr_b16 v[86:87], v14 offset:12928
    s_add_u32 m0, s27, 61440
    s_add_u32 s25, s25, 64
    buffer_load_dwordx4 v10, s[12:15], s24 offen lds
    s_waitcnt lgkmcnt(9)
    v_mfma_f32_32x32x16_bf16 v[156:171], v[96:99], v[68:71], v[156:171]
    ds_read_b64_tr_b16 v[88:89], v15 offset:10432
    ds_read_b64_tr_b16 v[90:91], v15 offset:12992
    buffer_load_dwordx4 v11, s[12:15], s24 offen offset:1024 lds
    s_add_u32 s24, s24, 122880
    s_cmp_eq_u32 s25, 1280
    s_cselect_b32 s25, 0, s25
    s_cselect_b32 s24, 0, s24
    s_waitcnt lgkmcnt(9)
    v_mfma_f32_32x32x16_bf16 v[172:187], v[96:99], v[72:75], v[172:187]
    ds_read_b64_tr_b16 v[92:93], v14 offset:10496
    ds_read_b64_tr_b16 v[94:95], v14 offset:13056
    s_waitcnt vmcnt(6)
    s_barrier
    s_waitcnt lgkmcnt(8)
    v_mfma_f32_32x32x16_bf16 v[108:123], v[100:103], v[76:79], v[108:123]
    ds_read_b64_tr_b16 v[56:57], v14 offset:20480
    ds_read_b64_tr_b16 v[58:59], v14 offset:23040
    ds_read_b128 v[96:99], v18 offset:8192
    s_waitcnt lgkmcnt(9)
    v_mfma_f32_32x32x16_bf16 v[124:139], v[100:103], v[80:83], v[124:139]
    ds_read_b64_tr_b16 v[60:61], v15 offset:20544
    ds_read_b64_tr_b16 v[62:63], v15 offset:23104
    s_waitcnt lgkmcnt(9)
    v_mfma_f32_32x32x16_bf16 v[140:155], v[100:103], v[84:87], v[140:155]
    ds_read_b64_tr_b16 v[64:65], v14 offset:20608
    ds_read_b64_tr_b16 v[66:67], v14 offset:23168
    s_waitcnt lgkmcnt(9)
    v_mfma_f32_32x32x16_bf16 v[156:171], v[100:103], v[88:91], v[156:171]
    ds_read_b64_tr_b16 v[68:69], v15 offset:20672
    ds_read_b64_tr_b16 v[70:71], v15 offset:23232
    s_waitcnt lgkmcnt(9)
    v_mfma_f32_32x32x16_bf16 v[172:187], v[100:103], v[92:95], v[172:187]
    ds_read_b64_tr_b16 v[72:73], v14 offset:20736
    ds_read_b64_tr_b16 v[74:75], v14 offset:23296
    s_waitcnt lgkmcnt(8)
    v_mfma_f32_32x32x16_bf16 v[108:123], v[96:99], v[56:59], v[108:123]
    ds_read_b64_tr_b16 v[76:77], v14 offset:30720
    ds_read_b64_tr_b16 v[78:79], v14 offset:33280
    ds_read_b128 v[100:103], v19 offset:8192
    s_waitcnt lgkmcnt(9)
    v_mfma_f32_32x32x16_bf16 v[124:139], v[96:99], v[60:63], v[124:139]
    ds_read_b64_tr_b16 v[80:81], v15 offset:30784
    ds_read_b64_tr_b16 v[82:83], v15 offset:33344
    s_add_u32 m0, s28, 32768
    s_nop 0
    buffer_load_dwordx4 v13, s[8:11], s25 offen lds
    s_waitcnt lgkmcnt(9)
    v_mfma_f32_32x32x16_bf16 v[140:155], v[96:99], v[64:67], v[140:155]
    ds_read_b64_tr_b16 v[84:85], v14 offset:30848
    ds_read_b64_tr_b16 v[86:87], v14 offset:33408
    s_add_u32 m0, s27, 81920
    s_add_u32 s25, s25, 64
    buffer_load_dwordx4 v10, s[12:15], s24 offen lds
    s_waitcnt lgkmcnt(9)
    v_mfma_f32_32x32x16_bf16 v[156:171], v[96:99], v[68:71], v[156:171]
    ds_read_b64_tr_b16 v[88:89], v15 offset:30912
    ds_read_b64_tr_b16 v[90:91], v15 offset:33472
    buffer_load_dwordx4 v11, s[12:15], s24 offen offset:1024 lds
    s_add_u32 s24, s24, 122880
    s_cmp_eq_u32 s25, 1280
    s_cselect_b32 s25, 0, s25
    s_cselect_b32 s24, 0, s24
    s_waitcnt lgkmcnt(9)
    v_mfma_f32_32x32x16_bf16 v[172:187], v[96:99], v[72:75], v[172:187]
    ds_read_b64_tr_b16 v[92:93], v14 offset:30976
    ds_read_b64_tr_b16 v[94:95], v14 offset:33536
    s_waitcnt vmcnt(6)
    s_barrier
    s_waitcnt lgkmcnt(8)
    v_mfma_f32_32x32x16_bf16 v[108:123], v[100:103], v[76:79], v[108:123]
    ds_read_b64_tr_b16 v[56:57], v14 offset:40960
    ds_read_b64_tr_b16 v[58:59], v14 offset:43520
    ds_read_b128 v[96:99], v18 offset:16384
    s_waitcnt lgkmcnt(9)
    v_mfma_f32_32x32x16_bf16 v[124:139], v[100:103], v[80:83], v[124:139]
    ds_read_b64_tr_b16 v[60:61], v15 offset:41024
    ds_read_b64_tr_b16 v[62:63], v15 offset:43584
    s_waitcnt lgkmcnt(9)
    v_mfma_f32_32x32x16_bf16 v[140:155], v[100:103], v[84:87], v[140:155]
    ds_read_b64_tr_b16 v[64:65], v14 offset:41088
    ds_read_b64_tr_b16 v[66:67], v14 offset:43648
    s_waitcnt lgkmcnt(9)
    v_mfma_f32_32x32x16_bf16 v[156:171], v[100:103], v[88:91], v[156:171]
    ds_read_b64_tr_b16 v[68:69], v15 offset:41152
    ds_read_b64_tr_b16 v[70:71], v15 offset:43712
    s_waitcnt lgkmcnt(9)
    v_mfma_f32_32x32x16_bf16 v[172:187], v[100:103], v[92:95], v[172:187]
    ds_read_b64_tr_b16 v[72:73], v14 offset:41216
    ds_read_b64_tr_b16 v[74:75], v14 offset:43776
    s_waitcnt lgkmcnt(8)
    v_mfma_f32_32x32x16_bf16 v[108:123], v[96:99], v[56:59], v[108:123]
    ds_read_b64_tr_b16 v[76:77], v14 offset:51200
    ds_read_b64_tr_b16 v[78:79], v14 offset:53760
    ds_read_b128 v[100:103], v19 offset:16384
    s_waitcnt lgkmcnt(9)
    v_mfma_f32_32x32x16_bf16 v[124:139], v[96:99], v[60:63], v[124:139]
    ds_read_b64_tr_b16 v[80:81], v15 offset:51264
    ds_read_b64_tr_b16 v[82:83], v15 offset:53824
    s_waitcnt lgkmcnt(9)
    v_mfma_f32_32x32x16_bf16 v[140:155], v[96:99], v[64:67], v[140:155]
    ds_read_b64_tr_b16 v[84:85], v14 offset:51328
    ds_read_b64_tr_b16 v[86:87], v14 offset:53888
    s_waitcnt lgkmcnt(9)
    v_mfma_f32_32x32x16_bf16 v[156:171], v[96:99], v[68:71], v[156:171]
    ds_read_b64_tr_b16 v[88:89], v15 offset:51392
    ds_read_b64_tr_b16 v[90:91], v15 offset:53952
    s_waitcnt lgkmcnt(9)
    v_mfma_f32_32x32x16_bf16 v[172:187], v[96:99], v[72:75], v[172:187]
    ds_read_b64_tr_b16 v[92:93], v14 offset:51456
    ds_read_b64_tr_b16 v[94:95], v14 offset:54016
    s_waitcnt vmcnt(3)
    s_barrier
    s_waitcnt lgkmcnt(8)
    v_mfma_f32_32x32x16_bf16 v[108:123], v[100:103], v[76:79], v[108:123]
    ds_read_b64_tr_b16 v[56:57], v16 offset:0
    ds_read_b64_tr_b16 v[58:59], v16 offset:2560
    ds_read_b128 v[96:99], v18 offset:24576
    s_waitcnt lgkmcnt(9)
    v_mfma_f32_32x32x16_bf16 v[124:139], v[100:103], v[80:83], v[124:139]
    ds_read_b64_tr_b16 v[60:61], v17 offset:64
    ds_read_b64_tr_b16 v[62:63], v17 offset:2624
    s_waitcnt lgkmcnt(9)
    v_mfma_f32_32x32x16_bf16 v[140:155], v[100:103], v[84:87], v[140:155]
    ds_read_b64_tr_b16 v[64:65], v16 offset:128
    ds_read_b64_tr_b16 v[66:67], v16 offset:2688
    s_waitcnt lgkmcnt(9)
    v_mfma_f32_32x32x16_bf16 v[156:171], v[100:103], v[88:91], v[156:171]
    ds_read_b64_tr_b16 v[68:69], v17 offset:192
    ds_read_b64_tr_b16 v[70:71], v17 offset:2752
    s_waitcnt lgkmcnt(9)
    v_mfma_f32_32x32x16_bf16 v[172:187], v[100:103], v[92:95], v[172:187]
    ds_read_b64_tr_b16 v[72:73], v16 offset:256
    ds_read_b64_tr_b16 v[74:75], v16 offset:2816
    s_waitcnt lgkmcnt(8)
    v_mfma_f32_32x32x16_bf16 v[108:123], v[96:99], v[56:59], v[108:123]
    ds_read_b64_tr_b16 v[76:77], v16 offset:10240
    ds_read_b64_tr_b16 v[78:79], v16 offset:12800
    ds_read_b128 v[100:103], v19 offset:24576
    s_waitcnt lgkmcnt(9)
    v_mfma_f32_32x32x16_bf16 v[124:139], v[96:99], v[60:63], v[124:139]
    ds_read_b64_tr_b16 v[80:81], v17 offset:10304
    ds_read_b64_tr_b16 v[82:83], v17 offset:12864
    s_waitcnt lgkmcnt(9)
    v_mfma_f32_32x32x16_bf16 v[140:155], v[96:99], v[64:67], v[140:155]
    ds_read_b64_tr_b16 v[84:85], v16 offset:10368
    ds_read_b64_tr_b16 v[86:87], v16 offset:12928
    s_waitcnt lgkmcnt(9)
    v_mfma_f32_32x32x16_bf16 v[156:171], v[96:99], v[68:71], v[156:171]
    ds_read_b64_tr_b16 v[88:89], v17 offset:10432
    ds_read_b64_tr_b16 v[90:91], v17 offset:12992
    s_waitcnt lgkmcnt(9)
    v_mfma_f32_32x32x16_bf16 v[172:187], v[96:99], v[72:75], v[172:187]
    ds_read_b64_tr_b16 v[92:93], v16 offset:10496
    ds_read_b64_tr_b16 v[94:95], v16 offset:13056
    v_lshlrev_b32 v3, 1, v23
    v_lshlrev_b32 v4, 2, v24
    s_mul_i32 s4, s21, 3072
    s_lshl_b32 s5, s20, 11
    s_add_u32 s5, s5, 65536
    buffer_load_dwordx2 v[20:21], v3, s[72:75], s4 offen sc1
    buffer_load_dwordx4 v[28:31], v4, s[72:75], s5 offen sc1
    s_waitcnt vmcnt(2)
    s_barrier
    s_waitcnt lgkmcnt(8)
    v_mfma_f32_32x32x16_bf16 v[108:123], v[100:103], v[76:79], v[108:123]
    ds_read_b64_tr_b16 v[56:57], v16 offset:20480
    ds_read_b64_tr_b16 v[58:59], v16 offset:23040
    ds_read_b128 v[96:99], v18 offset:32768
    s_waitcnt lgkmcnt(9)
    v_mfma_f32_32x32x16_bf16 v[124:139], v[100:103], v[80:83], v[124:139]
    ds_read_b64_tr_b16 v[60:61], v17 offset:20544
    ds_read_b64_tr_b16 v[62:63], v17 offset:23104
    s_waitcnt lgkmcnt(9)
    v_mfma_f32_32x32x16_bf16 v[140:155], v[100:103], v[84:87], v[140:155]
    ds_read_b64_tr_b16 v[64:65], v16 offset:20608
    ds_read_b64_tr_b16 v[66:67], v16 offset:23168
    s_waitcnt lgkmcnt(9)
    v_mfma_f32_32x32x16_bf16 v[156:171], v[100:103], v[88:91], v[156:171]
    ds_read_b64_tr_b16 v[68:69], v17 offset:20672
    ds_read_b64_tr_b16 v[70:71], v17 offset:23232
    s_waitcnt lgkmcnt(9)
    v_mfma_f32_32x32x16_bf16 v[172:187], v[100:103], v[92:95], v[172:187]
    ds_read_b64_tr_b16 v[72:73], v16 offset:20736
    ds_read_b64_tr_b16 v[74:75], v16 offset:23296
    s_waitcnt lgkmcnt(8)
    v_mfma_f32_32x32x16_bf16 v[108:123], v[96:99], v[56:59], v[108:123]
    ds_read_b64_tr_b16 v[76:77], v16 offset:30720
    ds_read_b64_tr_b16 v[78:79], v16 offset:33280
    ds_read_b128 v[100:103], v19 offset:32768
    s_waitcnt lgkmcnt(9)
    v_mfma_f32_32x32x16_bf16 v[124:139], v[96:99], v[60:63], v[124:139]
    ds_read_b64_tr_b16 v[80:81], v17 offset:30784
    ds_read_b64_tr_b16 v[82:83], v17 offset:33344
    s_waitcnt lgkmcnt(9)
    v_mfma_f32_32x32x16_bf16 v[140:155], v[96:99], v[64:67], v[140:155]
    ds_read_b64_tr_b16 v[84:85], v16 offset:30848
    ds_read_b64_tr_b16 v[86:87], v16 offset:33408
    s_waitcnt lgkmcnt(9)
    v_mfma_f32_32x32x16_bf16 v[156:171], v[96:99], v[68:71], v[156:171]
    ds_read_b64_tr_b16 v[88:89], v17 offset:30912
    ds_read_b64_tr_b16 v[90:91], v17 offset:33472
    s_waitcnt lgkmcnt(9)
    v_mfma_f32_32x32x16_bf16 v[172:187], v[96:99], v[72:75], v[172:187]
    ds_read_b64_tr_b16 v[92:93], v16 offset:30976
    ds_read_b64_tr_b16 v[94:95], v16 offset:33536
    s_waitcnt lgkmcnt(8)
    v_mfma_f32_32x32x16_bf16 v[108:123], v[100:103], v[76:79], v[108:123]
    s_waitcnt lgkmcnt(6)
    v_mfma_f32_32x32x16_bf16 v[124:139], v[100:103], v[80:83], v[124:139]
    s_waitcnt lgkmcnt(4)
    v_mfma_f32_32x32x16_bf16 v[140:155], v[100:103], v[84:87], v[140:155]
    s_waitcnt vmcnt(0)
    v_cmp_ne_u32 vcc, s29, v21
    v_cmp_ne_u32 s[6:7], s29, v30
    s_nop 1
    s_or_b64 vcc, vcc, s[6:7]
    s_cbranch_vccnz k1retry_40
k1back_41:
    ds_write_b32 v23, v20 offset:0
    ds_write_b32 v24, v28 offset:1536
    ds_write_b32 v24, v29 offset:2048
    s_waitcnt lgkmcnt(5)
    v_mfma_f32_32x32x16_bf16 v[156:171], v[100:103], v[88:91], v[156:171]
    s_waitcnt lgkmcnt(3)
    v_mfma_f32_32x32x16_bf16 v[172:187], v[100:103], v[92:95], v[172:187]
    s_waitcnt lgkmcnt(0)
    s_barrier
    s_branch k1_v_epi
k1retry_40:
    s_mov_b32 s23, 200000
k1retry_40_l:
    s_sleep 2
    v_lshlrev_b32 v3, 1, v23
    v_lshlrev_b32 v4, 2, v24
    s_mul_i32 s4, s21, 3072
    s_lshl_b32 s5, s20, 11
    s_add_u32 s5, s5, 65536
    buffer_load_dwordx2 v[20:21], v3, s[72:75], s4 offen sc1
    buffer_load_dwordx4 v[28:31], v4, s[72:75], s5 offen sc1
    s_waitcnt vmcnt(0)
    v_cmp_ne_u32 vcc, s29, v21
    v_cmp_ne_u32 s[6:7], s29, v30
    s_nop 1
    s_or_b64 vcc, vcc, s[6:7]
    s_cbranch_vccz k1back_41
    s_sub_u32 s23, s23, 1
    s_cmp_lg_u32 s23, 0
    s_cbranch_scc1 k1retry_40_l
    s_branch k1back_41
k1cs_33:
    s_waitcnt lgkmcnt(0)
    s_bitcmp1_b32 s26, 0
    s_cbranch_scc0 k1cs_33_s0
    v_mfma_f32_16x16x32_bf16 v[36:39], v[32:35], v[56:59], v[36:39]
    v_mfma_f32_16x16x32_bf16 v[36:39], v[32:35], v[76:79], v[36:39]
k1cs_33_s0:
    s_bitcmp1_b32 s26, 1
    s_cbranch_scc0 k1cs_33_s1
    v_mfma_f32_16x16x32_bf16 v[40:43], v[32:35], v[60:63], v[40:43]
    v_mfma_f32_16x16x32_bf16 v[40:43], v[32:35], v[80:83], v[40:43]
k1cs_33_s1:
    s_bitcmp1_b32 s26, 2
    s_cbranch_scc0 k1cs_33_s2
    v_mfma_f32_16x16x32_bf16 v[44:47], v[32:35], v[64:67], v[44:47]
    v_mfma_f32_16x16x32_bf16 v[44:47], v[32:35], v[84:87], v[44:47]
k1cs_33_s2:
    s_bitcmp1_b32 s26, 3
    s_cbranch_scc0 k1cs_33_s3
    v_mfma_f32_16x16x32_bf16 v[48:51], v[32:35], v[68:71], v[48:51]
    v_mfma_f32_16x16x32_bf16 v[48:51], v[32:35], v[88:91], v[48:51]
k1cs_33_s3:
    s_bitcmp1_b32 s26, 4
    s_cbranch_scc0 k1cs_33_s4
    v_mfma_f32_16x16x32_bf16 v[52:55], v[32:35], v[72:75], v[52:55]
    v_mfma_f32_16x16x32_bf16 v[52:55], v[32:35], v[92:95], v[52:55]
k1cs_33_s4:
    s_branch k1cs_33_back
k1cs_34:
    s_waitcnt lgkmcnt(0)
    s_bitcmp1_b32 s26, 0
    s_cbranch_scc0 k1cs_34_s0
    v_mfma_f32_16x16x32_bf16 v[36:39], v[32:35], v[56:59], v[36:39]
    v_mfma_f32_16x16x32_bf16 v[36:39], v[32:35], v[76:79], v[36:39]
k1cs_34_s0:
    s_bitcmp1_b32 s26, 1
    s_cbranch_scc0 k1cs_34_s1
    v_mfma_f32_16x16x32_bf16 v[40:43], v[32:35], v[60:63], v[40:43]
    v_mfma_f32_16x16x32_bf16 v[40:43], v[32:35], v[80:83], v[40:43]
k1cs_34_s1:
    s_bitcmp1_b32 s26, 2
    s_cbranch_scc0 k1cs_34_s2
    v_mfma_f32_16x16x32_bf16 v[44:47], v[32:35], v[64:67], v[44:47]
    v_mfma_f32_16x16x32_bf16 v[44:47], v[32:35], v[84:87], v[44:47]
k1cs_34_s2:
    s_bitcmp1_b32 s26, 3
    s_cbranch_scc0 k1cs_34_s3
    v_mfma_f32_16x16x32_bf16 v[48:51], v[32:35], v[68:71], v[48:51]
    v_mfma_f32_16x16x32_bf16 v[48:51], v[32:35], v[88:91], v[48:51]
k1cs_34_s3:
    s_bitcmp1_b32 s26, 4
    s_cbranch_scc0 k1cs_34_s4
    v_mfma_f32_16x16x32_bf16 v[52:55], v[32:35], v[72:75], v[52:55]
    v_mfma_f32_16x16x32_bf16 v[52:55], v[32:35], v[92:95], v[52:55]
k1cs_34_s4:
    s_branch k1cs_34_back
k1cs_35:
    s_waitcnt lgkmcnt(0)
    s_bitcmp1_b32 s26, 0
    s_cbranch_scc0 k1cs_35_s0
    v_mfma_f32_16x16x32_bf16 v[36:39], v[32:35], v[56:59], v[36:39]
    v_mfma_f32_16x16x32_bf16 v[36:39], v[32:35], v[76:79], v[36:39]
k1cs_35_s0:
    s_bitcmp1_b32 s26, 1
    s_cbranch_scc0 k1cs_35_s1
    v_mfma_f32_16x16x32_bf16 v[40:43], v[32:35], v[60:63], v[40:43]
    v_mfma_f32_16x16x32_bf16 v[40:43], v[32:35], v[80:83], v[40:43]
k1cs_35_s1:
    s_bitcmp1_b32 s26, 2
    s_cbranch_scc0 k1cs_35_s2
    v_mfma_f32_16x16x32_bf16 v[44:47], v[32:35], v[64:67], v[44:47]
    v_mfma_f32_16x16x32_bf16 v[44:47], v[32:35], v[84:87], v[44:47]
k1cs_35_s2:
    s_bitcmp1_b32 s26, 3
    s_cbranch_scc0 k1cs_35_s3
    v_mfma_f32_16x16x32_bf16 v[48:51], v[32:35], v[68:71], v[48:51]
    v_mfma_f32_16x16x32_bf16 v[48:51], v[32:35], v[88:91], v[48:51]
k1cs_35_s3:
    s_bitcmp1_b32 s26, 4
    s_cbranch_scc0 k1cs_35_s4
    v_mfma_f32_16x16x32_bf16 v[52:55], v[32:35], v[72:75], v[52:55]
    v_mfma_f32_16x16x32_bf16 v[52:55], v[32:35], v[92:95], v[52:55]
k1cs_35_s4:
    s_branch k1cs_35_back
k1cs_37:
    s_waitcnt lgkmcnt(0)
    s_bitcmp1_b32 s26, 0
    s_cbranch_scc0 k1cs_37_s0
    v_mfma_f32_16x16x32_bf16 v[36:39], v[32:35], v[56:59], v[36:39]
    v_mfma_f32_16x16x32_bf16 v[36:39], v[32:35], v[76:79], v[36:39]
k1cs_37_s0:
    s_bitcmp1_b32 s26, 1
    s_cbranch_scc0 k1cs_37_s1
    v_mfma_f32_16x16x32_bf16 v[40:43], v[32:35], v[60:63], v[40:43]
    v_mfma_f32_16x16x32_bf16 v[40:43], v[32:35], v[80:83], v[40:43]
k1cs_37_s1:
    s_bitcmp1_b32 s26, 2
    s_cbranch_scc0 k1cs_37_s2
    v_mfma_f32_16x16x32_bf16 v[44:47], v[32:35], v[64:67], v[44:47]
    v_mfma_f32_16x16x32_bf16 v[44:47], v[32:35], v[84:87], v[44:47]
k1cs_37_s2:
    s_bitcmp1_b32 s26, 3
    s_cbranch_scc0 k1cs_37_s3
    v_mfma_f32_16x16x32_bf16 v[48:51], v[32:35], v[68:71], v[48:51]
    v_mfma_f32_16x16x32_bf16 v[48:51], v[32:35], v[88:91], v[48:51]
k1cs_37_s3:
    s_bitcmp1_b32 s26, 4
    s_cbranch_scc0 k1cs_37_s4
    v_mfma_f32_16x16x32_bf16 v[52:55], v[32:35], v[72:75], v[52:55]
    v_mfma_f32_16x16x32_bf16 v[52:55], v[32:35], v[92:95], v[52:55]
k1cs_37_s4:
    s_branch k1cs_37_back
k1cs_38:
    s_waitcnt lgkmcnt(0)
    s_bitcmp1_b32 s26, 0
    s_cbranch_scc0 k1cs_38_s0
    v_mfma_f32_16x16x32_bf16 v[36:39], v[32:35], v[56:59], v[36:39]
    v_mfma_f32_16x16x32_bf16 v[36:39], v[32:35], v[76:79], v[36:39]
k1cs_38_s0:
    s_bitcmp1_b32 s26, 1
    s_cbranch_scc0 k1cs_38_s1
    v_mfma_f32_16x16x32_bf16 v[40:43], v[32:35], v[60:63], v[40:43]
    v_mfma_f32_16x16x32_bf16 v[40:43], v[32:35], v[80:83], v[40:43]
k1cs_38_s1:
    s_bitcmp1_b32 s26, 2
    s_cbranch_scc0 k1cs_38_s2
    v_mfma_f32_16x16x32_bf16 v[44:47], v[32:35], v[64:67], v[44:47]
    v_mfma_f32_16x16x32_bf16 v[44:47], v[32:35], v[84:87], v[44:47]
k1cs_38_s2:
    s_bitcmp1_b32 s26, 3
    s_cbranch_scc0 k1cs_38_s3
    v_mfma_f32_16x16x32_bf16 v[48:51], v[32:35], v[68:71], v[48:51]
    v_mfma_f32_16x16x32_bf16 v[48:51], v[32:35], v[88:91], v[48:51]
k1cs_38_s3:
    s_bitcmp1_b32 s26, 4
    s_cbranch_scc0 k1cs_38_s4
    v_mfma_f32_16x16x32_bf16 v[52:55], v[32:35], v[72:75], v[52:55]
    v_mfma_f32_16x16x32_bf16 v[52:55], v[32:35], v[92:95], v[52:55]
k1cs_38_s4:
    s_branch k1cs_38_back
k1pub_39:
    s_nop 7
    s_mov_b32 s4, 200000
k1pub_39_n:
    v_readfirstlane_b32 s29, v22
    s_cmp_lg_u32 s29, 0
    s_cbranch_scc1 k1pub_39_ok
    s_sleep 2
    buffer_load_dword v22, off, s[76:79], 0 sc1
    s_waitcnt vmcnt(0)
    s_sub_u32 s4, s4, 1
    s_cmp_lg_u32 s4, 0
    s_cbranch_scc1 k1pub_39_n
k1pub_39_ok:
    s_mov_b64 exec, 0xffff
    s_bitcmp1_b32 s26, 0
    s_cbranch_scc0 k1pub_39_s0
    v_mov_b32 v38, s29
    v_mov_b32 v39, s29
    buffer_store_dwordx4 v[36:39], v25, s[72:75], s30 offen offset:0 sc1
k1pub_39_s0:
    s_bitcmp1_b32 s26, 1
    s_cbranch_scc0 k1pub_39_s1
    v_mov_b32 v42, s29
    v_mov_b32 v43, s29
    buffer_store_dwordx4 v[40:43], v25, s[72:75], s30 offen offset:256 sc1
k1pub_39_s1:
    s_bitcmp1_b32 s26, 2
    s_cbranch_scc0 k1pub_39_s2
    v_mov_b32 v46, s29
    v_mov_b32 v47, s29
    buffer_store_dwordx4 v[44:47], v25, s[72:75], s30 offen offset:512 sc1
k1pub_39_s2:
    s_bitcmp1_b32 s26, 3
    s_cbranch_scc0 k1pub_39_s3
    v_mov_b32 v50, s29
    v_mov_b32 v51, s29
    buffer_store_dwordx4 v[48:51], v25, s[72:75], s30 offen offset:768 sc1
k1pub_39_s3:
    s_bitcmp1_b32 s26, 4
    s_cbranch_scc0 k1pub_39_s4
    v_mov_b32 v54, s29
    v_mov_b32 v55, s29
    buffer_store_dwordx4 v[52:55], v25, s[72:75], s30 offen offset:1024 sc1
k1pub_39_s4:
    s_mov_b64 exec, -1
    s_branch k1pub_39_back
k1_v_epi:
    s_setprio 0
    v_and_b32 v2, 31, v1
    s_lshl_b32 s4, s36, 5
    v_add_u32 v2, s4, v2
    v_lshlrev_b32 v2, 2, v2
    v_lshrrev_b32 v4, 5, v1
    s_mul_i32 s4, s37, 640
    v_lshlrev_b32 v5, 4, v4
    v_add_u32 v5, s4, v5
    s_add_u32 s16, s58, 0x1000000
    s_addc_u32 s17, s59, 0
    s_mov_b32 s18, 0x280000
    s_mov_b32 s19, 0x00020000
    s_lshl_b32 s4, s36, 7
    v_lshlrev_b32 v6, 4, v4
    v_add_u32 v6, s4, v6
    ds_read_b128 v[56:59], v6 offset:1536
    ds_read_b128 v[72:75], v6 offset:2048
    ds_read_b128 v[60:63], v6 offset:1568
    ds_read_b128 v[76:79], v6 offset:2080
    ds_read_b128 v[64:67], v6 offset:1600
    ds_read_b128 v[80:83], v6 offset:2112
    ds_read_b128 v[68:71], v6 offset:1632
    ds_read_b128 v[84:87], v6 offset:2144
    v_and_b32 v3, 31, v1
    s_mul_i32 s4, s37, 160
    v_add_u32 v3, s4, v3
    v_lshlrev_b32 v3, 2, v3
    ds_read_b32 v190, v3 offset:0
    ds_read_b32 v191, v3 offset:128
    ds_read_b32 v192, v3 offset:256
    ds_read_b32 v193, v3 offset:384
    ds_read_b32 v194, v3 offset:512
    s_sub_u32 s4, s21, 4
    s_lshl_b32 s4, s4, 4
    s_lshl_b32 s5, s37, 3
    s_add_u32 s4, s4, s5
    s_lshl_b32 s4, s4, 6
    s_lshl_b32 s5, s20, 2
    s_add_u32 s4, s4, s5
    s_add_u32 s4, s4, s36
    s_mul_i32 s4, s4, 1280
    s_mov_b32 s5, 3277
    s_mov_b32 s6, 81920
    v_and_b32 v7, 31, v1
    v_add_u32 v7, 0, v7
    v_mul_lo_u32 v8, v7, s5
    v_lshrrev_b32 v8, 16, v8
    v_mul_u32_u24 v9, 20, v8
    v_sub_u32 v7, v7, v9
    v_mul_lo_u32 v8, v8, s6
    v_lshl_add_u32 v8, v7, 4, v8
    v_mul_u32_u24 v9, 320, v4
    v_add3_u32 v195, v8, v9, s4
    v_and_b32 v7, 31, v1
    v_add_u32 v7, 32, v7
    v_mul_lo_u32 v8, v7, s5
    v_lshrrev_b32 v8, 16, v8
    v_mul_u32_u24 v9, 20, v8
    v_sub_u32 v7, v7, v9
    v_mul_lo_u32 v8, v8, s6
    v_lshl_add_u32 v8, v7, 4, v8
    v_mul_u32_u24 v9, 320, v4
    v_add3_u32 v196, v8, v9, s4
    v_and_b32 v7, 31, v1
    v_add_u32 v7, 64, v7
    v_mul_lo_u32 v8, v7, s5
    v_lshrrev_b32 v8, 16, v8
    v_mul_u32_u24 v9, 20, v8
    v_sub_u32 v7, v7, v9
    v_mul_lo_u32 v8, v8, s6
    v_lshl_add_u32 v8, v7, 4, v8
    v_mul_u32_u24 v9, 320, v4
    v_add3_u32 v197, v8, v9, s4
    v_and_b32 v7, 31, v1
    v_add_u32 v7, 96, v7
    v_mul_lo_u32 v8, v7, s5
    v_lshrrev_b32 v8, 16, v8
    v_mul_u32_u24 v9, 20, v8
    v_sub_u32 v7, v7, v9
    v_mul_lo_u32 v8, v8, s6
    v_lshl_add_u32 v8, v7, 4, v8
    v_mul_u32_u24 v9, 320, v4
    v_add3_u32 v198, v8, v9, s4
    v_and_b32 v7, 31, v1
    v_add_u32 v7, 128, v7
    v_mul_lo_u32 v8, v7, s5
    v_lshrrev_b32 v8, 16, v8
    v_mul_u32_u24 v9, 20, v8
    v_sub_u32 v7, v7, v9
    v_mul_lo_u32 v8, v8, s6
    v_lshl_add_u32 v8, v7, 4, v8
    v_mul_u32_u24 v9, 320, v4
    v_add3_u32 v199, v8, v9, s4
    s_waitcnt lgkmcnt(0)
    v_pk_fma_f32 v[108:109], v[72:73], v[190:191], v[108:109] op_sel:[0,0,0] op_sel_hi:[1,0,1]
    v_pk_fma_f32 v[110:111], v[74:75], v[190:191], v[110:111] op_sel:[0,0,0] op_sel_hi:[1,0,1]
    v_pk_fma_f32 v[112:113], v[76:77], v[190:191], v[112:113] op_sel:[0,0,0] op_sel_hi:[1,0,1]
    v_pk_fma_f32 v[114:115], v[78:79], v[190:191], v[114:115] op_sel:[0,0,0] op_sel_hi:[1,0,1]
    v_pk_fma_f32 v[116:117], v[80:81], v[190:191], v[116:117] op_sel:[0,0,0] op_sel_hi:[1,0,1]
    v_pk_fma_f32 v[118:119], v[82:83], v[190:191], v[118:119] op_sel:[0,0,0] op_sel_hi:[1,0,1]
    v_pk_fma_f32 v[120:121], v[84:85], v[190:191], v[120:121] op_sel:[0,0,0] op_sel_hi:[1,0,1]
    v_pk_fma_f32 v[122:123], v[86:87], v[190:191], v[122:123] op_sel:[0,0,0] op_sel_hi:[1,0,1]
    v_pk_mul_f32 v[108:109], v[56:57], v[108:109] op_sel:[0,0] op_sel_hi:[1,1]
    v_pk_mul_f32 v[110:111], v[58:59], v[110:111] op_sel:[0,0] op_sel_hi:[1,1]
    v_pk_mul_f32 v[112:113], v[60:61], v[112:113] op_sel:[0,0] op_sel_hi:[1,1]
    v_pk_mul_f32 v[114:115], v[62:63], v[114:115] op_sel:[0,0] op_sel_hi:[1,1]
    v_pk_mul_f32 v[116:117], v[64:65], v[116:117] op_sel:[0,0] op_sel_hi:[1,1]
    v_pk_mul_f32 v[118:119], v[66:67], v[118:119] op_sel:[0,0] op_sel_hi:[1,1]
    v_pk_mul_f32 v[120:121], v[68:69], v[120:121] op_sel:[0,0] op_sel_hi:[1,1]
    v_pk_mul_f32 v[122:123], v[70:71], v[122:123] op_sel:[0,0] op_sel_hi:[1,1]
    v_cvt_pk_bf16_f32 v108, v108, v109
    v_cvt_pk_bf16_f32 v109, v110, v111
    v_cvt_pk_bf16_f32 v110, v112, v113
    v_cvt_pk_bf16_f32 v111, v114, v115
    buffer_store_dwordx4 v[108:111], v195, s[16:19], 0 offen offset:0 sc1
    v_cvt_pk_bf16_f32 v116, v116, v117
    v_cvt_pk_bf16_f32 v117, v118, v119
    v_cvt_pk_bf16_f32 v118, v120, v121
    v_cvt_pk_bf16_f32 v119, v122, v123
    buffer_store_dwordx4 v[116:119], v195, s[16:19], 0 offen offset:640 sc1
    v_pk_fma_f32 v[124:125], v[72:73], v[190:191], v[124:125] op_sel:[0,1,0] op_sel_hi:[1,1,1]
    v_pk_fma_f32 v[126:127], v[74:75], v[190:191], v[126:127] op_sel:[0,1,0] op_sel_hi:[1,1,1]
    v_pk_fma_f32 v[128:129], v[76:77], v[190:191], v[128:129] op_sel:[0,1,0] op_sel_hi:[1,1,1]
    v_pk_fma_f32 v[130:131], v[78:79], v[190:191], v[130:131] op_sel:[0,1,0] op_sel_hi:[1,1,1]
    v_pk_fma_f32 v[132:133], v[80:81], v[190:191], v[132:133] op_sel:[0,1,0] op_sel_hi:[1,1,1]
    v_pk_fma_f32 v[134:135], v[82:83], v[190:191], v[134:135] op_sel:[0,1,0] op_sel_hi:[1,1,1]
    v_pk_fma_f32 v[136:137], v[84:85], v[190:191], v[136:137] op_sel:[0,1,0] op_sel_hi:[1,1,1]
    v_pk_fma_f32 v[138:139], v[86:87], v[190:191], v[138:139] op_sel:[0,1,0] op_sel_hi:[1,1,1]
    v_pk_mul_f32 v[124:125], v[56:57], v[124:125] op_sel:[0,0] op_sel_hi:[1,1]
    v_pk_mul_f32 v[126:127], v[58:59], v[126:127] op_sel:[0,0] op_sel_hi:[1,1]
    v_pk_mul_f32 v[128:129], v[60:61], v[128:129] op_sel:[0,0] op_sel_hi:[1,1]
    v_pk_mul_f32 v[130:131], v[62:63], v[130:131] op_sel:[0,0] op_sel_hi:[1,1]
    v_pk_mul_f32 v[132:133], v[64:65], v[132:133] op_sel:[0,0] op_sel_hi:[1,1]
    v_pk_mul_f32 v[134:135], v[66:67], v[134:135] op_sel:[0,0] op_sel_hi:[1,1]
    v_pk_mul_f32 v[136:137], v[68:69], v[136:137] op_sel:[0,0] op_sel_hi:[1,1]
    v_pk_mul_f32 v[138:139], v[70:71], v[138:139] op_sel:[0,0] op_sel_hi:[1,1]
    v_cvt_pk_bf16_f32 v124, v124, v125
    v_cvt_pk_bf16_f32 v125, v126, v127
    v_cvt_pk_bf16_f32 v126, v128, v129
    v_cvt_pk_bf16_f32 v127, v130, v131
    buffer_store_dwordx4 v[124:127], v196, s[16:19], 0 offen offset:0 sc1
    v_cvt_pk_bf16_f32 v132, v132, v133
    v_cvt_pk_bf16_f32 v133, v134, v135
    v_cvt_pk_bf16_f32 v134, v136, v137
    v_cvt_pk_bf16_f32 v135, v138, v139
    buffer_store_dwordx4 v[132:135], v196, s[16:19], 0 offen offset:640 sc1
    v_pk_fma_f32 v[140:141], v[72:73], v[192:193], v[140:141] op_sel:[0,0,0] op_sel_hi:[1,0,1]
    v_pk_fma_f32 v[142:143], v[74:75], v[192:193], v[142:143] op_sel:[0,0,0] op_sel_hi:[1,0,1]
    v_pk_fma_f32 v[144:145], v[76:77], v[192:193], v[144:145] op_sel:[0,0,0] op_sel_hi:[1,0,1]
    v_pk_fma_f32 v[146:147], v[78:79], v[192:193], v[146:147] op_sel:[0,0,0] op_sel_hi:[1,0,1]
    v_pk_fma_f32 v[148:149], v[80:81], v[192:193], v[148:149] op_sel:[0,0,0] op_sel_hi:[1,0,1]
    v_pk_fma_f32 v[150:151], v[82:83], v[192:193], v[150:151] op_sel:[0,0,0] op_sel_hi:[1,0,1]
    v_pk_fma_f32 v[152:153], v[84:85], v[192:193], v[152:153] op_sel:[0,0,0] op_sel_hi:[1,0,1]
    v_pk_fma_f32 v[154:155], v[86:87], v[192:193], v[154:155] op_sel:[0,0,0] op_sel_hi:[1,0,1]
    v_pk_mul_f32 v[140:141], v[56:57], v[140:141] op_sel:[0,0] op_sel_hi:[1,1]
    v_pk_mul_f32 v[142:143], v[58:59], v[142:143] op_sel:[0,0] op_sel_hi:[1,1]
    v_pk_mul_f32 v[144:145], v[60:61], v[144:145] op_sel:[0,0] op_sel_hi:[1,1]
    v_pk_mul_f32 v[146:147], v[62:63], v[146:147] op_sel:[0,0] op_sel_hi:[1,1]
    v_pk_mul_f32 v[148:149], v[64:65], v[148:149] op_sel:[0,0] op_sel_hi:[1,1]
    v_pk_mul_f32 v[150:151], v[66:67], v[150:151] op_sel:[0,0] op_sel_hi:[1,1]
    v_pk_mul_f32 v[152:153], v[68:69], v[152:153] op_sel:[0,0] op_sel_hi:[1,1]
    v_pk_mul_f32 v[154:155], v[70:71], v[154:155] op_sel:[0,0] op_sel_hi:[1,1]
    v_cvt_pk_bf16_f32 v140, v140, v141
    v_cvt_pk_bf16_f32 v141, v142, v143
    v_cvt_pk_bf16_f32 v142, v144, v145
    v_cvt_pk_bf16_f32 v143, v146, v147
    buffer_store_dwordx4 v[140:143], v197, s[16:19], 0 offen offset:0 sc1
    v_cvt_pk_bf16_f32 v148, v148, v149
    v_cvt_pk_bf16_f32 v149, v150, v151
    v_cvt_pk_bf16_f32 v150, v152, v153
    v_cvt_pk_bf16_f32 v151, v154, v155
    buffer_store_dwordx4 v[148:151], v197, s[16:19], 0 offen offset:640 sc1
    v_pk_fma_f32 v[156:157], v[72:73], v[192:193], v[156:157] op_sel:[0,1,0] op_sel_hi:[1,1,1]
    v_pk_fma_f32 v[158:159], v[74:75], v[192:193], v[158:159] op_sel:[0,1,0] op_sel_hi:[1,1,1]
    v_pk_fma_f32 v[160:161], v[76:77], v[192:193], v[160:161] op_sel:[0,1,0] op_sel_hi:[1,1,1]
    v_pk_fma_f32 v[162:163], v[78:79], v[192:193], v[162:163] op_sel:[0,1,0] op_sel_hi:[1,1,1]
    v_pk_fma_f32 v[164:165], v[80:81], v[192:193], v[164:165] op_sel:[0,1,0] op_sel_hi:[1,1,1]
    v_pk_fma_f32 v[166:167], v[82:83], v[192:193], v[166:167] op_sel:[0,1,0] op_sel_hi:[1,1,1]
    v_pk_fma_f32 v[168:169], v[84:85], v[192:193], v[168:169] op_sel:[0,1,0] op_sel_hi:[1,1,1]
    v_pk_fma_f32 v[170:171], v[86:87], v[192:193], v[170:171] op_sel:[0,1,0] op_sel_hi:[1,1,1]
    v_pk_mul_f32 v[156:157], v[56:57], v[156:157] op_sel:[0,0] op_sel_hi:[1,1]
    v_pk_mul_f32 v[158:159], v[58:59], v[158:159] op_sel:[0,0] op_sel_hi:[1,1]
    v_pk_mul_f32 v[160:161], v[60:61], v[160:161] op_sel:[0,0] op_sel_hi:[1,1]
    v_pk_mul_f32 v[162:163], v[62:63], v[162:163] op_sel:[0,0] op_sel_hi:[1,1]
    v_pk_mul_f32 v[164:165], v[64:65], v[164:165] op_sel:[0,0] op_sel_hi:[1,1]
    v_pk_mul_f32 v[166:167], v[66:67], v[166:167] op_sel:[0,0] op_sel_hi:[1,1]
    v_pk_mul_f32 v[168:169], v[68:69], v[168:169] op_sel:[0,0] op_sel_hi:[1,1]
    v_pk_mul_f32 v[170:171], v[70:71], v[170:171] op_sel:[0,0] op_sel_hi:[1,1]
    v_cvt_pk_bf16_f32 v156, v156, v157
    v_cvt_pk_bf16_f32 v157, v158, v159
    v_cvt_pk_bf16_f32 v158, v160, v161
    v_cvt_pk_bf16_f32 v159, v162, v163
    buffer_store_dwordx4 v[156:159], v198, s[16:19], 0 offen offset:0 sc1
    v_cvt_pk_bf16_f32 v164, v164, v165
    v_cvt_pk_bf16_f32 v165, v166, v167
    v_cvt_pk_bf16_f32 v166, v168, v169
    v_cvt_pk_bf16_f32 v167, v170, v171
    buffer_store_dwordx4 v[164:167], v198, s[16:19], 0 offen offset:640 sc1
    v_pk_fma_f32 v[172:173], v[72:73], v[194:195], v[172:173] op_sel:[0,0,0] op_sel_hi:[1,0,1]
    v_pk_fma_f32 v[174:175], v[74:75], v[194:195], v[174:175] op_sel:[0,0,0] op_sel_hi:[1,0,1]
    v_pk_fma_f32 v[176:177], v[76:77], v[194:195], v[176:177] op_sel:[0,0,0] op_sel_hi:[1,0,1]
    v_pk_fma_f32 v[178:179], v[78:79], v[194:195], v[178:179] op_sel:[0,0,0] op_sel_hi:[1,0,1]
    v_pk_fma_f32 v[180:181], v[80:81], v[194:195], v[180:181] op_sel:[0,0,0] op_sel_hi:[1,0,1]
    v_pk_fma_f32 v[182:183], v[82:83], v[194:195], v[182:183] op_sel:[0,0,0] op_sel_hi:[1,0,1]
    v_pk_fma_f32 v[184:185], v[84:85], v[194:195], v[184:185] op_sel:[0,0,0] op_sel_hi:[1,0,1]
    v_pk_fma_f32 v[186:187], v[86:87], v[194:195], v[186:187] op_sel:[0,0,0] op_sel_hi:[1,0,1]
    v_pk_mul_f32 v[172:173], v[56:57], v[172:173] op_sel:[0,0] op_sel_hi:[1,1]
    v_pk_mul_f32 v[174:175], v[58:59], v[174:175] op_sel:[0,0] op_sel_hi:[1,1]
    v_pk_mul_f32 v[176:177], v[60:61], v[176:177] op_sel:[0,0] op_sel_hi:[1,1]
    v_pk_mul_f32 v[178:179], v[62:63], v[178:179] op_sel:[0,0] op_sel_hi:[1,1]
    v_pk_mul_f32 v[180:181], v[64:65], v[180:181] op_sel:[0,0] op_sel_hi:[1,1]
    v_pk_mul_f32 v[182:183], v[66:67], v[182:183] op_sel:[0,0] op_sel_hi:[1,1]
    v_pk_mul_f32 v[184:185], v[68:69], v[184:185] op_sel:[0,0] op_sel_hi:[1,1]
    v_pk_mul_f32 v[186:187], v[70:71], v[186:187] op_sel:[0,0] op_sel_hi:[1,1]
    v_cvt_pk_bf16_f32 v172, v172, v173
    v_cvt_pk_bf16_f32 v173, v174, v175
    v_cvt_pk_bf16_f32 v174, v176, v177
    v_cvt_pk_bf16_f32 v175, v178, v179
    buffer_store_dwordx4 v[172:175], v199, s[16:19], 0 offen offset:0 sc1
    v_cvt_pk_bf16_f32 v180, v180, v181
    v_cvt_pk_bf16_f32 v181, v182, v183
    v_cvt_pk_bf16_f32 v182, v184, v185
    v_cvt_pk_bf16_f32 v183, v186, v187
    buffer_store_dwordx4 v[180:183], v199, s[16:19], 0 offen offset:640 sc1
    s_waitcnt vmcnt(0)
    s_barrier
    s_cmp_lg_u32 s22, 0
    s_cbranch_scc1 pub_42
    s_lshl_b32 s4, s21, 4
    s_add_u32 s4, s4, s20
    s_lshl_b32 s4, s4, 7
    s_add_u32 s4, s4, 0xe0000
    v_mov_b32 v2, s29
    s_mov_b64 exec, 1
    buffer_store_dword v2, off, s[72:75], s4 sc1
    s_mov_b64 exec, -1
pub_42:
    s_branch p2_entry
k1_ffn:
    s_and_b32 s36, s22, 1
    s_lshr_b32 s37, s22, 1
    s_and_b32 s32, s22, 3
    s_lshr_b32 s33, s22, 2
    s_sub_u32 s34, s21, 6
    s_mul_i32 s34, s34, 384
    s_mul_i32 s35, s32, 27648
    s_add_u32 s34, s34, s35
    s_lshl_b32 s35, s33, 2
    s_mul_i32 s4, s32, 3072
    s_mul_i32 s5, s33, 12288
    s_add_u32 s27, s4, s5
    v_mov_b32 v6, v1
    s_mov_b32 s4, 2731
    s_mov_b32 s5, 3456
    v_add_u32 v2, 0, v6
    v_mul_lo_u32 v3, v2, s4
    v_lshrrev_b32 v3, 16, v3
    v_mul_u32_u24 v4, 24, v3
    v_sub_u32 v4, v2, v4
    v_bfe_u32 v5, v3, 1, 1
    v_lshl_or_b32 v5, v5, 1, s35
    v_xor_b32 v4, v4, v5
    v_mul_lo_u32 v3, v3, s5
    v_lshl_add_u32 v3, v4, 4, v3
    v_add_u32 v3, s34, v3
    v_subrev_u32 v10, 0, v3
    v_add_u32 v2, 64, v6
    v_mul_lo_u32 v3, v2, s4
    v_lshrrev_b32 v3, 16, v3
    v_mul_u32_u24 v4, 24, v3
    v_sub_u32 v4, v2, v4
    v_bfe_u32 v5, v3, 1, 1
    v_lshl_or_b32 v5, v5, 1, s35
    v_xor_b32 v4, v4, v5
    v_mul_lo_u32 v3, v3, s5
    v_lshl_add_u32 v3, v4, 4, v3
    v_add_u32 v3, s34, v3
    v_subrev_u32 v11, 1024, v3
    v_add_u32 v2, 128, v6
    v_mul_lo_u32 v3, v2, s4
    v_lshrrev_b32 v3, 16, v3
    v_mul_u32_u24 v4, 24, v3
    v_sub_u32 v4, v2, v4
    v_bfe_u32 v5, v3, 1, 1
    v_lshl_or_b32 v5, v5, 1, s35
    v_xor_b32 v4, v4, v5
    v_mul_lo_u32 v3, v3, s5
    v_lshl_add_u32 v3, v4, 4, v3
    v_add_u32 v3, s34, v3
    v_subrev_u32 v12, 2048, v3
    s_lshl_b32 s4, s20, 7
    s_lshl_b32 s5, s22, 4
    s_add_u32 s4, s4, s5
    s_mul_i32 s4, s4, 1280
    v_lshrrev_b32 v2, 2, v1
    v_bfe_u32 v3, v1, 4, 2
    v_and_b32 v4, 3, v1
    v_xor_b32 v4, v4, v3
    v_mul_u32_u24 v2, 1280, v2
    v_lshl_add_u32 v2, v4, 4, v2
    v_add_u32 v13, s4, v2
    s_lshl_b32 s28, s22, 10
    s_add_u32 s28, s28, 122880
    s_lshr_b32 s6, s20, 2
    s_mul_i32 s6, s6, 5
    s_and_b32 s4, s20, 3
    s_cmp_eq_u32 s4, 0
    s_cselect_b32 s5, 4, 99
    s_mul_i32 s24, s6, 110592
    s_lshl_b32 s25, s6, 6
    s_mov_b32 s60, 99
    s_cmp_eq_u32 s4, 0
    s_cselect_b32 s60, 3, s60
    s_cmp_eq_u32 s4, 5
    s_cselect_b32 s60, 2, s60
    s_cmp_eq_u32 s5, 0
    s_cselect_b32 s60, 3, s60
    s_cmp_eq_u32 s5, 5
    s_cselect_b32 s60, 2, s60
    s_mov_b32 s61, 99
    s_cmp_eq_u32 s4, 1
    s_cselect_b32 s61, 3, s61
    s_cmp_eq_u32 s4, 6
    s_cselect_b32 s61, 2, s61
    s_cmp_eq_u32 s5, 1
    s_cselect_b32 s61, 3, s61
    s_cmp_eq_u32 s5, 6
    s_cselect_b32 s61, 2, s61
    s_mov_b32 s62, 99
    s_cmp_eq_u32 s4, 2
    s_cselect_b32 s62, 3, s62
    s_cmp_eq_u32 s4, 7
    s_cselect_b32 s62, 2, s62
    s_cmp_eq_u32 s5, 2
    s_cselect_b32 s62, 3, s62
    s_cmp_eq_u32 s5, 7
    s_cselect_b32 s62, 2, s62
    s_mov_b32 s63, 99
    s_cmp_eq_u32 s4, 3
    s_cselect_b32 s63, 3, s63
    s_cmp_eq_u32 s4, 8
    s_cselect_b32 s63, 2, s63
    s_cmp_eq_u32 s5, 3
    s_cselect_b32 s63, 3, s63
    s_cmp_eq_u32 s5, 8
    s_cselect_b32 s63, 2, s63
    s_mov_b32 s64, 99
    s_cmp_eq_u32 s4, 4
    s_cselect_b32 s64, 3, s64
    s_cmp_eq_u32 s4, 9
    s_cselect_b32 s64, 2, s64
    s_cmp_eq_u32 s5, 4
    s_cselect_b32 s64, 3, s64
    s_cmp_eq_u32 s5, 9
    s_cselect_b32 s64, 2, s64
    s_lshl_b32 s5, s21, 4
    s_add_u32 s4, s20, s5
    s_mul_i32 s4, s4, 12
    s_mul_i32 s5, s37, 3
    s_add_u32 s4, s4, s5
    s_lshl_b32 s4, s4, 8
    s_add_u32 s30, s4, 131072
    s_cmp_eq_u32 s36, 0
    s_cselect_b32 s26, 3, 4
    s_waitcnt lgkmcnt(0)
    s_or_b32 s4, s2, s22
    s_cmp_lg_u32 s4, 0
    s_cbranch_scc1 k1n_43
    s_mov_b32 s76, s56
    s_mov_b32 s77, s57
    s_mov_b32 s78, 0x100
    s_mov_b32 s79, 0x00020000
    s_memrealtime s[6:7]
    s_waitcnt lgkmcnt(0)
    s_or_b32 s6, s6, 1
    v_mov_b32 v2, s6
    s_mov_b64 exec, 1
    buffer_store_dword v2, off, s[76:79], 0 sc1
    s_mov_b64 exec, -1
k1n_43:
    s_mov_b32 s8, s40
    s_mov_b32 s9, s41
    s_mov_b32 s10, 0x280000
    s_mov_b32 s11, 0x00020000
    s_cmp_ge_u32 s22, 4
    s_cselect_b32 s12, s50, s48
    s_cselect_b32 s13, s51, s49
    s_mov_b32 s14, 0x21c000
    s_mov_b32 s15, 0x00020000
    s_cmp_ge_u32 s22, 4
    s_cbranch_scc1 k1_ffn_v1
    s_add_u32 m0, s28, 0
    s_nop 0
    buffer_load_dwordx4 v13, s[8:11], s25 offen lds
    s_add_u32 m0, s27, 0
    s_add_u32 s25, s25, 64
    buffer_load_dwordx4 v10, s[12:15], s24 offen lds
    buffer_load_dwordx4 v11, s[12:15], s24 offen offset:1024 lds
    buffer_load_dwordx4 v12, s[12:15], s24 offen offset:2048 lds
    s_add_u32 s24, s24, 110592
    s_cmp_eq_u32 s25, 1280
    s_cselect_b32 s25, 0, s25
    s_cselect_b32 s24, 0, s24
    v_lshrrev_b32 v2, 4, v1
    v_bfe_u32 v3, v1, 2, 2
    v_and_b32 v4, 3, v1
    v_bfe_u32 v5, v1, 3, 1
    v_lshrrev_b32 v6, 1, v2
    v_lshl_add_u32 v6, v6, 3, v3
    v_mul_u32_u24 v6, 384, v6
    v_and_b32 v7, 1, v2
    v_mul_u32_u24 v8, 12288, v7
    v_add_u32 v6, v6, v8
    v_and_b32 v8, 1, v4
    v_lshl_add_u32 v6, v8, 3, v6
    v_lshlrev_b32 v7, 2, v7
    v_lshl_add_u32 v7, v5, 1, v7
    v_lshrrev_b32 v8, 1, v4
    s_mul_i32 s4, s37, 6
    v_add3_u32 v9, v8, s4, 0
    v_xor_b32 v9, v9, v7
    v_lshl_add_u32 v14, v9, 4, v6
    v_add_u32 v17, 73728, v14
    v_add3_u32 v9, v8, s4, 2
    v_xor_b32 v9, v9, v7
    v_lshl_add_u32 v15, v9, 4, v6
    v_add_u32 v18, 73728, v15
    v_add3_u32 v9, v8, s4, 4
    v_xor_b32 v9, v9, v7
    v_lshl_add_u32 v16, v9, 4, v6
    v_add_u32 v19, 73728, v16
    v_and_b32 v2, 31, v1
    v_bfe_u32 v3, v1, 2, 2
    v_lshrrev_b32 v4, 5, v1
    s_lshl_b32 s5, s36, 12
    s_add_u32 s5, s5, 122880
    v_lshlrev_b32 v2, 6, v2
    v_add_u32 v2, s5, v2
    v_xor_b32 v5, v4, v3
    v_lshl_add_u32 v20, v5, 4, v2
    v_xor_b32 v21, 32, v20
    v_min_u32 v2, 383, v0
    v_lshlrev_b32 v25, 2, v2
    s_add_u32 m0, s28, 8192
    s_nop 0
    buffer_load_dwordx4 v13, s[8:11], s25 offen lds
    s_add_u32 m0, s27, 24576
    s_add_u32 s25, s25, 64
    buffer_load_dwordx4 v10, s[12:15], s24 offen lds
    buffer_load_dwordx4 v11, s[12:15], s24 offen offset:1024 lds
    buffer_load_dwordx4 v12, s[12:15], s24 offen offset:2048 lds
    s_add_u32 s24, s24, 110592
    s_cmp_eq_u32 s25, 1280
    s_cselect_b32 s25, 0, s25
    s_cselect_b32 s24, 0, s24
    v_and_b32 v2, 127, v0
    v_lshlrev_b32 v26, 2, v2
    v_and_b32 v2, 15, v1
    v_lshlrev_b32 v27, 4, v2
    v_and_b32 v2, 31, v1
    v_mov_b32 v3, 0x3f803f80
    v_cmp_eq_u32 vcc, 0, v2
    v_cmp_eq_u32 s[4:5], 17, v2
    s_nop 1
    s_or_b64 vcc, vcc, s[4:5]
    s_nop 1
    v_cndmask_b32 v32, 0, v3, vcc
    v_mov_b32 v33, v32
    v_mov_b32 v34, v32
    v_mov_b32 v35, v32
    v_mov_b32 v36, 0
    v_mov_b32 v37, 0
    v_mov_b32 v38, 0
    v_mov_b32 v39, 0
    v_mov_b32 v40, 0
    v_mov_b32 v41, 0
    v_mov_b32 v42, 0
    v_mov_b32 v43, 0
    v_mov_b32 v44, 0
    v_mov_b32 v45, 0
    v_mov_b32 v46, 0
    v_mov_b32 v47, 0
    v_mov_b32 v92, 0
    v_mov_b32 v93, 0
    v_mov_b32 v94, 0
    v_mov_b32 v95, 0
    v_mov_b32 v96, 0
    v_mov_b32 v97, 0
    v_mov_b32 v98, 0
    v_mov_b32 v99, 0
    v_mov_b32 v100, 0
    v_mov_b32 v101, 0
    v_mov_b32 v102, 0
    v_mov_b32 v103, 0
    v_mov_b32 v104, 0
    v_mov_b32 v105, 0
    s_add_u32 m0, s28, 16384
    s_nop 0
    buffer_load_dwordx4 v13, s[8:11], s25 offen lds
    s_add_u32 m0, s27, 49152
    s_add_u32 s25, s25, 64
    buffer_load_dwordx4 v10, s[12:15], s24 offen lds
    buffer_load_dwordx4 v11, s[12:15], s24 offen offset:1024 lds
    buffer_load_dwordx4 v12, s[12:15], s24 offen offset:2048 lds
    s_add_u32 s24, s24, 110592
    s_cmp_eq_u32 s25, 1280
    s_cselect_b32 s25, 0, s25
    s_cselect_b32 s24, 0, s24
    v_mov_b32 v106, 0
    v_mov_b32 v107, 0
    v_mov_b32 v108, 0
    v_mov_b32 v109, 0
    v_mov_b32 v110, 0
    v_mov_b32 v111, 0
    v_mov_b32 v112, 0
    v_mov_b32 v113, 0
    v_mov_b32 v114, 0
    v_mov_b32 v115, 0
    v_mov_b32 v116, 0
    v_mov_b32 v117, 0
    v_mov_b32 v118, 0
    v_mov_b32 v119, 0
    v_mov_b32 v120, 0
    v_mov_b32 v121, 0
    v_mov_b32 v122, 0
    v_mov_b32 v123, 0
    v_mov_b32 v124, 0
    v_mov_b32 v125, 0
    v_mov_b32 v126, 0
    v_mov_b32 v127, 0
    v_mov_b32 v128, 0
    v_mov_b32 v129, 0
    v_mov_b32 v130, 0
    v_mov_b32 v131, 0
    v_mov_b32 v132, 0
    v_mov_b32 v133, 0
    v_mov_b32 v134, 0
    v_mov_b32 v135, 0
    v_mov_b32 v136, 0
    v_mov_b32 v137, 0
    v_mov_b32 v138, 0
    v_mov_b32 v139, 0
    v_mov_b32 v140, 0
    v_mov_b32 v141, 0
    v_mov_b32 v142, 0
    v_mov_b32 v143, 0
    v_mov_b32 v144, 0
    v_mov_b32 v145, 0
    v_mov_b32 v146, 0
    s_add_u32 m0, s28, 24576
    s_nop 0
    buffer_load_dwordx4 v13, s[8:11], s25 offen lds
    s_add_u32 m0, s27, 73728
    s_add_u32 s25, s25, 64
    buffer_load_dwordx4 v10, s[12:15], s24 offen lds
    buffer_load_dwordx4 v11, s[12:15], s24 offen offset:1024 lds
    buffer_load_dwordx4 v12, s[12:15], s24 offen offset:2048 lds
    s_add_u32 s24, s24, 110592
    s_cmp_eq_u32 s25, 1280
    s_cselect_b32 s25, 0, s25
    s_cselect_b32 s24, 0, s24
    v_mov_b32 v147, 0
    v_mov_b32 v148, 0
    v_mov_b32 v149, 0
    v_mov_b32 v150, 0
    v_mov_b32 v151, 0
    v_mov_b32 v152, 0
    v_mov_b32 v153, 0
    v_mov_b32 v154, 0
    v_mov_b32 v155, 0
    v_mov_b32 v156, 0
    v_mov_b32 v157, 0
    v_mov_b32 v158, 0
    v_mov_b32 v159, 0
    v_mov_b32 v160, 0
    v_mov_b32 v161, 0
    v_mov_b32 v162, 0
    v_mov_b32 v163, 0
    v_mov_b32 v164, 0
    v_mov_b32 v165, 0
    v_mov_b32 v166, 0
    v_mov_b32 v167, 0
    v_mov_b32 v168, 0
    v_mov_b32 v169, 0
    v_mov_b32 v170, 0
    v_mov_b32 v171, 0
    v_mov_b32 v172, 0
    v_mov_b32 v173, 0
    v_mov_b32 v174, 0
    v_mov_b32 v175, 0
    v_mov_b32 v176, 0
    v_mov_b32 v177, 0
    v_mov_b32 v178, 0
    v_mov_b32 v179, 0
    v_mov_b32 v180, 0
    v_mov_b32 v181, 0
    v_mov_b32 v182, 0
    v_mov_b32 v183, 0
    v_mov_b32 v184, 0
    v_mov_b32 v185, 0
    v_mov_b32 v186, 0
    v_mov_b32 v187, 0
    s_mov_b32 s76, s56
    s_mov_b32 s77, s57
    s_mov_b32 s78, 0x100
    s_mov_b32 s79, 0x00020000
    s_add_u32 s72, s58, 0x1800000
    s_addc_u32 s73, s59, 0
    s_mov_b32 s74, 0x100000
    s_mov_b32 s75, 0x00020000
    s_waitcnt vmcnt(12)
    s_barrier
    ds_read_b64_tr_b16 v[48:49], v14 offset:0
    ds_read_b64_tr_b16 v[50:51], v14 offset:1536
    ds_read_b128 v[72:75], v20 offset:0
    ds_read_b128 v[76:79], v20 offset:2048
    ds_read_b64_tr_b16 v[52:53], v15 offset:0
    ds_read_b64_tr_b16 v[54:55], v15 offset:1536
    ds_read_b64_tr_b16 v[56:57], v16 offset:0
    ds_read_b64_tr_b16 v[58:59], v16 offset:1536
    s_mov_b32 s23, 3
k1_ffn_loop0:
    s_waitcnt lgkmcnt(5)
    v_mfma_f32_32x32x16_bf16 v[92:107], v[48:51], v[72:75], v[92:107]
    ds_read_b64_tr_b16 v[60:61], v14 offset:6144
    ds_read_b64_tr_b16 v[62:63], v14 offset:7680
    s_waitcnt lgkmcnt(6)
    v_mfma_f32_32x32x16_bf16 v[108:123], v[48:51], v[76:79], v[108:123]
    ds_read_b128 v[80:83], v21 offset:0
    s_waitcnt lgkmcnt(5)
    v_mfma_f32_32x32x16_bf16 v[124:139], v[52:55], v[72:75], v[124:139]
    ds_read_b128 v[84:87], v21 offset:2048
    v_mfma_f32_32x32x16_bf16 v[140:155], v[52:55], v[76:79], v[140:155]
    ds_read_b64_tr_b16 v[64:65], v15 offset:6144
    ds_read_b64_tr_b16 v[66:67], v15 offset:7680
    s_waitcnt lgkmcnt(6)
    v_mfma_f32_32x32x16_bf16 v[156:171], v[56:59], v[72:75], v[156:171]
    ds_read_b64_tr_b16 v[68:69], v16 offset:6144
    ds_read_b64_tr_b16 v[70:71], v16 offset:7680
    v_mfma_f32_32x32x16_bf16 v[172:187], v[56:59], v[76:79], v[172:187]
    s_cmp_eq_u32 s23, s60
    s_cbranch_scc1 k1cs_44
k1cs_44_back:
    s_waitcnt vmcnt(8)
    s_barrier
    s_cmp_eq_u32 s23, 1
    s_cbranch_scc1 k1dg_45
k1dg_45_back:
    s_waitcnt lgkmcnt(5)
    v_mfma_f32_32x32x16_bf16 v[92:107], v[60:63], v[80:83], v[92:107]
    ds_read_b64_tr_b16 v[48:49], v14 offset:24576
    ds_read_b64_tr_b16 v[50:51], v14 offset:26112
    s_waitcnt lgkmcnt(6)
    v_mfma_f32_32x32x16_bf16 v[108:123], v[60:63], v[84:87], v[108:123]
    ds_read_b128 v[72:75], v20 offset:8192
    s_add_u32 m0, s28, 32768
    s_nop 0
    buffer_load_dwordx4 v13, s[8:11], s25 offen lds
    s_waitcnt lgkmcnt(5)
    v_mfma_f32_32x32x16_bf16 v[124:139], v[64:67], v[80:83], v[124:139]
    ds_read_b128 v[76:79], v20 offset:10240
    s_add_u32 m0, s27, 98304
    s_add_u32 s25, s25, 64
    buffer_load_dwordx4 v10, s[12:15], s24 offen lds
    v_mfma_f32_32x32x16_bf16 v[140:155], v[64:67], v[84:87], v[140:155]
    ds_read_b64_tr_b16 v[52:53], v15 offset:24576
    ds_read_b64_tr_b16 v[54:55], v15 offset:26112
    buffer_load_dwordx4 v11, s[12:15], s24 offen offset:1024 lds
    s_waitcnt lgkmcnt(6)
    v_mfma_f32_32x32x16_bf16 v[156:171], v[68:71], v[80:83], v[156:171]
    ds_read_b64_tr_b16 v[56:57], v16 offset:24576
    ds_read_b64_tr_b16 v[58:59], v16 offset:26112
    buffer_load_dwordx4 v12, s[12:15], s24 offen offset:2048 lds
    s_add_u32 s24, s24, 110592
    s_cmp_eq_u32 s25, 1280
    s_cselect_b32 s25, 0, s25
    s_cselect_b32 s24, 0, s24
    v_mfma_f32_32x32x16_bf16 v[172:187], v[68:71], v[84:87], v[172:187]
    s_waitcnt lgkmcnt(5)
    v_mfma_f32_32x32x16_bf16 v[92:107], v[48:51], v[72:75], v[92:107]
    ds_read_b64_tr_b16 v[60:61], v14 offset:30720
    ds_read_b64_tr_b16 v[62:63], v14 offset:32256
    s_waitcnt lgkmcnt(6)
    v_mfma_f32_32x32x16_bf16 v[108:123], v[48:51], v[76:79], v[108:123]
    ds_read_b128 v[80:83], v21 offset:8192
    s_waitcnt lgkmcnt(5)
    v_mfma_f32_32x32x16_bf16 v[124:139], v[52:55], v[72:75], v[124:139]
    ds_read_b128 v[84:87], v21 offset:10240
    v_mfma_f32_32x32x16_bf16 v[140:155], v[52:55], v[76:79], v[140:155]
    ds_read_b64_tr_b16 v[64:65], v15 offset:30720
    ds_read_b64_tr_b16 v[66:67], v15 offset:32256
    s_waitcnt lgkmcnt(6)
    v_mfma_f32_32x32x16_bf16 v[156:171], v[56:59], v[72:75], v[156:171]
    ds_read_b64_tr_b16 v[68:69], v16 offset:30720
    ds_read_b64_tr_b16 v[70:71], v16 offset:32256
    v_mfma_f32_32x32x16_bf16 v[172:187], v[56:59], v[76:79], v[172:187]
    s_cmp_eq_u32 s23, s61
    s_cbranch_scc1 k1cs_46
k1cs_46_back:
    s_waitcnt vmcnt(8)
    s_barrier
    s_waitcnt lgkmcnt(5)
    v_mfma_f32_32x32x16_bf16 v[92:107], v[60:63], v[80:83], v[92:107]
    ds_read_b64_tr_b16 v[48:49], v14 offset:49152
    ds_read_b64_tr_b16 v[50:51], v14 offset:50688
    s_waitcnt lgkmcnt(6)
    v_mfma_f32_32x32x16_bf16 v[108:123], v[60:63], v[84:87], v[108:123]
    ds_read_b128 v[72:75], v20 offset:16384
    s_add_u32 m0, s28, 0
    s_nop 0
    buffer_load_dwordx4 v13, s[8:11], s25 offen lds
    s_waitcnt lgkmcnt(5)
    v_mfma_f32_32x32x16_bf16 v[124:139], v[64:67], v[80:83], v[124:139]
    ds_read_b128 v[76:79], v20 offset:18432
    s_add_u32 m0, s27, 0
    s_add_u32 s25, s25, 64
    buffer_load_dwordx4 v10, s[12:15], s24 offen lds
    v_mfma_f32_32x32x16_bf16 v[140:155], v[64:67], v[84:87], v[140:155]
    ds_read_b64_tr_b16 v[52:53], v15 offset:49152
    ds_read_b64_tr_b16 v[54:55], v15 offset:50688
    buffer_load_dwordx4 v11, s[12:15], s24 offen offset:1024 lds
    s_waitcnt lgkmcnt(6)
    v_mfma_f32_32x32x16_bf16 v[156:171], v[68:71], v[80:83], v[156:171]
    ds_read_b64_tr_b16 v[56:57], v16 offset:49152
    ds_read_b64_tr_b16 v[58:59], v16 offset:50688
    buffer_load_dwordx4 v12, s[12:15], s24 offen offset:2048 lds
    s_add_u32 s24, s24, 110592
    s_cmp_eq_u32 s25, 1280
    s_cselect_b32 s25, 0, s25
    s_cselect_b32 s24, 0, s24
    v_mfma_f32_32x32x16_bf16 v[172:187], v[68:71], v[84:87], v[172:187]
    s_waitcnt lgkmcnt(5)
    v_mfma_f32_32x32x16_bf16 v[92:107], v[48:51], v[72:75], v[92:107]
    ds_read_b64_tr_b16 v[60:61], v14 offset:55296
    ds_read_b64_tr_b16 v[62:63], v14 offset:56832
    s_waitcnt lgkmcnt(6)
    v_mfma_f32_32x32x16_bf16 v[108:123], v[48:51], v[76:79], v[108:123]
    ds_read_b128 v[80:83], v21 offset:16384
    s_waitcnt lgkmcnt(5)
    v_mfma_f32_32x32x16_bf16 v[124:139], v[52:55], v[72:75], v[124:139]
    ds_read_b128 v[84:87], v21 offset:18432
    v_mfma_f32_32x32x16_bf16 v[140:155], v[52:55], v[76:79], v[140:155]
    ds_read_b64_tr_b16 v[64:65], v15 offset:55296
    ds_read_b64_tr_b16 v[66:67], v15 offset:56832
    s_waitcnt lgkmcnt(6)
    v_mfma_f32_32x32x16_bf16 v[156:171], v[56:59], v[72:75], v[156:171]
    ds_read_b64_tr_b16 v[68:69], v16 offset:55296
    ds_read_b64_tr_b16 v[70:71], v16 offset:56832
    v_mfma_f32_32x32x16_bf16 v[172:187], v[56:59], v[76:79], v[172:187]
    s_cmp_eq_u32 s23, s62
    s_cbranch_scc1 k1cs_47
k1cs_47_back:
    s_cmp_eq_u32 s23, 3
    s_cbranch_scc0 k1nl_48
    buffer_load_dword v24, off, s[76:79], 0 sc1
k1nl_48:
    s_waitcnt vmcnt(8)
    s_barrier
    s_cmp_eq_u32 s23, 1
    s_cbranch_scc1 k1dg_49
k1dg_49_back:
    s_waitcnt lgkmcnt(5)
    v_mfma_f32_32x32x16_bf16 v[92:107], v[60:63], v[80:83], v[92:107]
    ds_read_b64_tr_b16 v[48:49], v17 offset:0
    ds_read_b64_tr_b16 v[50:51], v17 offset:1536
    s_waitcnt lgkmcnt(6)
    v_mfma_f32_32x32x16_bf16 v[108:123], v[60:63], v[84:87], v[108:123]
    ds_read_b128 v[72:75], v20 offset:24576
    s_add_u32 m0, s28, 8192
    s_nop 0
    buffer_load_dwordx4 v13, s[8:11], s25 offen lds
    s_waitcnt lgkmcnt(5)
    v_mfma_f32_32x32x16_bf16 v[124:139], v[64:67], v[80:83], v[124:139]
    ds_read_b128 v[76:79], v20 offset:26624
    s_add_u32 m0, s27, 24576
    s_add_u32 s25, s25, 64
    buffer_load_dwordx4 v10, s[12:15], s24 offen lds
    v_mfma_f32_32x32x16_bf16 v[140:155], v[64:67], v[84:87], v[140:155]
    ds_read_b64_tr_b16 v[52:53], v18 offset:0
    ds_read_b64_tr_b16 v[54:55], v18 offset:1536
    buffer_load_dwordx4 v11, s[12:15], s24 offen offset:1024 lds
    s_waitcnt lgkmcnt(6)
    v_mfma_f32_32x32x16_bf16 v[156:171], v[68:71], v[80:83], v[156:171]
    ds_read_b64_tr_b16 v[56:57], v19 offset:0
    ds_read_b64_tr_b16 v[58:59], v19 offset:1536
    buffer_load_dwordx4 v12, s[12:15], s24 offen offset:2048 lds
    s_add_u32 s24, s24, 110592
    s_cmp_eq_u32 s25, 1280
    s_cselect_b32 s25, 0, s25
    s_cselect_b32 s24, 0, s24
    v_mfma_f32_32x32x16_bf16 v[172:187], v[68:71], v[84:87], v[172:187]
    s_waitcnt lgkmcnt(5)
    v_mfma_f32_32x32x16_bf16 v[92:107], v[48:51], v[72:75], v[92:107]
    ds_read_b64_tr_b16 v[60:61], v17 offset:6144
    ds_read_b64_tr_b16 v[62:63], v17 offset:7680
    s_waitcnt lgkmcnt(6)
    v_mfma_f32_32x32x16_bf16 v[108:123], v[48:51], v[76:79], v[108:123]
    ds_read_b128 v[80:83], v21 offset:24576
    s_waitcnt lgkmcnt(5)
    v_mfma_f32_32x32x16_bf16 v[124:139], v[52:55], v[72:75], v[124:139]
    ds_read_b128 v[84:87], v21 offset:26624
    v_mfma_f32_32x32x16_bf16 v[140:155], v[52:55], v[76:79], v[140:155]
    ds_read_b64_tr_b16 v[64:65], v18 offset:6144
    ds_read_b64_tr_b16 v[66:67], v18 offset:7680
    s_waitcnt lgkmcnt(6)
    v_mfma_f32_32x32x16_bf16 v[156:171], v[56:59], v[72:75], v[156:171]
    ds_read_b64_tr_b16 v[68:69], v19 offset:6144
    ds_read_b64_tr_b16 v[70:71], v19 offset:7680
    v_mfma_f32_32x32x16_bf16 v[172:187], v[56:59], v[76:79], v[172:187]
    s_cmp_eq_u32 s23, s63
    s_cbranch_scc1 k1cs_50
k1cs_50_back:
    s_waitcnt vmcnt(8)
    s_barrier
    s_waitcnt lgkmcnt(5)
    v_mfma_f32_32x32x16_bf16 v[92:107], v[60:63], v[80:83], v[92:107]
    ds_read_b64_tr_b16 v[48:49], v17 offset:24576
    ds_read_b64_tr_b16 v[50:51], v17 offset:26112
    s_waitcnt lgkmcnt(6)
    v_mfma_f32_32x32x16_bf16 v[108:123], v[60:63], v[84:87], v[108:123]
    ds_read_b128 v[72:75], v20 offset:32768
    s_add_u32 m0, s28, 16384
    s_nop 0
    buffer_load_dwordx4 v13, s[8:11], s25 offen lds
    s_waitcnt lgkmcnt(5)
    v_mfma_f32_32x32x16_bf16 v[124:139], v[64:67], v[80:83], v[124:139]
    ds_read_b128 v[76:79], v20 offset:34816
    s_add_u32 m0, s27, 49152
    s_add_u32 s25, s25, 64
    buffer_load_dwordx4 v10, s[12:15], s24 offen lds
    v_mfma_f32_32x32x16_bf16 v[140:155], v[64:67], v[84:87], v[140:155]
    ds_read_b64_tr_b16 v[52:53], v18 offset:24576
    ds_read_b64_tr_b16 v[54:55], v18 offset:26112
    buffer_load_dwordx4 v11, s[12:15], s24 offen offset:1024 lds
    s_waitcnt lgkmcnt(6)
    v_mfma_f32_32x32x16_bf16 v[156:171], v[68:71], v[80:83], v[156:171]
    ds_read_b64_tr_b16 v[56:57], v19 offset:24576
    ds_read_b64_tr_b16 v[58:59], v19 offset:26112
    buffer_load_dwordx4 v12, s[12:15], s24 offen offset:2048 lds
    s_add_u32 s24, s24, 110592
    s_cmp_eq_u32 s25, 1280
    s_cselect_b32 s25, 0, s25
    s_cselect_b32 s24, 0, s24
    v_mfma_f32_32x32x16_bf16 v[172:187], v[68:71], v[84:87], v[172:187]
    s_waitcnt lgkmcnt(5)
    v_mfma_f32_32x32x16_bf16 v[92:107], v[48:51], v[72:75], v[92:107]
    ds_read_b64_tr_b16 v[60:61], v17 offset:30720
    ds_read_b64_tr_b16 v[62:63], v17 offset:32256
    s_waitcnt lgkmcnt(6)
    v_mfma_f32_32x32x16_bf16 v[108:123], v[48:51], v[76:79], v[108:123]
    ds_read_b128 v[80:83], v21 offset:32768
    s_waitcnt lgkmcnt(5)
    v_mfma_f32_32x32x16_bf16 v[124:139], v[52:55], v[72:75], v[124:139]
    ds_read_b128 v[84:87], v21 offset:34816
    v_mfma_f32_32x32x16_bf16 v[140:155], v[52:55], v[76:79], v[140:155]
    ds_read_b64_tr_b16 v[64:65], v18 offset:30720
    ds_read_b64_tr_b16 v[66:67], v18 offset:32256
    s_waitcnt lgkmcnt(6)
    v_mfma_f32_32x32x16_bf16 v[156:171], v[56:59], v[72:75], v[156:171]
    ds_read_b64_tr_b16 v[68:69], v19 offset:30720
    ds_read_b64_tr_b16 v[70:71], v19 offset:32256
    v_mfma_f32_32x32x16_bf16 v[172:187], v[56:59], v[76:79], v[172:187]
    s_cmp_eq_u32 s23, s64
    s_cbranch_scc1 k1cs_51
k1cs_51_back:
    s_waitcnt vmcnt(8)
    s_barrier
    s_cmp_eq_u32 s23, 3
    s_cbranch_scc1 k1pub_52
k1pub_52_back:
    s_waitcnt lgkmcnt(5)
    v_mfma_f32_32x32x16_bf16 v[92:107], v[60:63], v[80:83], v[92:107]
    ds_read_b64_tr_b16 v[48:49], v14 offset:0
    ds_read_b64_tr_b16 v[50:51], v14 offset:1536
    s_waitcnt lgkmcnt(6)
    v_mfma_f32_32x32x16_bf16 v[108:123], v[60:63], v[84:87], v[108:123]
    ds_read_b128 v[72:75], v20 offset:0
    s_add_u32 m0, s28, 24576
    s_nop 0
    buffer_load_dwordx4 v13, s[8:11], s25 offen lds
    s_waitcnt lgkmcnt(5)
    v_mfma_f32_32x32x16_bf16 v[124:139], v[64:67], v[80:83], v[124:139]
    ds_read_b128 v[76:79], v20 offset:2048
    s_add_u32 m0, s27, 73728
    s_add_u32 s25, s25, 64
    buffer_load_dwordx4 v10, s[12:15], s24 offen lds
    v_mfma_f32_32x32x16_bf16 v[140:155], v[64:67], v[84:87], v[140:155]
    ds_read_b64_tr_b16 v[52:53], v15 offset:0
    ds_read_b64_tr_b16 v[54:55], v15 offset:1536
    buffer_load_dwordx4 v11, s[12:15], s24 offen offset:1024 lds
    s_waitcnt lgkmcnt(6)
    v_mfma_f32_32x32x16_bf16 v[156:171], v[68:71], v[80:83], v[156:171]
    ds_read_b64_tr_b16 v[56:57], v16 offset:0
    ds_read_b64_tr_b16 v[58:59], v16 offset:1536
    buffer_load_dwordx4 v12, s[12:15], s24 offen offset:2048 lds
    s_add_u32 s24, s24, 110592
    s_cmp_eq_u32 s25, 1280
    s_cselect_b32 s25, 0, s25
    s_cselect_b32 s24, 0, s24
    v_mfma_f32_32x32x16_bf16 v[172:187], v[68:71], v[84:87], v[172:187]
    s_sub_u32 s23, s23, 1
    s_cmp_lg_u32 s23, 0
    s_cbranch_scc1 k1_ffn_loop0
    s_waitcnt lgkmcnt(5)
    v_mfma_f32_32x32x16_bf16 v[92:107], v[48:51], v[72:75], v[92:107]
    ds_read_b64_tr_b16 v[60:61], v14 offset:6144
    ds_read_b64_tr_b16 v[62:63], v14 offset:7680
    s_waitcnt lgkmcnt(6)
    v_mfma_f32_32x32x16_bf16 v[108:123], v[48:51], v[76:79], v[108:123]
    ds_read_b128 v[80:83], v21 offset:0
    s_waitcnt lgkmcnt(5)
    v_mfma_f32_32x32x16_bf16 v[124:139], v[52:55], v[72:75], v[124:139]
    ds_read_b128 v[84:87], v21 offset:2048
    v_mfma_f32_32x32x16_bf16 v[140:155], v[52:55], v[76:79], v[140:155]
    ds_read_b64_tr_b16 v[64:65], v15 offset:6144
    ds_read_b64_tr_b16 v[66:67], v15 offset:7680
    s_waitcnt lgkmcnt(6)
    v_mfma_f32_32x32x16_bf16 v[156:171], v[56:59], v[72:75], v[156:171]
    ds_read_b64_tr_b16 v[68:69], v16 offset:6144
    ds_read_b64_tr_b16 v[70:71], v16 offset:7680
    v_mfma_f32_32x32x16_bf16 v[172:187], v[56:59], v[76:79], v[172:187]
    s_waitcnt vmcnt(8)
    s_barrier
    s_waitcnt lgkmcnt(5)
    v_mfma_f32_32x32x16_bf16 v[92:107], v[60:63], v[80:83], v[92:107]
    ds_read_b64_tr_b16 v[48:49], v14 offset:24576
    ds_read_b64_tr_b16 v[50:51], v14 offset:26112
    s_waitcnt lgkmcnt(6)
    v_mfma_f32_32x32x16_bf16 v[108:123], v[60:63], v[84:87], v[108:123]
    ds_read_b128 v[72:75], v20 offset:8192
    s_add_u32 m0, s28, 32768
    s_nop 0
    buffer_load_dwordx4 v13, s[8:11], s25 offen lds
    s_waitcnt lgkmcnt(5)
    v_mfma_f32_32x32x16_bf16 v[124:139], v[64:67], v[80:83], v[124:139]
    ds_read_b128 v[76:79], v20 offset:10240
    s_add_u32 m0, s27, 98304
    s_add_u32 s25, s25, 64
    buffer_load_dwordx4 v10, s[12:15], s24 offen lds
    v_mfma_f32_32x32x16_bf16 v[140:155], v[64:67], v[84:87], v[140:155]
    ds_read_b64_tr_b16 v[52:53], v15 offset:24576
    ds_read_b64_tr_b16 v[54:55], v15 offset:26112
    buffer_load_dwordx4 v11, s[12:15], s24 offen offset:1024 lds
    s_waitcnt lgkmcnt(6)
    v_mfma_f32_32x32x16_bf16 v[156:171], v[68:71], v[80:83], v[156:171]
    ds_read_b64_tr_b16 v[56:57], v16 offset:24576
    ds_read_b64_tr_b16 v[58:59], v16 offset:26112
    buffer_load_dwordx4 v12, s[12:15], s24 offen offset:2048 lds
    s_add_u32 s24, s24, 110592
    s_cmp_eq_u32 s25, 1280
    s_cselect_b32 s25, 0, s25
    s_cselect_b32 s24, 0, s24
    v_mfma_f32_32x32x16_bf16 v[172:187], v[68:71], v[84:87], v[172:187]
    s_waitcnt lgkmcnt(5)
    v_mfma_f32_32x32x16_bf16 v[92:107], v[48:51], v[72:75], v[92:107]
    ds_read_b64_tr_b16 v[60:61], v14 offset:30720
    ds_read_b64_tr_b16 v[62:63], v14 offset:32256
    s_waitcnt lgkmcnt(6)
    v_mfma_f32_32x32x16_bf16 v[108:123], v[48:51], v[76:79], v[108:123]
    ds_read_b128 v[80:83], v21 offset:8192
    s_waitcnt lgkmcnt(5)
    v_mfma_f32_32x32x16_bf16 v[124:139], v[52:55], v[72:75], v[124:139]
    ds_read_b128 v[84:87], v21 offset:10240
    v_mfma_f32_32x32x16_bf16 v[140:155], v[52:55], v[76:79], v[140:155]
    ds_read_b64_tr_b16 v[64:65], v15 offset:30720
    ds_read_b64_tr_b16 v[66:67], v15 offset:32256
    s_waitcnt lgkmcnt(6)
    v_mfma_f32_32x32x16_bf16 v[156:171], v[56:59], v[72:75], v[156:171]
    ds_read_b64_tr_b16 v[68:69], v16 offset:30720
    ds_read_b64_tr_b16 v[70:71], v16 offset:32256
    v_mfma_f32_32x32x16_bf16 v[172:187], v[56:59], v[76:79], v[172:187]
    s_waitcnt vmcnt(8)
    s_barrier
    s_waitcnt lgkmcnt(5)
    v_mfma_f32_32x32x16_bf16 v[92:107], v[60:63], v[80:83], v[92:107]
    ds_read_b64_tr_b16 v[48:49], v14 offset:49152
    ds_read_b64_tr_b16 v[50:51], v14 offset:50688
    s_waitcnt lgkmcnt(6)
    v_mfma_f32_32x32x16_bf16 v[108:123], v[60:63], v[84:87], v[108:123]
    ds_read_b128 v[72:75], v20 offset:16384
    s_waitcnt lgkmcnt(5)
    v_mfma_f32_32x32x16_bf16 v[124:139], v[64:67], v[80:83], v[124:139]
    ds_read_b128 v[76:79], v20 offset:18432
    v_mfma_f32_32x32x16_bf16 v[140:155], v[64:67], v[84:87], v[140:155]
    ds_read_b64_tr_b16 v[52:53], v15 offset:49152
    ds_read_b64_tr_b16 v[54:55], v15 offset:50688
    s_waitcnt lgkmcnt(6)
    v_mfma_f32_32x32x16_bf16 v[156:171], v[68:71], v[80:83], v[156:171]
    ds_read_b64_tr_b16 v[56:57], v16 offset:49152
    ds_read_b64_tr_b16 v[58:59], v16 offset:50688
    v_mfma_f32_32x32x16_bf16 v[172:187], v[68:71], v[84:87], v[172:187]
    s_waitcnt lgkmcnt(5)
    v_mfma_f32_32x32x16_bf16 v[92:107], v[48:51], v[72:75], v[92:107]
    ds_read_b64_tr_b16 v[60:61], v14 offset:55296
    ds_read_b64_tr_b16 v[62:63], v14 offset:56832
    s_waitcnt lgkmcnt(6)
    v_mfma_f32_32x32x16_bf16 v[108:123], v[48:51], v[76:79], v[108:123]
    ds_read_b128 v[80:83], v21 offset:16384
    s_waitcnt lgkmcnt(5)
    v_mfma_f32_32x32x16_bf16 v[124:139], v[52:55], v[72:75], v[124:139]
    ds_read_b128 v[84:87], v21 offset:18432
    v_mfma_f32_32x32x16_bf16 v[140:155], v[52:55], v[76:79], v[140:155]
    ds_read_b64_tr_b16 v[64:65], v15 offset:55296
    ds_read_b64_tr_b16 v[66:67], v15 offset:56832
    s_waitcnt lgkmcnt(6)
    v_mfma_f32_32x32x16_bf16 v[156:171], v[56:59], v[72:75], v[156:171]
    ds_read_b64_tr_b16 v[68:69], v16 offset:55296
    ds_read_b64_tr_b16 v[70:71], v16 offset:56832
    v_mfma_f32_32x32x16_bf16 v[172:187], v[56:59], v[76:79], v[172:187]
    s_waitcnt vmcnt(4)
    s_barrier
    s_waitcnt lgkmcnt(5)
    v_mfma_f32_32x32x16_bf16 v[92:107], v[60:63], v[80:83], v[92:107]
    ds_read_b64_tr_b16 v[48:49], v17 offset:0
    ds_read_b64_tr_b16 v[50:51], v17 offset:1536
    s_waitcnt lgkmcnt(6)
    v_mfma_f32_32x32x16_bf16 v[108:123], v[60:63], v[84:87], v[108:123]
    ds_read_b128 v[72:75], v20 offset:24576
    s_waitcnt lgkmcnt(5)
    v_mfma_f32_32x32x16_bf16 v[124:139], v[64:67], v[80:83], v[124:139]
    ds_read_b128 v[76:79], v20 offset:26624
    v_mfma_f32_32x32x16_bf16 v[140:155], v[64:67], v[84:87], v[140:155]
    ds_read_b64_tr_b16 v[52:53], v18 offset:0
    ds_read_b64_tr_b16 v[54:55], v18 offset:1536
    s_waitcnt lgkmcnt(6)
    v_mfma_f32_32x32x16_bf16 v[156:171], v[68:71], v[80:83], v[156:171]
    ds_read_b64_tr_b16 v[56:57], v19 offset:0
    ds_read_b64_tr_b16 v[58:59], v19 offset:1536
    v_mfma_f32_32x32x16_bf16 v[172:187], v[68:71], v[84:87], v[172:187]
    s_waitcnt lgkmcnt(5)
    v_mfma_f32_32x32x16_bf16 v[92:107], v[48:51], v[72:75], v[92:107]
    ds_read_b64_tr_b16 v[60:61], v17 offset:6144
    ds_read_b64_tr_b16 v[62:63], v17 offset:7680
    s_waitcnt lgkmcnt(6)
    v_mfma_f32_32x32x16_bf16 v[108:123], v[48:51], v[76:79], v[108:123]
    ds_read_b128 v[80:83], v21 offset:24576
    s_waitcnt lgkmcnt(5)
    v_mfma_f32_32x32x16_bf16 v[124:139], v[52:55], v[72:75], v[124:139]
    ds_read_b128 v[84:87], v21 offset:26624
    v_mfma_f32_32x32x16_bf16 v[140:155], v[52:55], v[76:79], v[140:155]
    ds_read_b64_tr_b16 v[64:65], v18 offset:6144
    ds_read_b64_tr_b16 v[66:67], v18 offset:7680
    s_waitcnt lgkmcnt(6)
    v_mfma_f32_32x32x16_bf16 v[156:171], v[56:59], v[72:75], v[156:171]
    ds_read_b64_tr_b16 v[68:69], v19 offset:6144
    ds_read_b64_tr_b16 v[70:71], v19 offset:7680
    v_mfma_f32_32x32x16_bf16 v[172:187], v[56:59], v[76:79], v[172:187]
    v_lshlrev_b32 v3, 1, v25
    v_lshlrev_b32 v4, 2, v26
    s_mul_i32 s4, s21, 3072
    s_lshl_b32 s5, s20, 11
    s_add_u32 s5, s5, 65536
    buffer_load_dwordx2 v[22:23], v3, s[72:75], s4 offen sc1
    buffer_load_dwordx4 v[28:31], v4, s[72:75], s5 offen sc1
    s_waitcnt vmcnt(2)
    s_barrier
    s_waitcnt lgkmcnt(5)
    v_mfma_f32_32x32x16_bf16 v[92:107], v[60:63], v[80:83], v[92:107]
    ds_read_b64_tr_b16 v[48:49], v17 offset:24576
    ds_read_b64_tr_b16 v[50:51], v17 offset:26112
    s_waitcnt lgkmcnt(6)
    v_mfma_f32_32x32x16_bf16 v[108:123], v[60:63], v[84:87], v[108:123]
    ds_read_b128 v[72:75], v20 offset:32768
    s_waitcnt lgkmcnt(5)
    v_mfma_f32_32x32x16_bf16 v[124:139], v[64:67], v[80:83], v[124:139]
    ds_read_b128 v[76:79], v20 offset:34816
    v_mfma_f32_32x32x16_bf16 v[140:155], v[64:67], v[84:87], v[140:155]
    ds_read_b64_tr_b16 v[52:53], v18 offset:24576
    ds_read_b64_tr_b16 v[54:55], v18 offset:26112
    s_waitcnt lgkmcnt(6)
    v_mfma_f32_32x32x16_bf16 v[156:171], v[68:71], v[80:83], v[156:171]
    ds_read_b64_tr_b16 v[56:57], v19 offset:24576
    ds_read_b64_tr_b16 v[58:59], v19 offset:26112
    v_mfma_f32_32x32x16_bf16 v[172:187], v[68:71], v[84:87], v[172:187]
    s_waitcnt lgkmcnt(5)
    v_mfma_f32_32x32x16_bf16 v[92:107], v[48:51], v[72:75], v[92:107]
    ds_read_b64_tr_b16 v[60:61], v17 offset:30720
    ds_read_b64_tr_b16 v[62:63], v17 offset:32256
    s_waitcnt lgkmcnt(6)
    v_mfma_f32_32x32x16_bf16 v[108:123], v[48:51], v[76:79], v[108:123]
    ds_read_b128 v[80:83], v21 offset:32768
    s_waitcnt lgkmcnt(5)
    v_mfma_f32_32x32x16_bf16 v[124:139], v[52:55], v[72:75], v[124:139]
    ds_read_b128 v[84:87], v21 offset:34816
    v_mfma_f32_32x32x16_bf16 v[140:155], v[52:55], v[76:79], v[140:155]
    ds_read_b64_tr_b16 v[64:65], v18 offset:30720
    ds_read_b64_tr_b16 v[66:67], v18 offset:32256
    s_waitcnt lgkmcnt(6)
    v_mfma_f32_32x32x16_bf16 v[156:171], v[56:59], v[72:75], v[156:171]
    ds_read_b64_tr_b16 v[68:69], v19 offset:30720
    ds_read_b64_tr_b16 v[70:71], v19 offset:32256
    v_mfma_f32_32x32x16_bf16 v[172:187], v[56:59], v[76:79], v[172:187]
    s_waitcnt lgkmcnt(5)
    v_mfma_f32_32x32x16_bf16 v[92:107], v[60:63], v[80:83], v[92:107]
    s_waitcnt lgkmcnt(4)
    v_mfma_f32_32x32x16_bf16 v[108:123], v[60:63], v[84:87], v[108:123]
    s_waitcnt lgkmcnt(2)
    v_mfma_f32_32x32x16_bf16 v[124:139], v[64:67], v[80:83], v[124:139]
    s_waitcnt vmcnt(0)
    v_cmp_ne_u32 vcc, s29, v23
    v_cmp_ne_u32 s[6:7], s29, v30
    s_nop 1
    s_or_b64 vcc, vcc, s[6:7]
    s_cbranch_vccnz k1retry_53
k1back_54:
    ds_write_b32 v25, v22 offset:0
    ds_write_b32 v26, v28 offset:1536
    ds_write_b32 v26, v29 offset:2048
    v_mfma_f32_32x32x16_bf16 v[140:155], v[64:67], v[84:87], v[140:155]
    s_waitcnt lgkmcnt(3)
    v_mfma_f32_32x32x16_bf16 v[156:171], v[68:71], v[80:83], v[156:171]
    v_mfma_f32_32x32x16_bf16 v[172:187], v[68:71], v[84:87], v[172:187]
    s_waitcnt lgkmcnt(0)
    s_barrier
    s_branch k1_ffn_epi
k1retry_53:
    s_mov_b32 s23, 200000
k1retry_53_l:
    s_sleep 2
    v_lshlrev_b32 v3, 1, v25
    v_lshlrev_b32 v4, 2, v26
    s_mul_i32 s4, s21, 3072
    s_lshl_b32 s5, s20, 11
    s_add_u32 s5, s5, 65536
    buffer_load_dwordx2 v[22:23], v3, s[72:75], s4 offen sc1
    buffer_load_dwordx4 v[28:31], v4, s[72:75], s5 offen sc1
    s_waitcnt vmcnt(0)
    v_cmp_ne_u32 vcc, s29, v23
    v_cmp_ne_u32 s[6:7], s29, v30
    s_nop 1
    s_or_b64 vcc, vcc, s[6:7]
    s_cbranch_vccz k1back_54
    s_sub_u32 s23, s23, 1
    s_cmp_lg_u32 s23, 0
    s_cbranch_scc1 k1retry_53_l
    s_branch k1back_54
k1cs_44:
    s_waitcnt lgkmcnt(0)
    s_bitcmp1_b32 s26, 0
    s_cbranch_scc0 k1cs_44_s0
    v_mfma_f32_16x16x32_bf16 v[36:39], v[32:35], v[48:51], v[36:39]
    v_mfma_f32_16x16x32_bf16 v[36:39], v[32:35], v[60:63], v[36:39]
k1cs_44_s0:
    s_bitcmp1_b32 s26, 1
    s_cbranch_scc0 k1cs_44_s1
    v_mfma_f32_16x16x32_bf16 v[40:43], v[32:35], v[52:55], v[40:43]
    v_mfma_f32_16x16x32_bf16 v[40:43], v[32:35], v[64:67], v[40:43]
k1cs_44_s1:
    s_bitcmp1_b32 s26, 2
    s_cbranch_scc0 k1cs_44_s2
    v_mfma_f32_16x16x32_bf16 v[44:47], v[32:35], v[56:59], v[44:47]
    v_mfma_f32_16x16x32_bf16 v[44:47], v[32:35], v[68:71], v[44:47]
k1cs_44_s2:
    s_branch k1cs_44_back
k1dg_45:
    s_cmp_ge_u32 s22, 3
    s_cbranch_scc1 k1dg_45_back
    v_lshrrev_b32 v2, 4, v1
    s_lshl_b32 s4, s22, 2
    v_add_u32 v2, s4, v2
    v_min_u32 v2, 11, v2
    s_mul_i32 s4, s20, 12
    v_add_u32 v2, s4, v2
    v_and_b32 v3, 15, v1
    v_mul_u32_u24 v3, 3072, v3
    v_lshl_add_u32 v3, v2, 4, v3
    s_mul_i32 s5, s21, 49152
    s_add_u32 s5, s5, 131072
    buffer_load_dwordx4 v[28:31], v3, s[72:75], s5 offen sc1
    s_branch k1dg_45_back
k1cs_46:
    s_waitcnt lgkmcnt(0)
    s_bitcmp1_b32 s26, 0
    s_cbranch_scc0 k1cs_46_s0
    v_mfma_f32_16x16x32_bf16 v[36:39], v[32:35], v[48:51], v[36:39]
    v_mfma_f32_16x16x32_bf16 v[36:39], v[32:35], v[60:63], v[36:39]
k1cs_46_s0:
    s_bitcmp1_b32 s26, 1
    s_cbranch_scc0 k1cs_46_s1
    v_mfma_f32_16x16x32_bf16 v[40:43], v[32:35], v[52:55], v[40:43]
    v_mfma_f32_16x16x32_bf16 v[40:43], v[32:35], v[64:67], v[40:43]
k1cs_46_s1:
    s_bitcmp1_b32 s26, 2
    s_cbranch_scc0 k1cs_46_s2
    v_mfma_f32_16x16x32_bf16 v[44:47], v[32:35], v[56:59], v[44:47]
    v_mfma_f32_16x16x32_bf16 v[44:47], v[32:35], v[68:71], v[44:47]
k1cs_46_s2:
    s_branch k1cs_46_back
k1cs_47:
    s_waitcnt lgkmcnt(0)
    s_bitcmp1_b32 s26, 0
    s_cbranch_scc0 k1cs_47_s0
    v_mfma_f32_16x16x32_bf16 v[36:39], v[32:35], v[48:51], v[36:39]
    v_mfma_f32_16x16x32_bf16 v[36:39], v[32:35], v[60:63], v[36:39]
k1cs_47_s0:
    s_bitcmp1_b32 s26, 1
    s_cbranch_scc0 k1cs_47_s1
    v_mfma_f32_16x16x32_bf16 v[40:43], v[32:35], v[52:55], v[40:43]
    v_mfma_f32_16x16x32_bf16 v[40:43], v[32:35], v[64:67], v[40:43]
k1cs_47_s1:
    s_bitcmp1_b32 s26, 2
    s_cbranch_scc0 k1cs_47_s2
    v_mfma_f32_16x16x32_bf16 v[44:47], v[32:35], v[56:59], v[44:47]
    v_mfma_f32_16x16x32_bf16 v[44:47], v[32:35], v[68:71], v[44:47]
k1cs_47_s2:
    s_branch k1cs_47_back
k1dg_49:
    s_cmp_ge_u32 s22, 3
    s_cbranch_scc1 k1dg_49_back
    s_mov_b32 s4, 200000
k1dg_49_l:
    v_cmp_ne_u32 vcc, s29, v30
    s_nop 1
    s_cbranch_vccz k1dg_49_ok
    s_sleep 2
    s_mul_i32 s5, s21, 49152
    s_add_u32 s5, s5, 131072
    buffer_load_dwordx4 v[28:31], v3, s[72:75], s5 offen sc1
    s_waitcnt vmcnt(0)
    s_sub_u32 s4, s4, 1
    s_cmp_lg_u32 s4, 0
    s_cbranch_scc1 k1dg_49_l
k1dg_49_ok:
    s_nop 1
    v_add_f32_dpp v28, v28, v28 row_ror:8 row_mask:0xf bank_mask:0xf
    v_add_f32_dpp v29, v29, v29 row_ror:8 row_mask:0xf bank_mask:0xf
    s_nop 1
    v_add_f32_dpp v28, v28, v28 row_ror:4 row_mask:0xf bank_mask:0xf
    v_add_f32_dpp v29, v29, v29 row_ror:4 row_mask:0xf bank_mask:0xf
    s_nop 1
    v_add_f32_dpp v28, v28, v28 row_ror:2 row_mask:0xf bank_mask:0xf
    v_add_f32_dpp v29, v29, v29 row_ror:2 row_mask:0xf bank_mask:0xf
    s_nop 1
    v_add_f32_dpp v28, v28, v28 row_ror:1 row_mask:0xf bank_mask:0xf
    v_add_f32_dpp v29, v29, v29 row_ror:1 row_mask:0xf bank_mask:0xf
    v_lshrrev_b32 v4, 4, v2
    v_and_b32 v5, 15, v2
    v_lshlrev_b32 v5, 3, v5
    v_lshl_add_u32 v5, v4, 8, v5
    v_mov_b32 v30, v29
    v_mov_b32 v29, s29
    v_mov_b32 v31, s29
    s_mul_i32 s4, s21, 3072
    s_mov_b32 exec_lo, 0x00010001
    s_mov_b32 exec_hi, 0x00010001
    buffer_store_dwordx2 v[28:29], v5, s[72:75], s4 offen sc1
    buffer_store_dwordx2 v[30:31], v5, s[72:75], s4 offen offset:128 sc1
    s_mov_b64 exec, -1
    s_branch k1dg_49_back
k1cs_50:
    s_waitcnt lgkmcnt(0)
    s_bitcmp1_b32 s26, 0
    s_cbranch_scc0 k1cs_50_s0
    v_mfma_f32_16x16x32_bf16 v[36:39], v[32:35], v[48:51], v[36:39]
    v_mfma_f32_16x16x32_bf16 v[36:39], v[32:35], v[60:63], v[36:39]
k1cs_50_s0:
    s_bitcmp1_b32 s26, 1
    s_cbranch_scc0 k1cs_50_s1
    v_mfma_f32_16x16x32_bf16 v[40:43], v[32:35], v[52:55], v[40:43]
    v_mfma_f32_16x16x32_bf16 v[40:43], v[32:35], v[64:67], v[40:43]
k1cs_50_s1:
    s_bitcmp1_b32 s26, 2
    s_cbranch_scc0 k1cs_50_s2
    v_mfma_f32_16x16x32_bf16 v[44:47], v[32:35], v[56:59], v[44:47]
    v_mfma_f32_16x16x32_bf16 v[44:47], v[32:35], v[68:71], v[44:47]
k1cs_50_s2:
    s_branch k1cs_50_back
k1cs_51:
    s_waitcnt lgkmcnt(0)
    s_bitcmp1_b32 s26, 0
    s_cbranch_scc0 k1cs_51_s0
    v_mfma_f32_16x16x32_bf16 v[36:39], v[32:35], v[48:51], v[36:39]
    v_mfma_f32_16x16x32_bf16 v[36:39], v[32:35], v[60:63], v[36:39]
k1cs_51_s0:
    s_bitcmp1_b32 s26, 1
    s_cbranch_scc0 k1cs_51_s1
    v_mfma_f32_16x16x32_bf16 v[40:43], v[32:35], v[52:55], v[40:43]
    v_mfma_f32_16x16x32_bf16 v[40:43], v[32:35], v[64:67], v[40:43]
k1cs_51_s1:
    s_bitcmp1_b32 s26, 2
    s_cbranch_scc0 k1cs_51_s2
    v_mfma_f32_16x16x32_bf16 v[44:47], v[32:35], v[56:59], v[44:47]
    v_mfma_f32_16x16x32_bf16 v[44:47], v[32:35], v[68:71], v[44:47]
k1cs_51_s2:
    s_branch k1cs_51_back
k1pub_52:
    s_nop 7
    s_mov_b32 s4, 200000
k1pub_52_n:
    v_readfirstlane_b32 s29, v24
    s_cmp_lg_u32 s29, 0
    s_cbranch_scc1 k1pub_52_ok
    s_sleep 2
    buffer_load_dword v24, off, s[76:79], 0 sc1
    s_waitcnt vmcnt(0)
    s_sub_u32 s4, s4, 1
    s_cmp_lg_u32 s4, 0
    s_cbranch_scc1 k1pub_52_n
k1pub_52_ok:
    s_mov_b64 exec, 0xffff
    s_bitcmp1_b32 s26, 0
    s_cbranch_scc0 k1pub_52_s0
    v_mov_b32 v38, s29
    v_mov_b32 v39, s29
    buffer_store_dwordx4 v[36:39], v27, s[72:75], s30 offen offset:0 sc1
k1pub_52_s0:
    s_bitcmp1_b32 s26, 1
    s_cbranch_scc0 k1pub_52_s1
    v_mov_b32 v42, s29
    v_mov_b32 v43, s29
    buffer_store_dwordx4 v[40:43], v27, s[72:75], s30 offen offset:256 sc1
k1pub_52_s1:
    s_bitcmp1_b32 s26, 2
    s_cbranch_scc0 k1pub_52_s2
    v_mov_b32 v46, s29
    v_mov_b32 v47, s29
    buffer_store_dwordx4 v[44:47], v27, s[72:75], s30 offen offset:512 sc1
k1pub_52_s2:
    s_mov_b64 exec, -1
    s_branch k1pub_52_back
k1_ffn_v1:
    s_add_u32 m0, s28, 0
    s_nop 0
    buffer_load_dwordx4 v13, s[8:11], s25 offen lds
    s_add_u32 m0, s27, 0
    s_add_u32 s25, s25, 64
    buffer_load_dwordx4 v10, s[12:15], s24 offen lds
    buffer_load_dwordx4 v11, s[12:15], s24 offen offset:1024 lds
    buffer_load_dwordx4 v12, s[12:15], s24 offen offset:2048 lds
    s_add_u32 s24, s24, 110592
    s_cmp_eq_u32 s25, 1280
    s_cselect_b32 s25, 0, s25
    s_cselect_b32 s24, 0, s24
    v_lshrrev_b32 v2, 4, v1
    v_bfe_u32 v3, v1, 2, 2
    v_and_b32 v4, 3, v1
    v_bfe_u32 v5, v1, 3, 1
    v_lshrrev_b32 v6, 1, v2
    v_lshl_add_u32 v6, v6, 3, v3
    v_mul_u32_u24 v6, 384, v6
    v_and_b32 v7, 1, v2
    v_mul_u32_u24 v8, 12288, v7
    v_add_u32 v6, v6, v8
    v_and_b32 v8, 1, v4
    v_lshl_add_u32 v6, v8, 3, v6
    v_lshlrev_b32 v7, 2, v7
    v_lshl_add_u32 v7, v5, 1, v7
    v_lshrrev_b32 v8, 1, v4
    s_mul_i32 s4, s37, 6
    v_add3_u32 v9, v8, s4, 0
    v_xor_b32 v9, v9, v7
    v_lshl_add_u32 v14, v9, 4, v6
    v_add_u32 v17, 73728, v14
    v_add3_u32 v9, v8, s4, 2
    v_xor_b32 v9, v9, v7
    v_lshl_add_u32 v15, v9, 4, v6
    v_add_u32 v18, 73728, v15
    v_add3_u32 v9, v8, s4, 4
    v_xor_b32 v9, v9, v7
    v_lshl_add_u32 v16, v9, 4, v6
    v_add_u32 v19, 73728, v16
    v_and_b32 v2, 31, v1
    v_bfe_u32 v3, v1, 2, 2
    v_lshrrev_b32 v4, 5, v1
    s_lshl_b32 s5, s36, 12
    s_add_u32 s5, s5, 122880
    v_lshlrev_b32 v2, 6, v2
    v_add_u32 v2, s5, v2
    v_xor_b32 v5, v4, v3
    v_lshl_add_u32 v20, v5, 4, v2
    v_xor_b32 v21, 32, v20
    v_min_u32 v2, 383, v0
    v_lshlrev_b32 v25, 2, v2
    v_and_b32 v2, 127, v0
    v_lshlrev_b32 v26, 2, v2
    v_and_b32 v2, 15, v1
    v_lshlrev_b32 v27, 4, v2
    v_and_b32 v2, 31, v1
    v_mov_b32 v3, 0x3f803f80
    v_cmp_eq_u32 vcc, 0, v2
    v_cmp_eq_u32 s[4:5], 17, v2
    s_nop 1
    s_or_b64 vcc, vcc, s[4:5]
    s_nop 1
    v_cndmask_b32 v32, 0, v3, vcc
    v_mov_b32 v33, v32
    v_mov_b32 v34, v32
    s_add_u32 m0, s28, 8192
    s_nop 0
    buffer_load_dwordx4 v13, s[8:11], s25 offen lds
    s_add_u32 m0, s27, 24576
    s_add_u32 s25, s25, 64
    buffer_load_dwordx4 v10, s[12:15], s24 offen lds
    buffer_load_dwordx4 v11, s[12:15], s24 offen offset:1024 lds
    buffer_load_dwordx4 v12, s[12:15], s24 offen offset:2048 lds
    s_add_u32 s24, s24, 110592
    s_cmp_eq_u32 s25, 1280
    s_cselect_b32 s25, 0, s25
    s_cselect_b32 s24, 0, s24
    v_mov_b32 v35, v32
    v_mov_b32 v36, 0
    v_mov_b32 v37, 0
    v_mov_b32 v38, 0
    v_mov_b32 v39, 0
    v_mov_b32 v40, 0
    v_mov_b32 v41, 0
    v_mov_b32 v42, 0
    v_mov_b32 v43, 0
    v_mov_b32 v44, 0
    v_mov_b32 v45, 0
    v_mov_b32 v46, 0
    v_mov_b32 v47, 0
    v_mov_b32 v92, 0
    v_mov_b32 v93, 0
    v_mov_b32 v94, 0
    v_mov_b32 v95, 0
    v_mov_b32 v96, 0
    v_mov_b32 v97, 0
    v_mov_b32 v98, 0
    v_mov_b32 v99, 0
    v_mov_b32 v100, 0
    v_mov_b32 v101, 0
    v_mov_b32 v102, 0
    v_mov_b32 v103, 0
    v_mov_b32 v104, 0
    v_mov_b32 v105, 0
    v_mov_b32 v106, 0
    v_mov_b32 v107, 0
    v_mov_b32 v108, 0
    v_mov_b32 v109, 0
    v_mov_b32 v110, 0
    v_mov_b32 v111, 0
    v_mov_b32 v112, 0
    v_mov_b32 v113, 0
    v_mov_b32 v114, 0
    v_mov_b32 v115, 0
    v_mov_b32 v116, 0
    v_mov_b32 v117, 0
    v_mov_b32 v118, 0
    v_mov_b32 v119, 0
    v_mov_b32 v120, 0
    v_mov_b32 v121, 0
    v_mov_b32 v122, 0
    v_mov_b32 v123, 0
    v_mov_b32 v124, 0
    v_mov_b32 v125, 0
    v_mov_b32 v126, 0
    v_mov_b32 v127, 0
    v_mov_b32 v128, 0
    v_mov_b32 v129, 0
    v_mov_b32 v130, 0
    v_mov_b32 v131, 0
    v_mov_b32 v132, 0
    s_add_u32 m0, s28, 16384
    s_nop 0
    buffer_load_dwordx4 v13, s[8:11], s25 offen lds
    s_add_u32 m0, s27, 49152
    s_add_u32 s25, s25, 64
    buffer_load_dwordx4 v10, s[12:15], s24 offen lds
    buffer_load_dwordx4 v11, s[12:15], s24 offen offset:1024 lds
    buffer_load_dwordx4 v12, s[12:15], s24 offen offset:2048 lds
    s_add_u32 s24, s24, 110592
    s_cmp_eq_u32 s25, 1280
    s_cselect_b32 s25, 0, s25
    s_cselect_b32 s24, 0, s24
    v_mov_b32 v133, 0
    v_mov_b32 v134, 0
    v_mov_b32 v135, 0
    v_mov_b32 v136, 0
    v_mov_b32 v137, 0
    v_mov_b32 v138, 0
    v_mov_b32 v139, 0
    v_mov_b32 v140, 0
    v_mov_b32 v141, 0
    v_mov_b32 v142, 0
    v_mov_b32 v143, 0
    v_mov_b32 v144, 0
    v_mov_b32 v145, 0
    v_mov_b32 v146, 0
    v_mov_b32 v147, 0
    v_mov_b32 v148, 0
    v_mov_b32 v149, 0
    v_mov_b32 v150, 0
    v_mov_b32 v151, 0
    v_mov_b32 v152, 0
    v_mov_b32 v153, 0
    v_mov_b32 v154, 0
    v_mov_b32 v155, 0
    v_mov_b32 v156, 0
    v_mov_b32 v157, 0
    v_mov_b32 v158, 0
    v_mov_b32 v159, 0
    v_mov_b32 v160, 0
    v_mov_b32 v161, 0
    v_mov_b32 v162, 0
    v_mov_b32 v163, 0
    v_mov_b32 v164, 0
    v_mov_b32 v165, 0
    v_mov_b32 v166, 0
    v_mov_b32 v167, 0
    v_mov_b32 v168, 0
    v_mov_b32 v169, 0
    v_mov_b32 v170, 0
    v_mov_b32 v171, 0
    v_mov_b32 v172, 0
    v_mov_b32 v173, 0
    v_mov_b32 v174, 0
    v_mov_b32 v175, 0
    v_mov_b32 v176, 0
    v_mov_b32 v177, 0
    v_mov_b32 v178, 0
    v_mov_b32 v179, 0
    v_mov_b32 v180, 0
    v_mov_b32 v181, 0
    v_mov_b32 v182, 0
    v_mov_b32 v183, 0
    v_mov_b32 v184, 0
    v_mov_b32 v185, 0
    v_mov_b32 v186, 0
    v_mov_b32 v187, 0
    s_mov_b32 s76, s56
    s_mov_b32 s77, s57
    s_mov_b32 s78, 0x100
    s_mov_b32 s79, 0x00020000
    s_add_u32 s72, s58, 0x1800000
    s_addc_u32 s73, s59, 0
    s_mov_b32 s74, 0x100000
    s_mov_b32 s75, 0x00020000
    s_waitcnt vmcnt(8)
    s_barrier
    ds_read_b64_tr_b16 v[48:49], v14 offset:0
    ds_read_b64_tr_b16 v[50:51], v14 offset:1536
    ds_read_b128 v[72:75], v20 offset:0
    ds_read_b128 v[76:79], v20 offset:2048
    ds_read_b64_tr_b16 v[52:53], v15 offset:0
    ds_read_b64_tr_b16 v[54:55], v15 offset:1536
    ds_read_b64_tr_b16 v[56:57], v16 offset:0
    ds_read_b64_tr_b16 v[58:59], v16 offset:1536
    s_mov_b32 s23, 3
    s_setprio 1
k1_ffn_loop1:
    s_waitcnt lgkmcnt(5)
    v_mfma_f32_32x32x16_bf16 v[92:107], v[48:51], v[72:75], v[92:107]
    ds_read_b64_tr_b16 v[60:61], v14 offset:6144
    ds_read_b64_tr_b16 v[62:63], v14 offset:7680
    s_waitcnt lgkmcnt(6)
    v_mfma_f32_32x32x16_bf16 v[108:123], v[48:51], v[76:79], v[108:123]
    ds_read_b128 v[80:83], v21 offset:0
    s_add_u32 m0, s28, 24576
    s_nop 0
    buffer_load_dwordx4 v13, s[8:11], s25 offen lds
    s_waitcnt lgkmcnt(5)
    v_mfma_f32_32x32x16_bf16 v[124:139], v[52:55], v[72:75], v[124:139]
    ds_read_b128 v[84:87], v21 offset:2048
    s_add_u32 m0, s27, 73728
    s_add_u32 s25, s25, 64
    buffer_load_dwordx4 v10, s[12:15], s24 offen lds
    v_mfma_f32_32x32x16_bf16 v[140:155], v[52:55], v[76:79], v[140:155]
    ds_read_b64_tr_b16 v[64:65], v15 offset:6144
    ds_read_b64_tr_b16 v[66:67], v15 offset:7680
    buffer_load_dwordx4 v11, s[12:15], s24 offen offset:1024 lds
    s_waitcnt lgkmcnt(6)
    v_mfma_f32_32x32x16_bf16 v[156:171], v[56:59], v[72:75], v[156:171]
    ds_read_b64_tr_b16 v[68:69], v16 offset:6144
    ds_read_b64_tr_b16 v[70:71], v16 offset:7680
    buffer_load_dwordx4 v12, s[12:15], s24 offen offset:2048 lds
    s_add_u32 s24, s24, 110592
    s_cmp_eq_u32 s25, 1280
    s_cselect_b32 s25, 0, s25
    s_cselect_b32 s24, 0, s24
    v_mfma_f32_32x32x16_bf16 v[172:187], v[56:59], v[76:79], v[172:187]
    s_cmp_eq_u32 s23, s60
    s_cbranch_scc1 k1cs_55
k1cs_55_back:
    s_waitcnt vmcnt(8)
    s_barrier
    s_waitcnt lgkmcnt(5)
    v_mfma_f32_32x32x16_bf16 v[92:107], v[60:63], v[80:83], v[92:107]
    ds_read_b64_tr_b16 v[48:49], v14 offset:24576
    ds_read_b64_tr_b16 v[50:51], v14 offset:26112
    s_waitcnt lgkmcnt(6)
    v_mfma_f32_32x32x16_bf16 v[108:123], v[60:63], v[84:87], v[108:123]
    ds_read_b128 v[72:75], v20 offset:8192
    s_waitcnt lgkmcnt(5)
    v_mfma_f32_32x32x16_bf16 v[124:139], v[64:67], v[80:83], v[124:139]
    ds_read_b128 v[76:79], v20 offset:10240
    v_mfma_f32_32x32x16_bf16 v[140:155], v[64:67], v[84:87], v[140:155]
    ds_read_b64_tr_b16 v[52:53], v15 offset:24576
    ds_read_b64_tr_b16 v[54:55], v15 offset:26112
    s_waitcnt lgkmcnt(6)
    v_mfma_f32_32x32x16_bf16 v[156:171], v[68:71], v[80:83], v[156:171]
    ds_read_b64_tr_b16 v[56:57], v16 offset:24576
    ds_read_b64_tr_b16 v[58:59], v16 offset:26112
    v_mfma_f32_32x32x16_bf16 v[172:187], v[68:71], v[84:87], v[172:187]
    s_waitcnt lgkmcnt(5)
    v_mfma_f32_32x32x16_bf16 v[92:107], v[48:51], v[72:75], v[92:107]
    ds_read_b64_tr_b16 v[60:61], v14 offset:30720
    ds_read_b64_tr_b16 v[62:63], v14 offset:32256
    s_waitcnt lgkmcnt(6)
    v_mfma_f32_32x32x16_bf16 v[108:123], v[48:51], v[76:79], v[108:123]
    ds_read_b128 v[80:83], v21 offset:8192
    s_add_u32 m0, s28, 32768
    s_nop 0
    buffer_load_dwordx4 v13, s[8:11], s25 offen lds
    s_waitcnt lgkmcnt(5)
    v_mfma_f32_32x32x16_bf16 v[124:139], v[52:55], v[72:75], v[124:139]
    ds_read_b128 v[84:87], v21 offset:10240
    s_add_u32 m0, s27, 98304
    s_add_u32 s25, s25, 64
    buffer_load_dwordx4 v10, s[12:15], s24 offen lds
    v_mfma_f32_32x32x16_bf16 v[140:155], v[52:55], v[76:79], v[140:155]
    ds_read_b64_tr_b16 v[64:65], v15 offset:30720
    ds_read_b64_tr_b16 v[66:67], v15 offset:32256
    buffer_load_dwordx4 v11, s[12:15], s24 offen offset:1024 lds
    s_waitcnt lgkmcnt(6)
    v_mfma_f32_32x32x16_bf16 v[156:171], v[56:59], v[72:75], v[156:171]
    ds_read_b64_tr_b16 v[68:69], v16 offset:30720
    ds_read_b64_tr_b16 v[70:71], v16 offset:32256
    buffer_load_dwordx4 v12, s[12:15], s24 offen offset:2048 lds
    s_add_u32 s24, s24, 110592
    s_cmp_eq_u32 s25, 1280
    s_cselect_b32 s25, 0, s25
    s_cselect_b32 s24, 0, s24
    v_mfma_f32_32x32x16_bf16 v[172:187], v[56:59], v[76:79], v[172:187]
    s_cmp_eq_u32 s23, s61
    s_cbranch_scc1 k1cs_56
k1cs_56_back:
    s_waitcnt vmcnt(8)
    s_barrier
    s_waitcnt lgkmcnt(5)
    v_mfma_f32_32x32x16_bf16 v[92:107], v[60:63], v[80:83], v[92:107]
    ds_read_b64_tr_b16 v[48:49], v14 offset:49152
    ds_read_b64_tr_b16 v[50:51], v14 offset:50688
    s_waitcnt lgkmcnt(6)
    v_mfma_f32_32x32x16_bf16 v[108:123], v[60:63], v[84:87], v[108:123]
    ds_read_b128 v[72:75], v20 offset:16384
    s_waitcnt lgkmcnt(5)
    v_mfma_f32_32x32x16_bf16 v[124:139], v[64:67], v[80:83], v[124:139]
    ds_read_b128 v[76:79], v20 offset:18432
    v_mfma_f32_32x32x16_bf16 v[140:155], v[64:67], v[84:87], v[140:155]
    ds_read_b64_tr_b16 v[52:53], v15 offset:49152
    ds_read_b64_tr_b16 v[54:55], v15 offset:50688
    s_waitcnt lgkmcnt(6)
    v_mfma_f32_32x32x16_bf16 v[156:171], v[68:71], v[80:83], v[156:171]
    ds_read_b64_tr_b16 v[56:57], v16 offset:49152
    ds_read_b64_tr_b16 v[58:59], v16 offset:50688
    v_mfma_f32_32x32x16_bf16 v[172:187], v[68:71], v[84:87], v[172:187]
    s_waitcnt lgkmcnt(5)
    v_mfma_f32_32x32x16_bf16 v[92:107], v[48:51], v[72:75], v[92:107]
    ds_read_b64_tr_b16 v[60:61], v14 offset:55296
    ds_read_b64_tr_b16 v[62:63], v14 offset:56832
    s_waitcnt lgkmcnt(6)
    v_mfma_f32_32x32x16_bf16 v[108:123], v[48:51], v[76:79], v[108:123]
    ds_read_b128 v[80:83], v21 offset:16384
    s_add_u32 m0, s28, 0
    s_nop 0
    buffer_load_dwordx4 v13, s[8:11], s25 offen lds
    s_waitcnt lgkmcnt(5)
    v_mfma_f32_32x32x16_bf16 v[124:139], v[52:55], v[72:75], v[124:139]
    ds_read_b128 v[84:87], v21 offset:18432
    s_add_u32 m0, s27, 0
    s_add_u32 s25, s25, 64
    buffer_load_dwordx4 v10, s[12:15], s24 offen lds
    v_mfma_f32_32x32x16_bf16 v[140:155], v[52:55], v[76:79], v[140:155]
    ds_read_b64_tr_b16 v[64:65], v15 offset:55296
    ds_read_b64_tr_b16 v[66:67], v15 offset:56832
    buffer_load_dwordx4 v11, s[12:15], s24 offen offset:1024 lds
    s_waitcnt lgkmcnt(6)
    v_mfma_f32_32x32x16_bf16 v[156:171], v[56:59], v[72:75], v[156:171]
    ds_read_b64_tr_b16 v[68:69], v16 offset:55296
    ds_read_b64_tr_b16 v[70:71], v16 offset:56832
    buffer_load_dwordx4 v12, s[12:15], s24 offen offset:2048 lds
    s_add_u32 s24, s24, 110592
    s_cmp_eq_u32 s25, 1280
    s_cselect_b32 s25, 0, s25
    s_cselect_b32 s24, 0, s24
    v_mfma_f32_32x32x16_bf16 v[172:187], v[56:59], v[76:79], v[172:187]
    s_cmp_eq_u32 s23, s62
    s_cbranch_scc1 k1cs_57
k1cs_57_back:
    s_cmp_eq_u32 s23, 3
    s_cbranch_scc0 k1nl_58
    buffer_load_dword v24, off, s[76:79], 0 sc1
k1nl_58:
    s_waitcnt vmcnt(8)
    s_barrier
    s_waitcnt lgkmcnt(5)
    v_mfma_f32_32x32x16_bf16 v[92:107], v[60:63], v[80:83], v[92:107]
    ds_read_b64_tr_b16 v[48:49], v17 offset:0
    ds_read_b64_tr_b16 v[50:51], v17 offset:1536
    s_waitcnt lgkmcnt(6)
    v_mfma_f32_32x32x16_bf16 v[108:123], v[60:63], v[84:87], v[108:123]
    ds_read_b128 v[72:75], v20 offset:24576
    s_waitcnt lgkmcnt(5)
    v_mfma_f32_32x32x16_bf16 v[124:139], v[64:67], v[80:83], v[124:139]
    ds_read_b128 v[76:79], v20 offset:26624
    v_mfma_f32_32x32x16_bf16 v[140:155], v[64:67], v[84:87], v[140:155]
    ds_read_b64_tr_b16 v[52:53], v18 offset:0
    ds_read_b64_tr_b16 v[54:55], v18 offset:1536
    s_waitcnt lgkmcnt(6)
    v_mfma_f32_32x32x16_bf16 v[156:171], v[68:71], v[80:83], v[156:171]
    ds_read_b64_tr_b16 v[56:57], v19 offset:0
    ds_read_b64_tr_b16 v[58:59], v19 offset:1536
    v_mfma_f32_32x32x16_bf16 v[172:187], v[68:71], v[84:87], v[172:187]
    s_waitcnt lgkmcnt(5)
    v_mfma_f32_32x32x16_bf16 v[92:107], v[48:51], v[72:75], v[92:107]
    ds_read_b64_tr_b16 v[60:61], v17 offset:6144
    ds_read_b64_tr_b16 v[62:63], v17 offset:7680
    s_waitcnt lgkmcnt(6)
    v_mfma_f32_32x32x16_bf16 v[108:123], v[48:51], v[76:79], v[108:123]
    ds_read_b128 v[80:83], v21 offset:24576
    s_add_u32 m0, s28, 8192
    s_nop 0
    buffer_load_dwordx4 v13, s[8:11], s25 offen lds
    s_waitcnt lgkmcnt(5)
    v_mfma_f32_32x32x16_bf16 v[124:139], v[52:55], v[72:75], v[124:139]
    ds_read_b128 v[84:87], v21 offset:26624
    s_add_u32 m0, s27, 24576
    s_add_u32 s25, s25, 64
    buffer_load_dwordx4 v10, s[12:15], s24 offen lds
    v_mfma_f32_32x32x16_bf16 v[140:155], v[52:55], v[76:79], v[140:155]
    ds_read_b64_tr_b16 v[64:65], v18 offset:6144
    ds_read_b64_tr_b16 v[66:67], v18 offset:7680
    buffer_load_dwordx4 v11, s[12:15], s24 offen offset:1024 lds
    s_waitcnt lgkmcnt(6)
    v_mfma_f32_32x32x16_bf16 v[156:171], v[56:59], v[72:75], v[156:171]
    ds_read_b64_tr_b16 v[68:69], v19 offset:6144
    ds_read_b64_tr_b16 v[70:71], v19 offset:7680
    buffer_load_dwordx4 v12, s[12:15], s24 offen offset:2048 lds
    s_add_u32 s24, s24, 110592
    s_cmp_eq_u32 s25, 1280
    s_cselect_b32 s25, 0, s25
    s_cselect_b32 s24, 0, s24
    v_mfma_f32_32x32x16_bf16 v[172:187], v[56:59], v[76:79], v[172:187]
    s_cmp_eq_u32 s23, s63
    s_cbranch_scc1 k1cs_59
k1cs_59_back:
    s_waitcnt vmcnt(8)
    s_barrier
    s_waitcnt lgkmcnt(5)
    v_mfma_f32_32x32x16_bf16 v[92:107], v[60:63], v[80:83], v[92:107]
    ds_read_b64_tr_b16 v[48:49], v17 offset:24576
    ds_read_b64_tr_b16 v[50:51], v17 offset:26112
    s_waitcnt lgkmcnt(6)
    v_mfma_f32_32x32x16_bf16 v[108:123], v[60:63], v[84:87], v[108:123]
    ds_read_b128 v[72:75], v20 offset:32768
    s_waitcnt lgkmcnt(5)
    v_mfma_f32_32x32x16_bf16 v[124:139], v[64:67], v[80:83], v[124:139]
    ds_read_b128 v[76:79], v20 offset:34816
    v_mfma_f32_32x32x16_bf16 v[140:155], v[64:67], v[84:87], v[140:155]
    ds_read_b64_tr_b16 v[52:53], v18 offset:24576
    ds_read_b64_tr_b16 v[54:55], v18 offset:26112
    s_waitcnt lgkmcnt(6)
    v_mfma_f32_32x32x16_bf16 v[156:171], v[68:71], v[80:83], v[156:171]
    ds_read_b64_tr_b16 v[56:57], v19 offset:24576
    ds_read_b64_tr_b16 v[58:59], v19 offset:26112
    v_mfma_f32_32x32x16_bf16 v[172:187], v[68:71], v[84:87], v[172:187]
    s_waitcnt lgkmcnt(5)
    v_mfma_f32_32x32x16_bf16 v[92:107], v[48:51], v[72:75], v[92:107]
    ds_read_b64_tr_b16 v[60:61], v17 offset:30720
    ds_read_b64_tr_b16 v[62:63], v17 offset:32256
    s_waitcnt lgkmcnt(6)
    v_mfma_f32_32x32x16_bf16 v[108:123], v[48:51], v[76:79], v[108:123]
    ds_read_b128 v[80:83], v21 offset:32768
    s_add_u32 m0, s28, 16384
    s_nop 0
    buffer_load_dwordx4 v13, s[8:11], s25 offen lds
    s_waitcnt lgkmcnt(5)
    v_mfma_f32_32x32x16_bf16 v[124:139], v[52:55], v[72:75], v[124:139]
    ds_read_b128 v[84:87], v21 offset:34816
    s_add_u32 m0, s27, 49152
    s_add_u32 s25, s25, 64
    buffer_load_dwordx4 v10, s[12:15], s24 offen lds
    v_mfma_f32_32x32x16_bf16 v[140:155], v[52:55], v[76:79], v[140:155]
    ds_read_b64_tr_b16 v[64:65], v18 offset:30720
    ds_read_b64_tr_b16 v[66:67], v18 offset:32256
    buffer_load_dwordx4 v11, s[12:15], s24 offen offset:1024 lds
    s_waitcnt lgkmcnt(6)
    v_mfma_f32_32x32x16_bf16 v[156:171], v[56:59], v[72:75], v[156:171]
    ds_read_b64_tr_b16 v[68:69], v19 offset:30720
    ds_read_b64_tr_b16 v[70:71], v19 offset:32256
    buffer_load_dwordx4 v12, s[12:15], s24 offen offset:2048 lds
    s_add_u32 s24, s24, 110592
    s_cmp_eq_u32 s25, 1280
    s_cselect_b32 s25, 0, s25
    s_cselect_b32 s24, 0, s24
    v_mfma_f32_32x32x16_bf16 v[172:187], v[56:59], v[76:79], v[172:187]
    s_cmp_eq_u32 s23, s64
    s_cbranch_scc1 k1cs_60
k1cs_60_back:
    s_waitcnt vmcnt(8)
    s_barrier
    s_cmp_eq_u32 s23, 3
    s_cbranch_scc1 k1pub_61
k1pub_61_back:
    s_waitcnt lgkmcnt(5)
    v_mfma_f32_32x32x16_bf16 v[92:107], v[60:63], v[80:83], v[92:107]
    ds_read_b64_tr_b16 v[48:49], v14 offset:0
    ds_read_b64_tr_b16 v[50:51], v14 offset:1536
    s_waitcnt lgkmcnt(6)
    v_mfma_f32_32x32x16_bf16 v[108:123], v[60:63], v[84:87], v[108:123]
    ds_read_b128 v[72:75], v20 offset:0
    s_waitcnt lgkmcnt(5)
    v_mfma_f32_32x32x16_bf16 v[124:139], v[64:67], v[80:83], v[124:139]
    ds_read_b128 v[76:79], v20 offset:2048
    v_mfma_f32_32x32x16_bf16 v[140:155], v[64:67], v[84:87], v[140:155]
    ds_read_b64_tr_b16 v[52:53], v15 offset:0
    ds_read_b64_tr_b16 v[54:55], v15 offset:1536
    s_waitcnt lgkmcnt(6)
    v_mfma_f32_32x32x16_bf16 v[156:171], v[68:71], v[80:83], v[156:171]
    ds_read_b64_tr_b16 v[56:57], v16 offset:0
    ds_read_b64_tr_b16 v[58:59], v16 offset:1536
    v_mfma_f32_32x32x16_bf16 v[172:187], v[68:71], v[84:87], v[172:187]
    s_sub_u32 s23, s23, 1
    s_cmp_lg_u32 s23, 0
    s_cbranch_scc1 k1_ffn_loop1
    s_waitcnt lgkmcnt(5)
    v_mfma_f32_32x32x16_bf16 v[92:107], v[48:51], v[72:75], v[92:107]
    ds_read_b64_tr_b16 v[60:61], v14 offset:6144
    ds_read_b64_tr_b16 v[62:63], v14 offset:7680
    s_waitcnt lgkmcnt(6)
    v_mfma_f32_32x32x16_bf16 v[108:123], v[48:51], v[76:79], v[108:123]
    ds_read_b128 v[80:83], v21 offset:0
    s_add_u32 m0, s28, 24576
    s_nop 0
    buffer_load_dwordx4 v13, s[8:11], s25 offen lds
    s_waitcnt lgkmcnt(5)
    v_mfma_f32_32x32x16_bf16 v[124:139], v[52:55], v[72:75], v[124:139]
    ds_read_b128 v[84:87], v21 offset:2048
    s_add_u32 m0, s27, 73728
    s_add_u32 s25, s25, 64
    buffer_load_dwordx4 v10, s[12:15], s24 offen lds
    v_mfma_f32_32x32x16_bf16 v[140:155], v[52:55], v[76:79], v[140:155]
    ds_read_b64_tr_b16 v[64:65], v15 offset:6144
    ds_read_b64_tr_b16 v[66:67], v15 offset:7680
    buffer_load_dwordx4 v11, s[12:15], s24 offen offset:1024 lds
    s_waitcnt lgkmcnt(6)
    v_mfma_f32_32x32x16_bf16 v[156:171], v[56:59], v[72:75], v[156:171]
    ds_read_b64_tr_b16 v[68:69], v16 offset:6144
    ds_read_b64_tr_b16 v[70:71], v16 offset:7680
    buffer_load_dwordx4 v12, s[12:15], s24 offen offset:2048 lds
    s_add_u32 s24, s24, 110592
    s_cmp_eq_u32 s25, 1280
    s_cselect_b32 s25, 0, s25
    s_cselect_b32 s24, 0, s24
    v_mfma_f32_32x32x16_bf16 v[172:187], v[56:59], v[76:79], v[172:187]
    s_waitcnt vmcnt(8)
    s_barrier
    s_waitcnt lgkmcnt(5)
    v_mfma_f32_32x32x16_bf16 v[92:107], v[60:63], v[80:83], v[92:107]
    ds_read_b64_tr_b16 v[48:49], v14 offset:24576
    ds_read_b64_tr_b16 v[50:51], v14 offset:26112
    s_waitcnt lgkmcnt(6)
    v_mfma_f32_32x32x16_bf16 v[108:123], v[60:63], v[84:87], v[108:123]
    ds_read_b128 v[72:75], v20 offset:8192
    s_waitcnt lgkmcnt(5)
    v_mfma_f32_32x32x16_bf16 v[124:139], v[64:67], v[80:83], v[124:139]
    ds_read_b128 v[76:79], v20 offset:10240
    v_mfma_f32_32x32x16_bf16 v[140:155], v[64:67], v[84:87], v[140:155]
    ds_read_b64_tr_b16 v[52:53], v15 offset:24576
    ds_read_b64_tr_b16 v[54:55], v15 offset:26112
    s_waitcnt lgkmcnt(6)
    v_mfma_f32_32x32x16_bf16 v[156:171], v[68:71], v[80:83], v[156:171]
    ds_read_b64_tr_b16 v[56:57], v16 offset:24576
    ds_read_b64_tr_b16 v[58:59], v16 offset:26112
    v_mfma_f32_32x32x16_bf16 v[172:187], v[68:71], v[84:87], v[172:187]
    s_waitcnt lgkmcnt(5)
    v_mfma_f32_32x32x16_bf16 v[92:107], v[48:51], v[72:75], v[92:107]
    ds_read_b64_tr_b16 v[60:61], v14 offset:30720
    ds_read_b64_tr_b16 v[62:63], v14 offset:32256
    s_waitcnt lgkmcnt(6)
    v_mfma_f32_32x32x16_bf16 v[108:123], v[48:51], v[76:79], v[108:123]
    ds_read_b128 v[80:83], v21 offset:8192
    s_add_u32 m0, s28, 32768
    s_nop 0
    buffer_load_dwordx4 v13, s[8:11], s25 offen lds
    s_waitcnt lgkmcnt(5)
    v_mfma_f32_32x32x16_bf16 v[124:139], v[52:55], v[72:75], v[124:139]
    ds_read_b128 v[84:87], v21 offset:10240
    s_add_u32 m0, s27, 98304
    s_add_u32 s25, s25, 64
    buffer_load_dwordx4 v10, s[12:15], s24 offen lds
    v_mfma_f32_32x32x16_bf16 v[140:155], v[52:55], v[76:79], v[140:155]
    ds_read_b64_tr_b16 v[64:65], v15 offset:30720
    ds_read_b64_tr_b16 v[66:67], v15 offset:32256
    buffer_load_dwordx4 v11, s[12:15], s24 offen offset:1024 lds
    s_waitcnt lgkmcnt(6)
    v_mfma_f32_32x32x16_bf16 v[156:171], v[56:59], v[72:75], v[156:171]
    ds_read_b64_tr_b16 v[68:69], v16 offset:30720
    ds_read_b64_tr_b16 v[70:71], v16 offset:32256
    buffer_load_dwordx4 v12, s[12:15], s24 offen offset:2048 lds
    s_add_u32 s24, s24, 110592
    s_cmp_eq_u32 s25, 1280
    s_cselect_b32 s25, 0, s25
    s_cselect_b32 s24, 0, s24
    v_mfma_f32_32x32x16_bf16 v[172:187], v[56:59], v[76:79], v[172:187]
    s_waitcnt vmcnt(8)
    s_barrier
    s_waitcnt lgkmcnt(5)
    v_mfma_f32_32x32x16_bf16 v[92:107], v[60:63], v[80:83], v[92:107]
    ds_read_b64_tr_b16 v[48:49], v14 offset:49152
    ds_read_b64_tr_b16 v[50:51], v14 offset:50688
    s_waitcnt lgkmcnt(6)
    v_mfma_f32_32x32x16_bf16 v[108:123], v[60:63], v[84:87], v[108:123]
    ds_read_b128 v[72:75], v20 offset:16384
    s_waitcnt lgkmcnt(5)
    v_mfma_f32_32x32x16_bf16 v[124:139], v[64:67], v[80:83], v[124:139]
    ds_read_b128 v[76:79], v20 offset:18432
    v_mfma_f32_32x32x16_bf16 v[140:155], v[64:67], v[84:87], v[140:155]
    ds_read_b64_tr_b16 v[52:53], v15 offset:49152
    ds_read_b64_tr_b16 v[54:55], v15 offset:50688
    s_waitcnt lgkmcnt(6)
    v_mfma_f32_32x32x16_bf16 v[156:171], v[68:71], v[80:83], v[156:171]
    ds_read_b64_tr_b16 v[56:57], v16 offset:49152
    ds_read_b64_tr_b16 v[58:59], v16 offset:50688
    v_mfma_f32_32x32x16_bf16 v[172:187], v[68:71], v[84:87], v[172:187]
    s_waitcnt lgkmcnt(5)
    v_mfma_f32_32x32x16_bf16 v[92:107], v[48:51], v[72:75], v[92:107]
    ds_read_b64_tr_b16 v[60:61], v14 offset:55296
    ds_read_b64_tr_b16 v[62:63], v14 offset:56832
    s_waitcnt lgkmcnt(6)
    v_mfma_f32_32x32x16_bf16 v[108:123], v[48:51], v[76:79], v[108:123]
    ds_read_b128 v[80:83], v21 offset:16384
    s_waitcnt lgkmcnt(5)
    v_mfma_f32_32x32x16_bf16 v[124:139], v[52:55], v[72:75], v[124:139]
    ds_read_b128 v[84:87], v21 offset:18432
    v_mfma_f32_32x32x16_bf16 v[140:155], v[52:55], v[76:79], v[140:155]
    ds_read_b64_tr_b16 v[64:65], v15 offset:55296
    ds_read_b64_tr_b16 v[66:67], v15 offset:56832
    s_waitcnt lgkmcnt(6)
    v_mfma_f32_32x32x16_bf16 v[156:171], v[56:59], v[72:75], v[156:171]
    ds_read_b64_tr_b16 v[68:69], v16 offset:55296
    ds_read_b64_tr_b16 v[70:71], v16 offset:56832
    v_mfma_f32_32x32x16_bf16 v[172:187], v[56:59], v[76:79], v[172:187]
    s_waitcnt vmcnt(4)
    s_barrier
    s_waitcnt lgkmcnt(5)
    v_mfma_f32_32x32x16_bf16 v[92:107], v[60:63], v[80:83], v[92:107]
    ds_read_b64_tr_b16 v[48:49], v17 offset:0
    ds_read_b64_tr_b16 v[50:51], v17 offset:1536
    s_waitcnt lgkmcnt(6)
    v_mfma_f32_32x32x16_bf16 v[108:123], v[60:63], v[84:87], v[108:123]
    ds_read_b128 v[72:75], v20 offset:24576
    s_waitcnt lgkmcnt(5)
    v_mfma_f32_32x32x16_bf16 v[124:139], v[64:67], v[80:83], v[124:139]
    ds_read_b128 v[76:79], v20 offset:26624
    v_mfma_f32_32x32x16_bf16 v[140:155], v[64:67], v[84:87], v[140:155]
    ds_read_b64_tr_b16 v[52:53], v18 offset:0
    ds_read_b64_tr_b16 v[54:55], v18 offset:1536
    s_waitcnt lgkmcnt(6)
    v_mfma_f32_32x32x16_bf16 v[156:171], v[68:71], v[80:83], v[156:171]
    ds_read_b64_tr_b16 v[56:57], v19 offset:0
    ds_read_b64_tr_b16 v[58:59], v19 offset:1536
    v_mfma_f32_32x32x16_bf16 v[172:187], v[68:71], v[84:87], v[172:187]
    s_waitcnt lgkmcnt(5)
    v_mfma_f32_32x32x16_bf16 v[92:107], v[48:51], v[72:75], v[92:107]
    ds_read_b64_tr_b16 v[60:61], v17 offset:6144
    ds_read_b64_tr_b16 v[62:63], v17 offset:7680
    s_waitcnt lgkmcnt(6)
    v_mfma_f32_32x32x16_bf16 v[108:123], v[48:51], v[76:79], v[108:123]
    ds_read_b128 v[80:83], v21 offset:24576
    s_waitcnt lgkmcnt(5)
    v_mfma_f32_32x32x16_bf16 v[124:139], v[52:55], v[72:75], v[124:139]
    ds_read_b128 v[84:87], v21 offset:26624
    v_mfma_f32_32x32x16_bf16 v[140:155], v[52:55], v[76:79], v[140:155]
    ds_read_b64_tr_b16 v[64:65], v18 offset:6144
    ds_read_b64_tr_b16 v[66:67], v18 offset:7680
    s_waitcnt lgkmcnt(6)
    v_mfma_f32_32x32x16_bf16 v[156:171], v[56:59], v[72:75], v[156:171]
    ds_read_b64_tr_b16 v[68:69], v19 offset:6144
    ds_read_b64_tr_b16 v[70:71], v19 offset:7680
    v_mfma_f32_32x32x16_bf16 v[172:187], v[56:59], v[76:79], v[172:187]
    v_lshlrev_b32 v3, 1, v25
    v_lshlrev_b32 v4, 2, v26
    s_mul_i32 s4, s21, 3072
    s_lshl_b32 s5, s20, 11
    s_add_u32 s5, s5, 65536
    buffer_load_dwordx2 v[22:23], v3, s[72:75], s4 offen sc1
    buffer_load_dwordx4 v[28:31], v4, s[72:75], s5 offen sc1
    s_waitcnt vmcnt(2)
    s_barrier
    s_waitcnt lgkmcnt(5)
    v_mfma_f32_32x32x16_bf16 v[92:107], v[60:63], v[80:83], v[92:107]
    ds_read_b64_tr_b16 v[48:49], v17 offset:24576
    ds_read_b64_tr_b16 v[50:51], v17 offset:26112
    s_waitcnt lgkmcnt(6)
    v_mfma_f32_32x32x16_bf16 v[108:123], v[60:63], v[84:87], v[108:123]
    ds_read_b128 v[72:75], v20 offset:32768
    s_waitcnt lgkmcnt(5)
    v_mfma_f32_32x32x16_bf16 v[124:139], v[64:67], v[80:83], v[124:139]
    ds_read_b128 v[76:79], v20 offset:34816
    v_mfma_f32_32x32x16_bf16 v[140:155], v[64:67], v[84:87], v[140:155]
    ds_read_b64_tr_b16 v[52:53], v18 offset:24576
    ds_read_b64_tr_b16 v[54:55], v18 offset:26112
    s_waitcnt lgkmcnt(6)
    v_mfma_f32_32x32x16_bf16 v[156:171], v[68:71], v[80:83], v[156:171]
    ds_read_b64_tr_b16 v[56:57], v19 offset:24576
    ds_read_b64_tr_b16 v[58:59], v19 offset:26112
    v_mfma_f32_32x32x16_bf16 v[172:187], v[68:71], v[84:87], v[172:187]
    s_waitcnt lgkmcnt(5)
    v_mfma_f32_32x32x16_bf16 v[92:107], v[48:51], v[72:75], v[92:107]
    ds_read_b64_tr_b16 v[60:61], v17 offset:30720
    ds_read_b64_tr_b16 v[62:63], v17 offset:32256
    s_waitcnt lgkmcnt(6)
    v_mfma_f32_32x32x16_bf16 v[108:123], v[48:51], v[76:79], v[108:123]
    ds_read_b128 v[80:83], v21 offset:32768
    s_waitcnt lgkmcnt(5)
    v_mfma_f32_32x32x16_bf16 v[124:139], v[52:55], v[72:75], v[124:139]
    ds_read_b128 v[84:87], v21 offset:34816
    v_mfma_f32_32x32x16_bf16 v[140:155], v[52:55], v[76:79], v[140:155]
    ds_read_b64_tr_b16 v[64:65], v18 offset:30720
    ds_read_b64_tr_b16 v[66:67], v18 offset:32256
    s_waitcnt lgkmcnt(6)
    v_mfma_f32_32x32x16_bf16 v[156:171], v[56:59], v[72:75], v[156:171]
    ds_read_b64_tr_b16 v[68:69], v19 offset:30720
    ds_read_b64_tr_b16 v[70:71], v19 offset:32256
    v_mfma_f32_32x32x16_bf16 v[172:187], v[56:59], v[76:79], v[172:187]
    s_waitcnt lgkmcnt(5)
    v_mfma_f32_32x32x16_bf16 v[92:107], v[60:63], v[80:83], v[92:107]
    s_waitcnt lgkmcnt(4)
    v_mfma_f32_32x32x16_bf16 v[108:123], v[60:63], v[84:87], v[108:123]
    s_waitcnt lgkmcnt(2)
    v_mfma_f32_32x32x16_bf16 v[124:139], v[64:67], v[80:83], v[124:139]
    s_waitcnt vmcnt(0)
    v_cmp_ne_u32 vcc, s29, v23
    v_cmp_ne_u32 s[6:7], s29, v30
    s_nop 1
    s_or_b64 vcc, vcc, s[6:7]
    s_cbranch_vccnz k1retry_62
k1back_63:
    ds_write_b32 v25, v22 offset:0
    ds_write_b32 v26, v28 offset:1536
    ds_write_b32 v26, v29 offset:2048
    v_mfma_f32_32x32x16_bf16 v[140:155], v[64:67], v[84:87], v[140:155]
    s_waitcnt lgkmcnt(3)
    v_mfma_f32_32x32x16_bf16 v[156:171], v[68:71], v[80:83], v[156:171]
    v_mfma_f32_32x32x16_bf16 v[172:187], v[68:71], v[84:87], v[172:187]
    s_waitcnt lgkmcnt(0)
    s_barrier
    s_branch k1_ffn_epi
k1retry_62:
    s_mov_b32 s23, 200000
k1retry_62_l:
    s_sleep 2
    v_lshlrev_b32 v3, 1, v25
    v_lshlrev_b32 v4, 2, v26
    s_mul_i32 s4, s21, 3072
    s_lshl_b32 s5, s20, 11
    s_add_u32 s5, s5, 65536
    buffer_load_dwordx2 v[22:23], v3, s[72:75], s4 offen sc1
    buffer_load_dwordx4 v[28:31], v4, s[72:75], s5 offen sc1
    s_waitcnt vmcnt(0)
    v_cmp_ne_u32 vcc, s29, v23
    v_cmp_ne_u32 s[6:7], s29, v30
    s_nop 1
    s_or_b64 vcc, vcc, s[6:7]
    s_cbranch_vccz k1back_63
    s_sub_u32 s23, s23, 1
    s_cmp_lg_u32 s23, 0
    s_cbranch_scc1 k1retry_62_l
    s_branch k1back_63
k1cs_55:
    s_waitcnt lgkmcnt(0)
    s_bitcmp1_b32 s26, 0
    s_cbranch_scc0 k1cs_55_s0
    v_mfma_f32_16x16x32_bf16 v[36:39], v[32:35], v[48:51], v[36:39]
    v_mfma_f32_16x16x32_bf16 v[36:39], v[32:35], v[60:63], v[36:39]
k1cs_55_s0:
    s_bitcmp1_b32 s26, 1
    s_cbranch_scc0 k1cs_55_s1
    v_mfma_f32_16x16x32_bf16 v[40:43], v[32:35], v[52:55], v[40:43]
    v_mfma_f32_16x16x32_bf16 v[40:43], v[32:35], v[64:67], v[40:43]
k1cs_55_s1:
    s_bitcmp1_b32 s26, 2
    s_cbranch_scc0 k1cs_55_s2
    v_mfma_f32_16x16x32_bf16 v[44:47], v[32:35], v[56:59], v[44:47]
    v_mfma_f32_16x16x32_bf16 v[44:47], v[32:35], v[68:71], v[44:47]
k1cs_55_s2:
    s_branch k1cs_55_back
k1cs_56:
    s_waitcnt lgkmcnt(0)
    s_bitcmp1_b32 s26, 0
    s_cbranch_scc0 k1cs_56_s0
    v_mfma_f32_16x16x32_bf16 v[36:39], v[32:35], v[48:51], v[36:39]
    v_mfma_f32_16x16x32_bf16 v[36:39], v[32:35], v[60:63], v[36:39]
k1cs_56_s0:
    s_bitcmp1_b32 s26, 1
    s_cbranch_scc0 k1cs_56_s1
    v_mfma_f32_16x16x32_bf16 v[40:43], v[32:35], v[52:55], v[40:43]
    v_mfma_f32_16x16x32_bf16 v[40:43], v[32:35], v[64:67], v[40:43]
k1cs_56_s1:
    s_bitcmp1_b32 s26, 2
    s_cbranch_scc0 k1cs_56_s2
    v_mfma_f32_16x16x32_bf16 v[44:47], v[32:35], v[56:59], v[44:47]
    v_mfma_f32_16x16x32_bf16 v[44:47], v[32:35], v[68:71], v[44:47]
k1cs_56_s2:
    s_branch k1cs_56_back
k1cs_57:
    s_waitcnt lgkmcnt(0)
    s_bitcmp1_b32 s26, 0
    s_cbranch_scc0 k1cs_57_s0
    v_mfma_f32_16x16x32_bf16 v[36:39], v[32:35], v[48:51], v[36:39]
    v_mfma_f32_16x16x32_bf16 v[36:39], v[32:35], v[60:63], v[36:39]
k1cs_57_s0:
    s_bitcmp1_b32 s26, 1
    s_cbranch_scc0 k1cs_57_s1
    v_mfma_f32_16x16x32_bf16 v[40:43], v[32:35], v[52:55], v[40:43]
    v_mfma_f32_16x16x32_bf16 v[40:43], v[32:35], v[64:67], v[40:43]
k1cs_57_s1:
    s_bitcmp1_b32 s26, 2
    s_cbranch_scc0 k1cs_57_s2
    v_mfma_f32_16x16x32_bf16 v[44:47], v[32:35], v[56:59], v[44:47]
    v_mfma_f32_16x16x32_bf16 v[44:47], v[32:35], v[68:71], v[44:47]
k1cs_57_s2:
    s_branch k1cs_57_back
k1cs_59:
    s_waitcnt lgkmcnt(0)
    s_bitcmp1_b32 s26, 0
    s_cbranch_scc0 k1cs_59_s0
    v_mfma_f32_16x16x32_bf16 v[36:39], v[32:35], v[48:51], v[36:39]
    v_mfma_f32_16x16x32_bf16 v[36:39], v[32:35], v[60:63], v[36:39]
k1cs_59_s0:
    s_bitcmp1_b32 s26, 1
    s_cbranch_scc0 k1cs_59_s1
    v_mfma_f32_16x16x32_bf16 v[40:43], v[32:35], v[52:55], v[40:43]
    v_mfma_f32_16x16x32_bf16 v[40:43], v[32:35], v[64:67], v[40:43]
k1cs_59_s1:
    s_bitcmp1_b32 s26, 2
    s_cbranch_scc0 k1cs_59_s2
    v_mfma_f32_16x16x32_bf16 v[44:47], v[32:35], v[56:59], v[44:47]
    v_mfma_f32_16x16x32_bf16 v[44:47], v[32:35], v[68:71], v[44:47]
k1cs_59_s2:
    s_branch k1cs_59_back
k1cs_60:
    s_waitcnt lgkmcnt(0)
    s_bitcmp1_b32 s26, 0
    s_cbranch_scc0 k1cs_60_s0
    v_mfma_f32_16x16x32_bf16 v[36:39], v[32:35], v[48:51], v[36:39]
    v_mfma_f32_16x16x32_bf16 v[36:39], v[32:35], v[60:63], v[36:39]
k1cs_60_s0:
    s_bitcmp1_b32 s26, 1
    s_cbranch_scc0 k1cs_60_s1
    v_mfma_f32_16x16x32_bf16 v[40:43], v[32:35], v[52:55], v[40:43]
    v_mfma_f32_16x16x32_bf16 v[40:43], v[32:35], v[64:67], v[40:43]
k1cs_60_s1:
    s_bitcmp1_b32 s26, 2
    s_cbranch_scc0 k1cs_60_s2
    v_mfma_f32_16x16x32_bf16 v[44:47], v[32:35], v[56:59], v[44:47]
    v_mfma_f32_16x16x32_bf16 v[44:47], v[32:35], v[68:71], v[44:47]
k1cs_60_s2:
    s_branch k1cs_60_back
k1pub_61:
    s_nop 7
    s_mov_b32 s4, 200000
k1pub_61_n:
    v_readfirstlane_b32 s29, v24
    s_cmp_lg_u32 s29, 0
    s_cbranch_scc1 k1pub_61_ok
    s_sleep 2
    buffer_load_dword v24, off, s[76:79], 0 sc1
    s_waitcnt vmcnt(0)
    s_sub_u32 s4, s4, 1
    s_cmp_lg_u32 s4, 0
    s_cbranch_scc1 k1pub_61_n
k1pub_61_ok:
    s_mov_b64 exec, 0xffff
    s_bitcmp1_b32 s26, 0
    s_cbranch_scc0 k1pub_61_s0
    v_mov_b32 v38, s29
    v_mov_b32 v39, s29
    buffer_store_dwordx4 v[36:39], v27, s[72:75], s30 offen offset:0 sc1
k1pub_61_s0:
    s_bitcmp1_b32 s26, 1
    s_cbranch_scc0 k1pub_61_s1
    v_mov_b32 v42, s29
    v_mov_b32 v43, s29
    buffer_store_dwordx4 v[40:43], v27, s[72:75], s30 offen offset:256 sc1
k1pub_61_s1:
    s_bitcmp1_b32 s26, 2
    s_cbranch_scc0 k1pub_61_s2
    v_mov_b32 v46, s29
    v_mov_b32 v47, s29
    buffer_store_dwordx4 v[44:47], v27, s[72:75], s30 offen offset:512 sc1
k1pub_61_s2:
    s_mov_b64 exec, -1
    s_branch k1pub_61_back
k1_ffn_epi:
    s_setprio 0
    v_and_b32 v2, 31, v1
    s_lshl_b32 s4, s36, 6
    v_add_u32 v2, s4, v2
    v_lshlrev_b32 v2, 2, v2
    ds_read_b32 v188, v2 offset:2048
    ds_read_b32 v190, v2 offset:1536
    ds_read_b32 v189, v2 offset:2176
    ds_read_b32 v191, v2 offset:1664
    v_lshrrev_b32 v4, 5, v1
    s_mul_i32 s4, s37, 384
    v_lshlrev_b32 v5, 4, v4
    v_add_u32 v5, s4, v5
    ds_read_b128 v[48:51], v5 offset:0
    ds_read_b128 v[52:55], v5 offset:32
    ds_read_b128 v[56:59], v5 offset:64
    ds_read_b128 v[60:63], v5 offset:96
    ds_read_b128 v[64:67], v5 offset:128
    ds_read_b128 v[68:71], v5 offset:160
    ds_read_b128 v[72:75], v5 offset:192
    ds_read_b128 v[76:79], v5 offset:224
    ds_read_b128 v[192:195], v5 offset:256
    ds_read_b128 v[196:199], v5 offset:288
    ds_read_b128 v[200:203], v5 offset:320
    ds_read_b128 v[204:207], v5 offset:352
    s_mov_b32 s16, s58
    s_mov_b32 s17, s59
    s_mov_b32 s18, 0x940000
    s_mov_b32 s19, 0x00020000
    s_lshl_b32 s4, s20, 3
    s_lshl_b32 s5, s36, 2
    s_add_u32 s4, s4, s5
    s_mul_i32 s4, s4, 75776
    s_sub_u32 s5, s21, 6
    s_mul_i32 s5, s5, 12
    s_mul_i32 s6, s37, 3
    s_add_u32 s5, s5, s6
    s_lshl_b32 s5, s5, 9
    s_add_u32 s4, s4, s5
    v_bfe_u32 v6, v1, 4, 1
    v_mul_u32_u24 v6, 75776, v6
    v_lshl_add_u32 v6, v4, 8, v6
    v_and_b32 v7, 15, v1
    v_lshl_add_u32 v6, v7, 4, v6
    v_add_u32 v6, s4, v6
    s_mov_b32 s7, 151552
    s_waitcnt lgkmcnt(12)
    v_mul_f32 v190, v190, v190
    v_mul_f32 v191, v191, v191
    s_waitcnt lgkmcnt(11)
    v_pk_fma_f32 v[92:93], v[188:189], v[48:49], v[92:93] op_sel:[0,0,0] op_sel_hi:[0,1,1]
    v_pk_fma_f32 v[94:95], v[188:189], v[50:51], v[94:95] op_sel:[0,0,0] op_sel_hi:[0,1,1]
    s_waitcnt lgkmcnt(10)
    v_pk_fma_f32 v[96:97], v[188:189], v[52:53], v[96:97] op_sel:[0,0,0] op_sel_hi:[0,1,1]
    v_pk_fma_f32 v[98:99], v[188:189], v[54:55], v[98:99] op_sel:[0,0,0] op_sel_hi:[0,1,1]
    s_waitcnt lgkmcnt(9)
    v_pk_fma_f32 v[100:101], v[188:189], v[56:57], v[100:101] op_sel:[0,0,0] op_sel_hi:[0,1,1]
    v_pk_fma_f32 v[102:103], v[188:189], v[58:59], v[102:103] op_sel:[0,0,0] op_sel_hi:[0,1,1]
    s_waitcnt lgkmcnt(8)
    v_pk_fma_f32 v[104:105], v[188:189], v[60:61], v[104:105] op_sel:[0,0,0] op_sel_hi:[0,1,1]
    v_pk_fma_f32 v[106:107], v[188:189], v[62:63], v[106:107] op_sel:[0,0,0] op_sel_hi:[0,1,1]
    v_max_f32 v92, 0, v92
    v_max_f32 v93, 0, v93
    v_pk_mul_f32 v[100:101], v[190:191], v[100:101] op_sel:[0,0] op_sel_hi:[0,1]
    v_max_f32 v94, 0, v94
    v_max_f32 v95, 0, v95
    v_pk_mul_f32 v[102:103], v[190:191], v[102:103] op_sel:[0,0] op_sel_hi:[0,1]
    v_max_f32 v96, 0, v96
    v_max_f32 v97, 0, v97
    v_pk_mul_f32 v[104:105], v[190:191], v[104:105] op_sel:[0,0] op_sel_hi:[0,1]
    v_max_f32 v98, 0, v98
    v_max_f32 v99, 0, v99
    v_pk_mul_f32 v[106:107], v[190:191], v[106:107] op_sel:[0,0] op_sel_hi:[0,1]
    v_pk_mul_f32 v[92:93], v[92:93], v[100:101] op_sel:[0,0] op_sel_hi:[1,1]
    v_pk_mul_f32 v[94:95], v[94:95], v[102:103] op_sel:[0,0] op_sel_hi:[1,1]
    v_pk_mul_f32 v[96:97], v[96:97], v[104:105] op_sel:[0,0] op_sel_hi:[1,1]
    v_pk_mul_f32 v[98:99], v[98:99], v[106:107] op_sel:[0,0] op_sel_hi:[1,1]
    v_cvt_pk_bf16_f32 v100, v92, v93
    v_cvt_pk_bf16_f32 v101, v94, v95
    v_cvt_pk_bf16_f32 v102, v96, v97
    v_cvt_pk_bf16_f32 v103, v98, v99
    buffer_store_dwordx4 v[100:103], v6, s[16:19], 0 offen offset:0 sc1
    v_pk_fma_f32 v[108:109], v[188:189], v[48:49], v[108:109] op_sel:[1,0,0] op_sel_hi:[1,1,1]
    v_pk_fma_f32 v[110:111], v[188:189], v[50:51], v[110:111] op_sel:[1,0,0] op_sel_hi:[1,1,1]
    v_pk_fma_f32 v[112:113], v[188:189], v[52:53], v[112:113] op_sel:[1,0,0] op_sel_hi:[1,1,1]
    v_pk_fma_f32 v[114:115], v[188:189], v[54:55], v[114:115] op_sel:[1,0,0] op_sel_hi:[1,1,1]
    v_pk_fma_f32 v[116:117], v[188:189], v[56:57], v[116:117] op_sel:[1,0,0] op_sel_hi:[1,1,1]
    v_pk_fma_f32 v[118:119], v[188:189], v[58:59], v[118:119] op_sel:[1,0,0] op_sel_hi:[1,1,1]
    v_pk_fma_f32 v[120:121], v[188:189], v[60:61], v[120:121] op_sel:[1,0,0] op_sel_hi:[1,1,1]
    v_pk_fma_f32 v[122:123], v[188:189], v[62:63], v[122:123] op_sel:[1,0,0] op_sel_hi:[1,1,1]
    v_max_f32 v108, 0, v108
    v_max_f32 v109, 0, v109
    v_pk_mul_f32 v[116:117], v[190:191], v[116:117] op_sel:[1,0] op_sel_hi:[1,1]
    v_max_f32 v110, 0, v110
    v_max_f32 v111, 0, v111
    v_pk_mul_f32 v[118:119], v[190:191], v[118:119] op_sel:[1,0] op_sel_hi:[1,1]
    v_max_f32 v112, 0, v112
    v_max_f32 v113, 0, v113
    v_pk_mul_f32 v[120:121], v[190:191], v[120:121] op_sel:[1,0] op_sel_hi:[1,1]
    v_max_f32 v114, 0, v114
    v_max_f32 v115, 0, v115
    v_pk_mul_f32 v[122:123], v[190:191], v[122:123] op_sel:[1,0] op_sel_hi:[1,1]
    v_pk_mul_f32 v[108:109], v[108:109], v[116:117] op_sel:[0,0] op_sel_hi:[1,1]
    v_pk_mul_f32 v[110:111], v[110:111], v[118:119] op_sel:[0,0] op_sel_hi:[1,1]
    v_pk_mul_f32 v[112:113], v[112:113], v[120:121] op_sel:[0,0] op_sel_hi:[1,1]
    v_pk_mul_f32 v[114:115], v[114:115], v[122:123] op_sel:[0,0] op_sel_hi:[1,1]
    v_cvt_pk_bf16_f32 v116, v108, v109
    v_cvt_pk_bf16_f32 v117, v110, v111
    v_cvt_pk_bf16_f32 v118, v112, v113
    v_cvt_pk_bf16_f32 v119, v114, v115
    buffer_store_dwordx4 v[116:119], v6, s[16:19], s7 offen offset:0 sc1
    s_waitcnt lgkmcnt(7)
    v_pk_fma_f32 v[124:125], v[188:189], v[64:65], v[124:125] op_sel:[0,0,0] op_sel_hi:[0,1,1]
    v_pk_fma_f32 v[126:127], v[188:189], v[66:67], v[126:127] op_sel:[0,0,0] op_sel_hi:[0,1,1]
    s_waitcnt lgkmcnt(6)
    v_pk_fma_f32 v[128:129], v[188:189], v[68:69], v[128:129] op_sel:[0,0,0] op_sel_hi:[0,1,1]
    v_pk_fma_f32 v[130:131], v[188:189], v[70:71], v[130:131] op_sel:[0,0,0] op_sel_hi:[0,1,1]
    s_waitcnt lgkmcnt(5)
    v_pk_fma_f32 v[132:133], v[188:189], v[72:73], v[132:133] op_sel:[0,0,0] op_sel_hi:[0,1,1]
    v_pk_fma_f32 v[134:135], v[188:189], v[74:75], v[134:135] op_sel:[0,0,0] op_sel_hi:[0,1,1]
    s_waitcnt lgkmcnt(4)
    v_pk_fma_f32 v[136:137], v[188:189], v[76:77], v[136:137] op_sel:[0,0,0] op_sel_hi:[0,1,1]
    v_pk_fma_f32 v[138:139], v[188:189], v[78:79], v[138:139] op_sel:[0,0,0] op_sel_hi:[0,1,1]
    v_max_f32 v124, 0, v124
    v_max_f32 v125, 0, v125
    v_pk_mul_f32 v[132:133], v[190:191], v[132:133] op_sel:[0,0] op_sel_hi:[0,1]
    v_max_f32 v126, 0, v126
    v_max_f32 v127, 0, v127
    v_pk_mul_f32 v[134:135], v[190:191], v[134:135] op_sel:[0,0] op_sel_hi:[0,1]
    v_max_f32 v128, 0, v128
    v_max_f32 v129, 0, v129
    v_pk_mul_f32 v[136:137], v[190:191], v[136:137] op_sel:[0,0] op_sel_hi:[0,1]
    v_max_f32 v130, 0, v130
    v_max_f32 v131, 0, v131
    v_pk_mul_f32 v[138:139], v[190:191], v[138:139] op_sel:[0,0] op_sel_hi:[0,1]
    v_pk_mul_f32 v[124:125], v[124:125], v[132:133] op_sel:[0,0] op_sel_hi:[1,1]
    v_pk_mul_f32 v[126:127], v[126:127], v[134:135] op_sel:[0,0] op_sel_hi:[1,1]
    v_pk_mul_f32 v[128:129], v[128:129], v[136:137] op_sel:[0,0] op_sel_hi:[1,1]
    v_pk_mul_f32 v[130:131], v[130:131], v[138:139] op_sel:[0,0] op_sel_hi:[1,1]
    v_cvt_pk_bf16_f32 v132, v124, v125
    v_cvt_pk_bf16_f32 v133, v126, v127
    v_cvt_pk_bf16_f32 v134, v128, v129
    v_cvt_pk_bf16_f32 v135, v130, v131
    buffer_store_dwordx4 v[132:135], v6, s[16:19], 0 offen offset:512 sc1
    v_pk_fma_f32 v[140:141], v[188:189], v[64:65], v[140:141] op_sel:[1,0,0] op_sel_hi:[1,1,1]
    v_pk_fma_f32 v[142:143], v[188:189], v[66:67], v[142:143] op_sel:[1,0,0] op_sel_hi:[1,1,1]
    v_pk_fma_f32 v[144:145], v[188:189], v[68:69], v[144:145] op_sel:[1,0,0] op_sel_hi:[1,1,1]
    v_pk_fma_f32 v[146:147], v[188:189], v[70:71], v[146:147] op_sel:[1,0,0] op_sel_hi:[1,1,1]
    v_pk_fma_f32 v[148:149], v[188:189], v[72:73], v[148:149] op_sel:[1,0,0] op_sel_hi:[1,1,1]
    v_pk_fma_f32 v[150:151], v[188:189], v[74:75], v[150:151] op_sel:[1,0,0] op_sel_hi:[1,1,1]
    v_pk_fma_f32 v[152:153], v[188:189], v[76:77], v[152:153] op_sel:[1,0,0] op_sel_hi:[1,1,1]
    v_pk_fma_f32 v[154:155], v[188:189], v[78:79], v[154:155] op_sel:[1,0,0] op_sel_hi:[1,1,1]
    v_max_f32 v140, 0, v140
    v_max_f32 v141, 0, v141
    v_pk_mul_f32 v[148:149], v[190:191], v[148:149] op_sel:[1,0] op_sel_hi:[1,1]
    v_max_f32 v142, 0, v142
    v_max_f32 v143, 0, v143
    v_pk_mul_f32 v[150:151], v[190:191], v[150:151] op_sel:[1,0] op_sel_hi:[1,1]
    v_max_f32 v144, 0, v144
    v_max_f32 v145, 0, v145
    v_pk_mul_f32 v[152:153], v[190:191], v[152:153] op_sel:[1,0] op_sel_hi:[1,1]
    v_max_f32 v146, 0, v146
    v_max_f32 v147, 0, v147
    v_pk_mul_f32 v[154:155], v[190:191], v[154:155] op_sel:[1,0] op_sel_hi:[1,1]
    v_pk_mul_f32 v[140:141], v[140:141], v[148:149] op_sel:[0,0] op_sel_hi:[1,1]
    v_pk_mul_f32 v[142:143], v[142:143], v[150:151] op_sel:[0,0] op_sel_hi:[1,1]
    v_pk_mul_f32 v[144:145], v[144:145], v[152:153] op_sel:[0,0] op_sel_hi:[1,1]
    v_pk_mul_f32 v[146:147], v[146:147], v[154:155] op_sel:[0,0] op_sel_hi:[1,1]
    v_cvt_pk_bf16_f32 v148, v140, v141
    v_cvt_pk_bf16_f32 v149, v142, v143
    v_cvt_pk_bf16_f32 v150, v144, v145
    v_cvt_pk_bf16_f32 v151, v146, v147
    buffer_store_dwordx4 v[148:151], v6, s[16:19], s7 offen offset:512 sc1
    s_waitcnt lgkmcnt(3)
    v_pk_fma_f32 v[156:157], v[188:189], v[192:193], v[156:157] op_sel:[0,0,0] op_sel_hi:[0,1,1]
    v_pk_fma_f32 v[158:159], v[188:189], v[194:195], v[158:159] op_sel:[0,0,0] op_sel_hi:[0,1,1]
    s_waitcnt lgkmcnt(2)
    v_pk_fma_f32 v[160:161], v[188:189], v[196:197], v[160:161] op_sel:[0,0,0] op_sel_hi:[0,1,1]
    v_pk_fma_f32 v[162:163], v[188:189], v[198:199], v[162:163] op_sel:[0,0,0] op_sel_hi:[0,1,1]
    s_waitcnt lgkmcnt(1)
    v_pk_fma_f32 v[164:165], v[188:189], v[200:201], v[164:165] op_sel:[0,0,0] op_sel_hi:[0,1,1]
    v_pk_fma_f32 v[166:167], v[188:189], v[202:203], v[166:167] op_sel:[0,0,0] op_sel_hi:[0,1,1]
    s_waitcnt lgkmcnt(0)
    v_pk_fma_f32 v[168:169], v[188:189], v[204:205], v[168:169] op_sel:[0,0,0] op_sel_hi:[0,1,1]
    v_pk_fma_f32 v[170:171], v[188:189], v[206:207], v[170:171] op_sel:[0,0,0] op_sel_hi:[0,1,1]
    v_max_f32 v156, 0, v156
    v_max_f32 v157, 0, v157
    v_pk_mul_f32 v[164:165], v[190:191], v[164:165] op_sel:[0,0] op_sel_hi:[0,1]
    v_max_f32 v158, 0, v158
    v_max_f32 v159, 0, v159
    v_pk_mul_f32 v[166:167], v[190:191], v[166:167] op_sel:[0,0] op_sel_hi:[0,1]
    v_max_f32 v160, 0, v160
    v_max_f32 v161, 0, v161
    v_pk_mul_f32 v[168:169], v[190:191], v[168:169] op_sel:[0,0] op_sel_hi:[0,1]
    v_max_f32 v162, 0, v162
    v_max_f32 v163, 0, v163
    v_pk_mul_f32 v[170:171], v[190:191], v[170:171] op_sel:[0,0] op_sel_hi:[0,1]
    v_pk_mul_f32 v[156:157], v[156:157], v[164:165] op_sel:[0,0] op_sel_hi:[1,1]
    v_pk_mul_f32 v[158:159], v[158:159], v[166:167] op_sel:[0,0] op_sel_hi:[1,1]
    v_pk_mul_f32 v[160:161], v[160:161], v[168:169] op_sel:[0,0] op_sel_hi:[1,1]
    v_pk_mul_f32 v[162:163], v[162:163], v[170:171] op_sel:[0,0] op_sel_hi:[1,1]
    v_cvt_pk_bf16_f32 v164, v156, v157
    v_cvt_pk_bf16_f32 v165, v158, v159
    v_cvt_pk_bf16_f32 v166, v160, v161
    v_cvt_pk_bf16_f32 v167, v162, v163
    buffer_store_dwordx4 v[164:167], v6, s[16:19], 0 offen offset:1024 sc1
    v_pk_fma_f32 v[172:173], v[188:189], v[192:193], v[172:173] op_sel:[1,0,0] op_sel_hi:[1,1,1]
    v_pk_fma_f32 v[174:175], v[188:189], v[194:195], v[174:175] op_sel:[1,0,0] op_sel_hi:[1,1,1]
    v_pk_fma_f32 v[176:177], v[188:189], v[196:197], v[176:177] op_sel:[1,0,0] op_sel_hi:[1,1,1]
    v_pk_fma_f32 v[178:179], v[188:189], v[198:199], v[178:179] op_sel:[1,0,0] op_sel_hi:[1,1,1]
    v_pk_fma_f32 v[180:181], v[188:189], v[200:201], v[180:181] op_sel:[1,0,0] op_sel_hi:[1,1,1]
    v_pk_fma_f32 v[182:183], v[188:189], v[202:203], v[182:183] op_sel:[1,0,0] op_sel_hi:[1,1,1]
    v_pk_fma_f32 v[184:185], v[188:189], v[204:205], v[184:185] op_sel:[1,0,0] op_sel_hi:[1,1,1]
    v_pk_fma_f32 v[186:187], v[188:189], v[206:207], v[186:187] op_sel:[1,0,0] op_sel_hi:[1,1,1]
    v_max_f32 v172, 0, v172
    v_max_f32 v173, 0, v173
    v_pk_mul_f32 v[180:181], v[190:191], v[180:181] op_sel:[1,0] op_sel_hi:[1,1]
    v_max_f32 v174, 0, v174
    v_max_f32 v175, 0, v175
    v_pk_mul_f32 v[182:183], v[190:191], v[182:183] op_sel:[1,0] op_sel_hi:[1,1]
    v_max_f32 v176, 0, v176
    v_max_f32 v177, 0, v177
    v_pk_mul_f32 v[184:185], v[190:191], v[184:185] op_sel:[1,0] op_sel_hi:[1,1]
    v_max_f32 v178, 0, v178
    v_max_f32 v179, 0, v179
    v_pk_mul_f32 v[186:187], v[190:191], v[186:187] op_sel:[1,0] op_sel_hi:[1,1]
    v_pk_mul_f32 v[172:173], v[172:173], v[180:181] op_sel:[0,0] op_sel_hi:[1,1]
    v_pk_mul_f32 v[174:175], v[174:175], v[182:183] op_sel:[0,0] op_sel_hi:[1,1]
    v_pk_mul_f32 v[176:177], v[176:177], v[184:185] op_sel:[0,0] op_sel_hi:[1,1]
    v_pk_mul_f32 v[178:179], v[178:179], v[186:187] op_sel:[0,0] op_sel_hi:[1,1]
    v_cvt_pk_bf16_f32 v180, v172, v173
    v_cvt_pk_bf16_f32 v181, v174, v175
    v_cvt_pk_bf16_f32 v182, v176, v177
    v_cvt_pk_bf16_f32 v183, v178, v179
    buffer_store_dwordx4 v[180:183], v6, s[16:19], s7 offen offset:1024 sc1
    s_waitcnt vmcnt(0)
    s_barrier
    s_cmp_lg_u32 s22, 0
    s_cbranch_scc1 pub_64
    s_lshl_b32 s4, s21, 4
    s_add_u32 s4, s4, s20
    s_lshl_b32 s4, s4, 7
    s_add_u32 s4, s4, 0xe0000
    v_mov_b32 v2, s29
    s_mov_b64 exec, 1
    buffer_store_dword v2, off, s[72:75], s4 sc1
    s_mov_b64 exec, -1
pub_64:
    s_branch p2_entry
k1_helper:
    v_lshlrev_b32 v8, 4, v1
    v_lshrrev_b32 v2, 5, v1
    v_bfe_u32 v3, v1, 4, 1
    v_bfe_u32 v4, v1, 2, 2
    v_lshl_add_u32 v4, v3, 2, v4
    v_lshl_add_u32 v4, v2, 4, v4
    v_mul_u32_u24 v4, 1280, v4
    v_and_b32 v5, 3, v1
    v_mul_u32_u24 v5, 40, v5
    s_mul_i32 s4, s22, 160
    s_add_u32 s4, s4, 32768
    v_add3_u32 v9, v4, v5, s4
    s_mul_i32 s4, s22, 378880
    v_add_u32 v10, s4, v8
    v_mov_b32 v12, 0
    v_mov_b32 v13, 0
    v_mov_b32 v14, 0
    v_mov_b32 v15, 0
    v_mov_b32 v16, 0
    v_mov_b32 v17, 0
    v_mov_b32 v18, 0
    v_mov_b32 v19, 0
    s_waitcnt lgkmcnt(0)
    s_mov_b32 s8, s52
    s_mov_b32 s9, s53
    s_mov_b32 s10, 0x21c000
    s_mov_b32 s11, 0x00020000
    s_mov_b32 s12, s44
    s_mov_b32 s13, s45
    s_mov_b32 s14, 0xc8000
    s_mov_b32 s15, 0x00020000
    s_add_u32 s16, s58, 0x1300000
    s_addc_u32 s17, s59, 0
    s_mov_b32 s18, 0x2e4000
    s_mov_b32 s19, 0x00020000
    s_mov_b32 s76, s56
    s_mov_b32 s77, s57
    s_mov_b32 s78, 0x100
    s_mov_b32 s79, 0x00020000
    s_add_u32 s72, s58, 0x1800000
    s_addc_u32 s73, s59, 0
    s_mov_b32 s74, 0x100000
    s_mov_b32 s75, 0x00020000
    s_or_b32 s4, s2, s22
    s_cmp_lg_u32 s4, 0
    s_cbranch_scc1 k1n_65
    s_memrealtime s[6:7]
    s_waitcnt lgkmcnt(0)
    s_or_b32 s6, s6, 1
    v_mov_b32 v2, s6
    s_mov_b64 exec, 1
    buffer_store_dword v2, off, s[76:79], 0 sc1
    s_mov_b64 exec, -1
k1n_65:
    s_add_u32 s24, s20, 0
    s_mul_i32 m0, s22, 5120
    s_add_u32 m0, m0, 32768
    s_lshl_b32 s4, s24, 5
    s_lshl_b32 s5, s22, 2
    s_add_u32 s4, s4, s5
    s_mul_i32 s25, s4, 1280
    buffer_load_dwordx4 v8, s[8:11], s25 offen offset:0 lds
    buffer_load_dwordx4 v8, s[8:11], s25 offen offset:1024 lds
    buffer_load_dwordx4 v8, s[8:11], s25 offen offset:2048 lds
    buffer_load_dwordx4 v8, s[8:11], s25 offen offset:3072 lds
    s_add_u32 s25, s25, 4096
    s_add_u32 m0, m0, 4096
    s_nop 0
    buffer_load_dwordx4 v8, s[8:11], s25 offen lds
    s_mov_b32 s80, s40
    s_mov_b32 s81, s41
    s_mov_b32 s82, 0x280000
    s_mov_b32 s83, 0x00020000
    s_lshl_b32 s4, s20, 7
    s_lshl_b32 s5, s22, 4
    s_add_u32 s4, s4, s5
    s_mul_i32 s4, s4, 1280
    v_lshrrev_b32 v2, 2, v1
    v_mul_u32_u24 v2, 1280, v2
    v_and_b32 v3, 3, v1
    v_lshl_add_u32 v11, v3, 4, v2
    buffer_load_dwordx4 v[44:47], v11, s[80:83], s4 offen offset:0
    buffer_load_dwordx4 v[48:51], v11, s[80:83], s4 offen offset:64
    buffer_load_dwordx4 v[52:55], v11, s[80:83], s4 offen offset:128
    buffer_load_dwordx4 v[56:59], v11, s[80:83], s4 offen offset:192
    buffer_load_dwordx4 v[60:63], v11, s[80:83], s4 offen offset:256
    buffer_load_dwordx4 v[64:67], v11, s[80:83], s4 offen offset:320
    buffer_load_dwordx4 v[68:71], v11, s[80:83], s4 offen offset:384
    buffer_load_dwordx4 v[72:75], v11, s[80:83], s4 offen offset:448
    buffer_load_dwordx4 v[76:79], v11, s[80:83], s4 offen offset:512
    buffer_load_dwordx4 v[80:83], v11, s[80:83], s4 offen offset:576
    buffer_load_dwordx4 v[84:87], v11, s[80:83], s4 offen offset:640
    buffer_load_dwordx4 v[88:91], v11, s[80:83], s4 offen offset:704
    buffer_load_dwordx4 v[92:95], v11, s[80:83], s4 offen offset:768
    buffer_load_dwordx4 v[96:99], v11, s[80:83], s4 offen offset:832
    buffer_load_dwordx4 v[100:103], v11, s[80:83], s4 offen offset:896
    buffer_load_dwordx4 v[104:107], v11, s[80:83], s4 offen offset:960
    buffer_load_dwordx4 v[108:111], v11, s[80:83], s4 offen offset:1024
    buffer_load_dwordx4 v[112:115], v11, s[80:83], s4 offen offset:1088
    buffer_load_dwordx4 v[116:119], v11, s[80:83], s4 offen offset:1152
    buffer_load_dwordx4 v[120:123], v11, s[80:83], s4 offen offset:1216
    s_add_u32 s24, s20, 16
    s_mul_i32 m0, s22, 5120
    s_add_u32 m0, m0, 73728
    s_lshl_b32 s4, s24, 5
    s_lshl_b32 s5, s22, 2
    s_add_u32 s4, s4, s5
    s_mul_i32 s25, s4, 1280
    buffer_load_dwordx4 v8, s[8:11], s25 offen offset:0 lds
    buffer_load_dwordx4 v8, s[8:11], s25 offen offset:1024 lds
    buffer_load_dwordx4 v8, s[8:11], s25 offen offset:2048 lds
    buffer_load_dwordx4 v8, s[8:11], s25 offen offset:3072 lds
    s_add_u32 s25, s25, 4096
    s_add_u32 m0, m0, 4096
    s_nop 0
    buffer_load_dwordx4 v8, s[8:11], s25 offen lds
    s_add_u32 s24, s20, 32
    s_mul_i32 m0, s22, 5120
    s_add_u32 m0, m0, 114688
    s_lshl_b32 s4, s24, 5
    s_lshl_b32 s5, s22, 2
    s_add_u32 s4, s4, s5
    s_mul_i32 s25, s4, 1280
    buffer_load_dwordx4 v8, s[8:11], s25 offen offset:0 lds
    buffer_load_dwordx4 v8, s[8:11], s25 offen offset:1024 lds
    buffer_load_dwordx4 v8, s[8:11], s25 offen offset:2048 lds
    buffer_load_dwordx4 v8, s[8:11], s25 offen offset:3072 lds
    s_add_u32 s25, s25, 4096
    s_add_u32 m0, m0, 4096
    s_nop 0
    buffer_load_dwordx4 v8, s[8:11], s25 offen lds
    s_waitcnt vmcnt(30)
    s_barrier
    buffer_load_dword v7, off, s[76:79], 0 sc1
    s_mov_b32 s4, 0
    v_add_u32 v2, s4, v9
    ds_read_b64_tr_b16 v[24:25], v2 offset:0
    ds_read_b64_tr_b16 v[26:27], v2 offset:10240
    ds_read_b64_tr_b16 v[28:29], v2 offset:8
    ds_read_b64_tr_b16 v[30:31], v2 offset:10248
    ds_read_b64_tr_b16 v[32:33], v2 offset:16
    ds_read_b64_tr_b16 v[34:35], v2 offset:10256
    ds_read_b64_tr_b16 v[36:37], v2 offset:24
    ds_read_b64_tr_b16 v[38:39], v2 offset:10264
    ds_read_b64_tr_b16 v[40:41], v2 offset:32
    ds_read_b64_tr_b16 v[42:43], v2 offset:10272
    s_waitcnt lgkmcnt(0)
    s_barrier
    s_add_u32 s4, s20, 0
    s_mul_i32 s7, s4, 5120
    buffer_store_dwordx4 v[24:27], v10, s[16:19], s7 offen offset:0 sc1
    buffer_store_dwordx4 v[28:31], v10, s[16:19], s7 offen offset:1024 sc1
    buffer_store_dwordx4 v[32:35], v10, s[16:19], s7 offen offset:2048 sc1
    buffer_store_dwordx4 v[36:39], v10, s[16:19], s7 offen offset:3072 sc1
    s_add_u32 s7, s7, 4096
    buffer_store_dwordx4 v[40:43], v10, s[16:19], s7 offen sc1
    s_waitcnt vmcnt(16)
    v_lshlrev_b32 v20, 16, v44
    v_and_b32 v21, s39, v44
    v_add_f32 v12, v12, v20
    v_add_f32 v13, v13, v21
    v_fmac_f32 v16, v20, v20
    v_fmac_f32 v17, v21, v21
    v_lshlrev_b32 v22, 16, v45
    v_and_b32 v23, s39, v45
    v_add_f32 v14, v14, v22
    v_add_f32 v15, v15, v23
    v_fmac_f32 v18, v22, v22
    v_fmac_f32 v19, v23, v23
    v_lshlrev_b32 v20, 16, v46
    v_and_b32 v21, s39, v46
    v_add_f32 v12, v12, v20
    v_add_f32 v13, v13, v21
    v_fmac_f32 v16, v20, v20
    v_fmac_f32 v17, v21, v21
    v_lshlrev_b32 v22, 16, v47
    v_and_b32 v23, s39, v47
    v_add_f32 v14, v14, v22
    v_add_f32 v15, v15, v23
    v_fmac_f32 v18, v22, v22
    v_fmac_f32 v19, v23, v23
    v_lshlrev_b32 v20, 16, v48
    v_and_b32 v21, s39, v48
    v_add_f32 v12, v12, v20
    v_add_f32 v13, v13, v21
    v_fmac_f32 v16, v20, v20
    v_fmac_f32 v17, v21, v21
    v_lshlrev_b32 v22, 16, v49
    v_and_b32 v23, s39, v49
    v_add_f32 v14, v14, v22
    v_add_f32 v15, v15, v23
    v_fmac_f32 v18, v22, v22
    v_fmac_f32 v19, v23, v23
    v_lshlrev_b32 v20, 16, v50
    v_and_b32 v21, s39, v50
    v_add_f32 v12, v12, v20
    v_add_f32 v13, v13, v21
    v_fmac_f32 v16, v20, v20
    v_fmac_f32 v17, v21, v21
    v_lshlrev_b32 v22, 16, v51
    v_and_b32 v23, s39, v51
    v_add_f32 v14, v14, v22
    v_add_f32 v15, v15, v23
    v_fmac_f32 v18, v22, v22
    v_fmac_f32 v19, v23, v23
    v_lshlrev_b32 v20, 16, v52
    v_and_b32 v21, s39, v52
    v_add_f32 v12, v12, v20
    v_add_f32 v13, v13, v21
    v_fmac_f32 v16, v20, v20
    v_fmac_f32 v17, v21, v21
    v_lshlrev_b32 v22, 16, v53
    v_and_b32 v23, s39, v53
    v_add_f32 v14, v14, v22
    v_add_f32 v15, v15, v23
    v_fmac_f32 v18, v22, v22
    v_fmac_f32 v19, v23, v23
    v_lshlrev_b32 v20, 16, v54
    v_and_b32 v21, s39, v54
    v_add_f32 v12, v12, v20
    v_add_f32 v13, v13, v21
    v_fmac_f32 v16, v20, v20
    v_fmac_f32 v17, v21, v21
    v_lshlrev_b32 v22, 16, v55
    v_and_b32 v23, s39, v55
    v_add_f32 v14, v14, v22
    v_add_f32 v15, v15, v23
    v_fmac_f32 v18, v22, v22
    v_fmac_f32 v19, v23, v23
    v_lshlrev_b32 v20, 16, v56
    v_and_b32 v21, s39, v56
    v_add_f32 v12, v12, v20
    v_add_f32 v13, v13, v21
    v_fmac_f32 v16, v20, v20
    v_fmac_f32 v17, v21, v21
    v_lshlrev_b32 v22, 16, v57
    v_and_b32 v23, s39, v57
    v_add_f32 v14, v14, v22
    v_add_f32 v15, v15, v23
    v_fmac_f32 v18, v22, v22
    v_fmac_f32 v19, v23, v23
    v_lshlrev_b32 v20, 16, v58
    v_and_b32 v21, s39, v58
    v_add_f32 v12, v12, v20
    v_add_f32 v13, v13, v21
    v_fmac_f32 v16, v20, v20
    v_fmac_f32 v17, v21, v21
    v_lshlrev_b32 v22, 16, v59
    v_and_b32 v23, s39, v59
    v_add_f32 v14, v14, v22
    v_add_f32 v15, v15, v23
    v_fmac_f32 v18, v22, v22
    v_fmac_f32 v19, v23, v23
    v_lshlrev_b32 v20, 16, v60
    v_and_b32 v21, s39, v60
    v_add_f32 v12, v12, v20
    v_add_f32 v13, v13, v21
    v_fmac_f32 v16, v20, v20
    v_fmac_f32 v17, v21, v21
    v_lshlrev_b32 v22, 16, v61
    v_and_b32 v23, s39, v61
    v_add_f32 v14, v14, v22
    v_add_f32 v15, v15, v23
    v_fmac_f32 v18, v22, v22
    v_fmac_f32 v19, v23, v23
    v_lshlrev_b32 v20, 16, v62
    v_and_b32 v21, s39, v62
    v_add_f32 v12, v12, v20
    v_add_f32 v13, v13, v21
    v_fmac_f32 v16, v20, v20
    v_fmac_f32 v17, v21, v21
    v_lshlrev_b32 v22, 16, v63
    v_and_b32 v23, s39, v63
    v_add_f32 v14, v14, v22
    v_add_f32 v15, v15, v23
    v_fmac_f32 v18, v22, v22
    v_fmac_f32 v19, v23, v23
    v_lshlrev_b32 v20, 16, v64
    v_and_b32 v21, s39, v64
    v_add_f32 v12, v12, v20
    v_add_f32 v13, v13, v21
    v_fmac_f32 v16, v20, v20
    v_fmac_f32 v17, v21, v21
    v_lshlrev_b32 v22, 16, v65
    v_and_b32 v23, s39, v65
    v_add_f32 v14, v14, v22
    v_add_f32 v15, v15, v23
    v_fmac_f32 v18, v22, v22
    v_fmac_f32 v19, v23, v23
    v_lshlrev_b32 v20, 16, v66
    v_and_b32 v21, s39, v66
    v_add_f32 v12, v12, v20
    v_add_f32 v13, v13, v21
    v_fmac_f32 v16, v20, v20
    v_fmac_f32 v17, v21, v21
    v_lshlrev_b32 v22, 16, v67
    v_and_b32 v23, s39, v67
    v_add_f32 v14, v14, v22
    v_add_f32 v15, v15, v23
    v_fmac_f32 v18, v22, v22
    v_fmac_f32 v19, v23, v23
    v_lshlrev_b32 v20, 16, v68
    v_and_b32 v21, s39, v68
    v_add_f32 v12, v12, v20
    v_add_f32 v13, v13, v21
    v_fmac_f32 v16, v20, v20
    v_fmac_f32 v17, v21, v21
    v_lshlrev_b32 v22, 16, v69
    v_and_b32 v23, s39, v69
    v_add_f32 v14, v14, v22
    v_add_f32 v15, v15, v23
    v_fmac_f32 v18, v22, v22
    v_fmac_f32 v19, v23, v23
    v_lshlrev_b32 v20, 16, v70
    v_and_b32 v21, s39, v70
    v_add_f32 v12, v12, v20
    v_add_f32 v13, v13, v21
    v_fmac_f32 v16, v20, v20
    v_fmac_f32 v17, v21, v21
    v_lshlrev_b32 v22, 16, v71
    v_and_b32 v23, s39, v71
    v_add_f32 v14, v14, v22
    v_add_f32 v15, v15, v23
    v_fmac_f32 v18, v22, v22
    v_fmac_f32 v19, v23, v23
    v_lshlrev_b32 v20, 16, v72
    v_and_b32 v21, s39, v72
    v_add_f32 v12, v12, v20
    v_add_f32 v13, v13, v21
    v_fmac_f32 v16, v20, v20
    v_fmac_f32 v17, v21, v21
    v_lshlrev_b32 v22, 16, v73
    v_and_b32 v23, s39, v73
    v_add_f32 v14, v14, v22
    v_add_f32 v15, v15, v23
    v_fmac_f32 v18, v22, v22
    v_fmac_f32 v19, v23, v23
    v_lshlrev_b32 v20, 16, v74
    v_and_b32 v21, s39, v74
    v_add_f32 v12, v12, v20
    v_add_f32 v13, v13, v21
    v_fmac_f32 v16, v20, v20
    v_fmac_f32 v17, v21, v21
    v_lshlrev_b32 v22, 16, v75
    v_and_b32 v23, s39, v75
    v_add_f32 v14, v14, v22
    v_add_f32 v15, v15, v23
    v_fmac_f32 v18, v22, v22
    v_fmac_f32 v19, v23, v23
    v_lshlrev_b32 v20, 16, v76
    v_and_b32 v21, s39, v76
    v_add_f32 v12, v12, v20
    v_add_f32 v13, v13, v21
    v_fmac_f32 v16, v20, v20
    v_fmac_f32 v17, v21, v21
    v_lshlrev_b32 v22, 16, v77
    v_and_b32 v23, s39, v77
    v_add_f32 v14, v14, v22
    v_add_f32 v15, v15, v23
    v_fmac_f32 v18, v22, v22
    v_fmac_f32 v19, v23, v23
    v_lshlrev_b32 v20, 16, v78
    v_and_b32 v21, s39, v78
    v_add_f32 v12, v12, v20
    v_add_f32 v13, v13, v21
    v_fmac_f32 v16, v20, v20
    v_fmac_f32 v17, v21, v21
    v_lshlrev_b32 v22, 16, v79
    v_and_b32 v23, s39, v79
    v_add_f32 v14, v14, v22
    v_add_f32 v15, v15, v23
    v_fmac_f32 v18, v22, v22
    v_fmac_f32 v19, v23, v23
    v_lshlrev_b32 v20, 16, v80
    v_and_b32 v21, s39, v80
    v_add_f32 v12, v12, v20
    v_add_f32 v13, v13, v21
    v_fmac_f32 v16, v20, v20
    v_fmac_f32 v17, v21, v21
    v_lshlrev_b32 v22, 16, v81
    v_and_b32 v23, s39, v81
    v_add_f32 v14, v14, v22
    v_add_f32 v15, v15, v23
    v_fmac_f32 v18, v22, v22
    v_fmac_f32 v19, v23, v23
    v_lshlrev_b32 v20, 16, v82
    v_and_b32 v21, s39, v82
    v_add_f32 v12, v12, v20
    v_add_f32 v13, v13, v21
    v_fmac_f32 v16, v20, v20
    v_fmac_f32 v17, v21, v21
    v_lshlrev_b32 v22, 16, v83
    v_and_b32 v23, s39, v83
    v_add_f32 v14, v14, v22
    v_add_f32 v15, v15, v23
    v_fmac_f32 v18, v22, v22
    v_fmac_f32 v19, v23, v23
    v_lshlrev_b32 v20, 16, v84
    v_and_b32 v21, s39, v84
    v_add_f32 v12, v12, v20
    v_add_f32 v13, v13, v21
    v_fmac_f32 v16, v20, v20
    v_fmac_f32 v17, v21, v21
    v_lshlrev_b32 v22, 16, v85
    v_and_b32 v23, s39, v85
    v_add_f32 v14, v14, v22
    v_add_f32 v15, v15, v23
    v_fmac_f32 v18, v22, v22
    v_fmac_f32 v19, v23, v23
    v_lshlrev_b32 v20, 16, v86
    v_and_b32 v21, s39, v86
    v_add_f32 v12, v12, v20
    v_add_f32 v13, v13, v21
    v_fmac_f32 v16, v20, v20
    v_fmac_f32 v17, v21, v21
    v_lshlrev_b32 v22, 16, v87
    v_and_b32 v23, s39, v87
    v_add_f32 v14, v14, v22
    v_add_f32 v15, v15, v23
    v_fmac_f32 v18, v22, v22
    v_fmac_f32 v19, v23, v23
    v_lshlrev_b32 v20, 16, v88
    v_and_b32 v21, s39, v88
    v_add_f32 v12, v12, v20
    v_add_f32 v13, v13, v21
    v_fmac_f32 v16, v20, v20
    v_fmac_f32 v17, v21, v21
    v_lshlrev_b32 v22, 16, v89
    v_and_b32 v23, s39, v89
    v_add_f32 v14, v14, v22
    v_add_f32 v15, v15, v23
    v_fmac_f32 v18, v22, v22
    v_fmac_f32 v19, v23, v23
    v_lshlrev_b32 v20, 16, v90
    v_and_b32 v21, s39, v90
    v_add_f32 v12, v12, v20
    v_add_f32 v13, v13, v21
    v_fmac_f32 v16, v20, v20
    v_fmac_f32 v17, v21, v21
    v_lshlrev_b32 v22, 16, v91
    v_and_b32 v23, s39, v91
    v_add_f32 v14, v14, v22
    v_add_f32 v15, v15, v23
    v_fmac_f32 v18, v22, v22
    v_fmac_f32 v19, v23, v23
    v_lshlrev_b32 v20, 16, v92
    v_and_b32 v21, s39, v92
    v_add_f32 v12, v12, v20
    v_add_f32 v13, v13, v21
    v_fmac_f32 v16, v20, v20
    v_fmac_f32 v17, v21, v21
    v_lshlrev_b32 v22, 16, v93
    v_and_b32 v23, s39, v93
    v_add_f32 v14, v14, v22
    v_add_f32 v15, v15, v23
    v_fmac_f32 v18, v22, v22
    v_fmac_f32 v19, v23, v23
    v_lshlrev_b32 v20, 16, v94
    v_and_b32 v21, s39, v94
    v_add_f32 v12, v12, v20
    v_add_f32 v13, v13, v21
    v_fmac_f32 v16, v20, v20
    v_fmac_f32 v17, v21, v21
    v_lshlrev_b32 v22, 16, v95
    v_and_b32 v23, s39, v95
    v_add_f32 v14, v14, v22
    v_add_f32 v15, v15, v23
    v_fmac_f32 v18, v22, v22
    v_fmac_f32 v19, v23, v23
    v_lshlrev_b32 v20, 16, v96
    v_and_b32 v21, s39, v96
    v_add_f32 v12, v12, v20
    v_add_f32 v13, v13, v21
    v_fmac_f32 v16, v20, v20
    v_fmac_f32 v17, v21, v21
    v_lshlrev_b32 v22, 16, v97
    v_and_b32 v23, s39, v97
    v_add_f32 v14, v14, v22
    v_add_f32 v15, v15, v23
    v_fmac_f32 v18, v22, v22
    v_fmac_f32 v19, v23, v23
    v_lshlrev_b32 v20, 16, v98
    v_and_b32 v21, s39, v98
    v_add_f32 v12, v12, v20
    v_add_f32 v13, v13, v21
    v_fmac_f32 v16, v20, v20
    v_fmac_f32 v17, v21, v21
    v_lshlrev_b32 v22, 16, v99
    v_and_b32 v23, s39, v99
    v_add_f32 v14, v14, v22
    v_add_f32 v15, v15, v23
    v_fmac_f32 v18, v22, v22
    v_fmac_f32 v19, v23, v23
    v_lshlrev_b32 v20, 16, v100
    v_and_b32 v21, s39, v100
    v_add_f32 v12, v12, v20
    v_add_f32 v13, v13, v21
    v_fmac_f32 v16, v20, v20
    v_fmac_f32 v17, v21, v21
    v_lshlrev_b32 v22, 16, v101
    v_and_b32 v23, s39, v101
    v_add_f32 v14, v14, v22
    v_add_f32 v15, v15, v23
    v_fmac_f32 v18, v22, v22
    v_fmac_f32 v19, v23, v23
    v_lshlrev_b32 v20, 16, v102
    v_and_b32 v21, s39, v102
    v_add_f32 v12, v12, v20
    v_add_f32 v13, v13, v21
    v_fmac_f32 v16, v20, v20
    v_fmac_f32 v17, v21, v21
    v_lshlrev_b32 v22, 16, v103
    v_and_b32 v23, s39, v103
    v_add_f32 v14, v14, v22
    v_add_f32 v15, v15, v23
    v_fmac_f32 v18, v22, v22
    v_fmac_f32 v19, v23, v23
    v_lshlrev_b32 v20, 16, v104
    v_and_b32 v21, s39, v104
    v_add_f32 v12, v12, v20
    v_add_f32 v13, v13, v21
    v_fmac_f32 v16, v20, v20
    v_fmac_f32 v17, v21, v21
    v_lshlrev_b32 v22, 16, v105
    v_and_b32 v23, s39, v105
    v_add_f32 v14, v14, v22
    v_add_f32 v15, v15, v23
    v_fmac_f32 v18, v22, v22
    v_fmac_f32 v19, v23, v23
    v_lshlrev_b32 v20, 16, v106
    v_and_b32 v21, s39, v106
    v_add_f32 v12, v12, v20
    v_add_f32 v13, v13, v21
    v_fmac_f32 v16, v20, v20
    v_fmac_f32 v17, v21, v21
    v_lshlrev_b32 v22, 16, v107
    v_and_b32 v23, s39, v107
    v_add_f32 v14, v14, v22
    v_add_f32 v15, v15, v23
    v_fmac_f32 v18, v22, v22
    v_fmac_f32 v19, v23, v23
    v_lshlrev_b32 v20, 16, v108
    v_and_b32 v21, s39, v108
    v_add_f32 v12, v12, v20
    v_add_f32 v13, v13, v21
    v_fmac_f32 v16, v20, v20
    v_fmac_f32 v17, v21, v21
    v_lshlrev_b32 v22, 16, v109
    v_and_b32 v23, s39, v109
    v_add_f32 v14, v14, v22
    v_add_f32 v15, v15, v23
    v_fmac_f32 v18, v22, v22
    v_fmac_f32 v19, v23, v23
    v_lshlrev_b32 v20, 16, v110
    v_and_b32 v21, s39, v110
    v_add_f32 v12, v12, v20
    v_add_f32 v13, v13, v21
    v_fmac_f32 v16, v20, v20
    v_fmac_f32 v17, v21, v21
    v_lshlrev_b32 v22, 16, v111
    v_and_b32 v23, s39, v111
    v_add_f32 v14, v14, v22
    v_add_f32 v15, v15, v23
    v_fmac_f32 v18, v22, v22
    v_fmac_f32 v19, v23, v23
    v_lshlrev_b32 v20, 16, v112
    v_and_b32 v21, s39, v112
    v_add_f32 v12, v12, v20
    v_add_f32 v13, v13, v21
    v_fmac_f32 v16, v20, v20
    v_fmac_f32 v17, v21, v21
    v_lshlrev_b32 v22, 16, v113
    v_and_b32 v23, s39, v113
    v_add_f32 v14, v14, v22
    v_add_f32 v15, v15, v23
    v_fmac_f32 v18, v22, v22
    v_fmac_f32 v19, v23, v23
    v_lshlrev_b32 v20, 16, v114
    v_and_b32 v21, s39, v114
    v_add_f32 v12, v12, v20
    v_add_f32 v13, v13, v21
    v_fmac_f32 v16, v20, v20
    v_fmac_f32 v17, v21, v21
    v_lshlrev_b32 v22, 16, v115
    v_and_b32 v23, s39, v115
    v_add_f32 v14, v14, v22
    v_add_f32 v15, v15, v23
    v_fmac_f32 v18, v22, v22
    v_fmac_f32 v19, v23, v23
    v_lshlrev_b32 v20, 16, v116
    v_and_b32 v21, s39, v116
    v_add_f32 v12, v12, v20
    v_add_f32 v13, v13, v21
    v_fmac_f32 v16, v20, v20
    v_fmac_f32 v17, v21, v21
    v_lshlrev_b32 v22, 16, v117
    v_and_b32 v23, s39, v117
    v_add_f32 v14, v14, v22
    v_add_f32 v15, v15, v23
    v_fmac_f32 v18, v22, v22
    v_fmac_f32 v19, v23, v23
    v_lshlrev_b32 v20, 16, v118
    v_and_b32 v21, s39, v118
    v_add_f32 v12, v12, v20
    v_add_f32 v13, v13, v21
    v_fmac_f32 v16, v20, v20
    v_fmac_f32 v17, v21, v21
    v_lshlrev_b32 v22, 16, v119
    v_and_b32 v23, s39, v119
    v_add_f32 v14, v14, v22
    v_add_f32 v15, v15, v23
    v_fmac_f32 v18, v22, v22
    v_fmac_f32 v19, v23, v23
    v_lshlrev_b32 v20, 16, v120
    v_and_b32 v21, s39, v120
    v_add_f32 v12, v12, v20
    v_add_f32 v13, v13, v21
    v_fmac_f32 v16, v20, v20
    v_fmac_f32 v17, v21, v21
    v_lshlrev_b32 v22, 16, v121
    v_and_b32 v23, s39, v121
    v_add_f32 v14, v14, v22
    v_add_f32 v15, v15, v23
    v_fmac_f32 v18, v22, v22
    v_fmac_f32 v19, v23, v23
    v_lshlrev_b32 v20, 16, v122
    v_and_b32 v21, s39, v122
    v_add_f32 v12, v12, v20
    v_add_f32 v13, v13, v21
    v_fmac_f32 v16, v20, v20
    v_fmac_f32 v17, v21, v21
    v_lshlrev_b32 v22, 16, v123
    v_and_b32 v23, s39, v123
    v_add_f32 v14, v14, v22
    v_add_f32 v15, v15, v23
    v_fmac_f32 v18, v22, v22
    v_fmac_f32 v19, v23, v23
    v_add_f32 v12, v12, v13
    v_add_f32 v14, v14, v15
    v_add_f32 v16, v16, v17
    v_add_f32 v18, v18, v19
    v_add_f32 v12, v12, v14
    v_add_f32 v16, v16, v18
    s_mov_b32 s4, 0x3acccccd
    s_mov_b32 s5, 0x3727c5ac
    s_nop 1
    v_add_f32_dpp v12, v12, v12 quad_perm:[1,0,3,2] row_mask:0xf bank_mask:0xf
    v_add_f32_dpp v16, v16, v16 quad_perm:[1,0,3,2] row_mask:0xf bank_mask:0xf
    s_nop 1
    v_add_f32_dpp v12, v12, v12 quad_perm:[2,3,0,1] row_mask:0xf bank_mask:0xf
    v_add_f32_dpp v16, v16, v16 quad_perm:[2,3,0,1] row_mask:0xf bank_mask:0xf
    s_nop 0
    v_mul_f32 v13, s4, v12
    v_mul_f32 v16, s4, v16
    v_fma_f32 v16, -v13, v13, v16
    v_max_f32 v16, 0, v16
    v_add_f32 v16, s5, v16
    v_rsq_f32 v12, v16
    v_sub_f32 v13, 0, v13
    s_mov_b32 s23, 200000
    s_waitcnt vmcnt(5)
csn_67:
    v_readfirstlane_b32 s29, v7
    s_cmp_lg_u32 s29, 0
    s_cbranch_scc1 csn_67_ok
    s_sleep 2
    buffer_load_dword v7, off, s[76:79], 0 sc1
    s_waitcnt vmcnt(0)
    s_sub_u32 s23, s23, 1
    s_cmp_lg_u32 s23, 0
    s_cbranch_scc1 csn_67
csn_67_ok:
    v_mov_b32 v14, s29
    v_mov_b32 v15, s29
    v_lshrrev_b32 v2, 2, v1
    v_lshlrev_b32 v2, 4, v2
    s_lshl_b32 s4, s20, 11
    s_lshl_b32 s5, s22, 8
    s_add_u32 s4, s4, s5
    s_add_u32 s4, s4, 65536
    s_mov_b32 exec_lo, 0x11111111
    s_mov_b32 exec_hi, 0x11111111
    buffer_store_dwordx4 v[12:15], v2, s[72:75], s4 offen sc1
    s_mov_b64 exec, -1
    s_barrier
    s_mov_b32 s4, 40960
    v_add_u32 v2, s4, v9
    ds_read_b64_tr_b16 v[24:25], v2 offset:0
    ds_read_b64_tr_b16 v[26:27], v2 offset:10240
    ds_read_b64_tr_b16 v[28:29], v2 offset:8
    ds_read_b64_tr_b16 v[30:31], v2 offset:10248
    ds_read_b64_tr_b16 v[32:33], v2 offset:16
    ds_read_b64_tr_b16 v[34:35], v2 offset:10256
    ds_read_b64_tr_b16 v[36:37], v2 offset:24
    ds_read_b64_tr_b16 v[38:39], v2 offset:10264
    ds_read_b64_tr_b16 v[40:41], v2 offset:32
    ds_read_b64_tr_b16 v[42:43], v2 offset:10272
    s_waitcnt lgkmcnt(0)
    s_barrier
    s_add_u32 s4, s20, 16
    s_mul_i32 s7, s4, 5120
    buffer_store_dwordx4 v[24:27], v10, s[16:19], s7 offen offset:0 sc1
    buffer_store_dwordx4 v[28:31], v10, s[16:19], s7 offen offset:1024 sc1
    buffer_store_dwordx4 v[32:35], v10, s[16:19], s7 offen offset:2048 sc1
    buffer_store_dwordx4 v[36:39], v10, s[16:19], s7 offen offset:3072 sc1
    s_add_u32 s7, s7, 4096
    buffer_store_dwordx4 v[40:43], v10, s[16:19], s7 offen sc1
    s_add_u32 s24, s20, 48
    s_mul_i32 m0, s22, 5120
    s_add_u32 m0, m0, 32768
    s_cmp_ge_u32 s24, 54
    s_cbranch_scc1 w3_70_o
    s_lshl_b32 s4, s24, 5
    s_lshl_b32 s5, s22, 2
    s_add_u32 s4, s4, s5
    s_mul_i32 s25, s4, 1280
    buffer_load_dwordx4 v8, s[8:11], s25 offen offset:0 lds
    buffer_load_dwordx4 v8, s[8:11], s25 offen offset:1024 lds
    buffer_load_dwordx4 v8, s[8:11], s25 offen offset:2048 lds
    buffer_load_dwordx4 v8, s[8:11], s25 offen offset:3072 lds
    s_add_u32 s25, s25, 4096
    s_add_u32 m0, m0, 4096
    s_nop 0
    buffer_load_dwordx4 v8, s[8:11], s25 offen lds
    s_branch w3_70_go
w3_70_o:
    s_cmp_ge_u32 s24, 70
    s_cbranch_scc1 w3_70_x
    s_sub_u32 s4, s24, 54
    s_mul_i32 s4, s4, 40
    s_lshr_b32 s5, s22, 2
    s_mul_i32 s5, s5, 20
    s_add_u32 s4, s4, s5
    s_and_b32 s5, s22, 3
    s_lshl_b32 s5, s5, 2
    s_add_u32 s4, s4, s5
    s_branch w3_70_wo
w3_70_x:
    s_sub_u32 s4, s24, 70
    s_lshl_b32 s4, s4, 3
    s_lshr_b32 s5, s22, 2
    s_lshl_b32 s5, s5, 2
    s_add_u32 s4, s4, s5
    s_and_b32 s5, s22, 1
    s_lshl_b32 s5, s5, 1
    s_add_u32 s4, s4, s5
    s_bfe_u32 s5, s22, 0x10001
    s_add_u32 s4, s4, s5
    s_mul_i32 s4, s4, 20
    s_add_u32 s4, s4, 16
w3_70_wo:
    s_mul_i32 s25, s4, 1280
    buffer_load_dwordx4 v8, s[12:15], s25 offen offset:0 lds
    buffer_load_dwordx4 v8, s[12:15], s25 offen offset:1024 lds
    buffer_load_dwordx4 v8, s[12:15], s25 offen offset:2048 lds
    buffer_load_dwordx4 v8, s[12:15], s25 offen offset:3072 lds
    s_add_u32 s25, s25, 4096
    s_add_u32 m0, m0, 4096
    s_nop 0
    buffer_load_dwordx4 v8, s[12:15], s25 offen lds
w3_70_go:
    s_cmp_ge_u32 s20, 10
    s_cbranch_scc1 w3s_71
    s_add_u32 s24, s20, 64
    s_mul_i32 m0, s22, 5120
    s_add_u32 m0, m0, 73728
    s_cmp_ge_u32 s24, 54
    s_cbranch_scc1 w3_72_o
    s_branch w3_72_go
w3_72_o:
    s_cmp_ge_u32 s24, 70
    s_cbranch_scc1 w3_72_x
    s_sub_u32 s4, s24, 54
    s_mul_i32 s4, s4, 40
    s_lshr_b32 s5, s22, 2
    s_mul_i32 s5, s5, 20
    s_add_u32 s4, s4, s5
    s_and_b32 s5, s22, 3
    s_lshl_b32 s5, s5, 2
    s_add_u32 s4, s4, s5
    s_branch w3_72_wo
w3_72_x:
    s_sub_u32 s4, s24, 70
    s_lshl_b32 s4, s4, 3
    s_lshr_b32 s5, s22, 2
    s_lshl_b32 s5, s5, 2
    s_add_u32 s4, s4, s5
    s_and_b32 s5, s22, 1
    s_lshl_b32 s5, s5, 1
    s_add_u32 s4, s4, s5
    s_bfe_u32 s5, s22, 0x10001
    s_add_u32 s4, s4, s5
    s_mul_i32 s4, s4, 20
    s_add_u32 s4, s4, 16
w3_72_wo:
    s_mul_i32 s25, s4, 1280
    buffer_load_dwordx4 v8, s[12:15], s25 offen offset:0 lds
    buffer_load_dwordx4 v8, s[12:15], s25 offen offset:1024 lds
    buffer_load_dwordx4 v8, s[12:15], s25 offen offset:2048 lds
    buffer_load_dwordx4 v8, s[12:15], s25 offen offset:3072 lds
    s_add_u32 s25, s25, 4096
    s_add_u32 m0, m0, 4096
    s_nop 0
    buffer_load_dwordx4 v8, s[12:15], s25 offen lds
w3_72_go:
w3s_71:
    s_mov_b32 s4, 81920
    v_add_u32 v2, s4, v9
    ds_read_b64_tr_b16 v[24:25], v2 offset:0
    ds_read_b64_tr_b16 v[26:27], v2 offset:10240
    ds_read_b64_tr_b16 v[28:29], v2 offset:8
    ds_read_b64_tr_b16 v[30:31], v2 offset:10248
    ds_read_b64_tr_b16 v[32:33], v2 offset:16
    ds_read_b64_tr_b16 v[34:35], v2 offset:10256
    ds_read_b64_tr_b16 v[36:37], v2 offset:24
    ds_read_b64_tr_b16 v[38:39], v2 offset:10264
    ds_read_b64_tr_b16 v[40:41], v2 offset:32
    ds_read_b64_tr_b16 v[42:43], v2 offset:10272
    s_waitcnt lgkmcnt(0)
    s_barrier
    s_branch csg_73_skip
    s_cmp_eq_u32 s20, 15
    s_cbranch_scc1 csg_73_skip
    s_cmp_ge_u32 s22, 3
    s_cbranch_scc1 csg_73_skip
    s_mov_b32 s5, 159
    s_cmp_lt_u32 s20, 6
    s_cselect_b32 s4, s5, 191
    v_min_u32 v2, s4, v0
    v_lshlrev_b32 v3, 4, v2
    s_mov_b32 s23, 200000
    s_mul_i32 s4, s20, 49152
    s_add_u32 s4, s4, 131072
    buffer_load_dwordx4 v[44:47], v3, s[72:75], s4 offen sc1
    s_add_u32 s4, s4, 3072
    buffer_load_dwordx4 v[48:51], v3, s[72:75], s4 offen sc1
    s_add_u32 s4, s4, 3072
    buffer_load_dwordx4 v[52:55], v3, s[72:75], s4 offen sc1
    s_add_u32 s4, s4, 3072
    buffer_load_dwordx4 v[56:59], v3, s[72:75], s4 offen sc1
    s_add_u32 s4, s4, 3072
    buffer_load_dwordx4 v[60:63], v3, s[72:75], s4 offen sc1
    s_add_u32 s4, s4, 3072
    buffer_load_dwordx4 v[64:67], v3, s[72:75], s4 offen sc1
    s_add_u32 s4, s4, 3072
    buffer_load_dwordx4 v[68:71], v3, s[72:75], s4 offen sc1
    s_add_u32 s4, s4, 3072
    buffer_load_dwordx4 v[72:75], v3, s[72:75], s4 offen sc1
    s_add_u32 s4, s4, 3072
    buffer_load_dwordx4 v[76:79], v3, s[72:75], s4 offen sc1
    s_add_u32 s4, s4, 3072
    buffer_load_dwordx4 v[80:83], v3, s[72:75], s4 offen sc1
    s_add_u32 s4, s4, 3072
    buffer_load_dwordx4 v[84:87], v3, s[72:75], s4 offen sc1
    s_add_u32 s4, s4, 3072
    buffer_load_dwordx4 v[88:91], v3, s[72:75], s4 offen sc1
    s_add_u32 s4, s4, 3072
    buffer_load_dwordx4 v[92:95], v3, s[72:75], s4 offen sc1
    s_add_u32 s4, s4, 3072
    buffer_load_dwordx4 v[96:99], v3, s[72:75], s4 offen sc1
    s_add_u32 s4, s4, 3072
    buffer_load_dwordx4 v[100:103], v3, s[72:75], s4 offen sc1
    s_add_u32 s4, s4, 3072
    buffer_load_dwordx4 v[104:107], v3, s[72:75], s4 offen sc1
    s_add_u32 s4, s20, 32
    s_mul_i32 s7, s4, 5120
    buffer_store_dwordx4 v[24:27], v10, s[16:19], s7 offen offset:0 sc1
    buffer_store_dwordx4 v[28:31], v10, s[16:19], s7 offen offset:1024 sc1
    buffer_store_dwordx4 v[32:35], v10, s[16:19], s7 offen offset:2048 sc1
    buffer_store_dwordx4 v[36:39], v10, s[16:19], s7 offen offset:3072 sc1
    s_add_u32 s7, s7, 4096
    buffer_store_dwordx4 v[40:43], v10, s[16:19], s7 offen sc1
    s_waitcnt vmcnt(5)
    s_branch csg_73_chk
csg_73:
    s_mul_i32 s4, s20, 49152
    s_add_u32 s4, s4, 131072
    buffer_load_dwordx4 v[44:47], v3, s[72:75], s4 offen sc1
    s_add_u32 s4, s4, 3072
    buffer_load_dwordx4 v[48:51], v3, s[72:75], s4 offen sc1
    s_add_u32 s4, s4, 3072
    buffer_load_dwordx4 v[52:55], v3, s[72:75], s4 offen sc1
    s_add_u32 s4, s4, 3072
    buffer_load_dwordx4 v[56:59], v3, s[72:75], s4 offen sc1
    s_add_u32 s4, s4, 3072
    buffer_load_dwordx4 v[60:63], v3, s[72:75], s4 offen sc1
    s_add_u32 s4, s4, 3072
    buffer_load_dwordx4 v[64:67], v3, s[72:75], s4 offen sc1
    s_add_u32 s4, s4, 3072
    buffer_load_dwordx4 v[68:71], v3, s[72:75], s4 offen sc1
    s_add_u32 s4, s4, 3072
    buffer_load_dwordx4 v[72:75], v3, s[72:75], s4 offen sc1
    s_add_u32 s4, s4, 3072
    buffer_load_dwordx4 v[76:79], v3, s[72:75], s4 offen sc1
    s_add_u32 s4, s4, 3072
    buffer_load_dwordx4 v[80:83], v3, s[72:75], s4 offen sc1
    s_add_u32 s4, s4, 3072
    buffer_load_dwordx4 v[84:87], v3, s[72:75], s4 offen sc1
    s_add_u32 s4, s4, 3072
    buffer_load_dwordx4 v[88:91], v3, s[72:75], s4 offen sc1
    s_add_u32 s4, s4, 3072
    buffer_load_dwordx4 v[92:95], v3, s[72:75], s4 offen sc1
    s_add_u32 s4, s4, 3072
    buffer_load_dwordx4 v[96:99], v3, s[72:75], s4 offen sc1
    s_add_u32 s4, s4, 3072
    buffer_load_dwordx4 v[100:103], v3, s[72:75], s4 offen sc1
    s_add_u32 s4, s4, 3072
    buffer_load_dwordx4 v[104:107], v3, s[72:75], s4 offen sc1
    s_waitcnt vmcnt(0)
csg_73_chk:
    v_xor_b32 v4, s29, v46
    v_xor_b32 v5, s29, v50
    v_or_b32 v4, v4, v5
    v_xor_b32 v5, s29, v54
    v_or_b32 v4, v4, v5
    v_xor_b32 v5, s29, v58
    v_or_b32 v4, v4, v5
    v_xor_b32 v5, s29, v62
    v_or_b32 v4, v4, v5
    v_xor_b32 v5, s29, v66
    v_or_b32 v4, v4, v5
    v_xor_b32 v5, s29, v70
    v_or_b32 v4, v4, v5
    v_xor_b32 v5, s29, v74
    v_or_b32 v4, v4, v5
    v_xor_b32 v5, s29, v78
    v_or_b32 v4, v4, v5
    v_xor_b32 v5, s29, v82
    v_or_b32 v4, v4, v5
    v_xor_b32 v5, s29, v86
    v_or_b32 v4, v4, v5
    v_xor_b32 v5, s29, v90
    v_or_b32 v4, v4, v5
    v_xor_b32 v5, s29, v94
    v_or_b32 v4, v4, v5
    v_xor_b32 v5, s29, v98
    v_or_b32 v4, v4, v5
    v_xor_b32 v5, s29, v102
    v_or_b32 v4, v4, v5
    v_xor_b32 v5, s29, v106
    v_or_b32 v4, v4, v5
    v_cmp_ne_u32 vcc, 0, v4
    s_nop 1
    s_cbranch_vccz csg_73_ok
    s_sleep 4
    s_sub_u32 s23, s23, 1
    s_cmp_lg_u32 s23, 0
    s_cbranch_scc1 csg_73
csg_73_ok:
    v_add_f32 v44, v44, v48
    v_add_f32 v45, v45, v49
    v_add_f32 v44, v44, v52
    v_add_f32 v45, v45, v53
    v_add_f32 v44, v44, v56
    v_add_f32 v45, v45, v57
    v_add_f32 v44, v44, v60
    v_add_f32 v45, v45, v61
    v_add_f32 v44, v44, v64
    v_add_f32 v45, v45, v65
    v_add_f32 v44, v44, v68
    v_add_f32 v45, v45, v69
    v_add_f32 v44, v44, v72
    v_add_f32 v45, v45, v73
    v_add_f32 v44, v44, v76
    v_add_f32 v45, v45, v77
    v_add_f32 v44, v44, v80
    v_add_f32 v45, v45, v81
    v_add_f32 v44, v44, v84
    v_add_f32 v45, v45, v85
    v_add_f32 v44, v44, v88
    v_add_f32 v45, v45, v89
    v_add_f32 v44, v44, v92
    v_add_f32 v45, v45, v93
    v_add_f32 v44, v44, v96
    v_add_f32 v45, v45, v97
    v_add_f32 v44, v44, v100
    v_add_f32 v45, v45, v101
    v_add_f32 v44, v44, v104
    v_add_f32 v45, v45, v105
    v_mov_b32 v46, v45
    v_mov_b32 v45, s29
    v_mov_b32 v47, s29
    v_lshrrev_b32 v4, 4, v2
    v_and_b32 v5, 15, v2
    v_lshlrev_b32 v5, 3, v5
    v_lshl_add_u32 v5, v4, 8, v5
    s_mul_i32 s4, s20, 3072
    buffer_store_dwordx2 v[44:45], v5, s[72:75], s4 offen sc1
    buffer_store_dwordx2 v[46:47], v5, s[72:75], s4 offen offset:128 sc1
    s_branch csg_73_end
csg_73_skip:
    s_add_u32 s4, s20, 32
    s_mul_i32 s7, s4, 5120
    buffer_store_dwordx4 v[24:27], v10, s[16:19], s7 offen offset:0 sc1
    buffer_store_dwordx4 v[28:31], v10, s[16:19], s7 offen offset:1024 sc1
    buffer_store_dwordx4 v[32:35], v10, s[16:19], s7 offen offset:2048 sc1
    buffer_store_dwordx4 v[36:39], v10, s[16:19], s7 offen offset:3072 sc1
    s_add_u32 s7, s7, 4096
    buffer_store_dwordx4 v[40:43], v10, s[16:19], s7 offen sc1
csg_73_end:
    s_waitcnt vmcnt(5)
    s_barrier
    s_mov_b32 s4, 0
    v_add_u32 v2, s4, v9
    ds_read_b64_tr_b16 v[24:25], v2 offset:0
    ds_read_b64_tr_b16 v[26:27], v2 offset:10240
    ds_read_b64_tr_b16 v[28:29], v2 offset:8
    ds_read_b64_tr_b16 v[30:31], v2 offset:10248
    ds_read_b64_tr_b16 v[32:33], v2 offset:16
    ds_read_b64_tr_b16 v[34:35], v2 offset:10256
    ds_read_b64_tr_b16 v[36:37], v2 offset:24
    ds_read_b64_tr_b16 v[38:39], v2 offset:10264
    ds_read_b64_tr_b16 v[40:41], v2 offset:32
    ds_read_b64_tr_b16 v[42:43], v2 offset:10272
    s_waitcnt lgkmcnt(0)
    s_barrier
    s_add_u32 s4, s20, 48
    s_mul_i32 s7, s4, 5120
    buffer_store_dwordx4 v[24:27], v10, s[16:19], s7 offen offset:0 sc1
    buffer_store_dwordx4 v[28:31], v10, s[16:19], s7 offen offset:1024 sc1
    buffer_store_dwordx4 v[32:35], v10, s[16:19], s7 offen offset:2048 sc1
    buffer_store_dwordx4 v[36:39], v10, s[16:19], s7 offen offset:3072 sc1
    s_add_u32 s7, s7, 4096
    buffer_store_dwordx4 v[40:43], v10, s[16:19], s7 offen sc1
    s_cmp_ge_u32 s20, 10
    s_cbranch_scc1 k1_h_end
    s_mov_b32 s4, 40960
    v_add_u32 v2, s4, v9
    ds_read_b64_tr_b16 v[24:25], v2 offset:0
    ds_read_b64_tr_b16 v[26:27], v2 offset:10240
    ds_read_b64_tr_b16 v[28:29], v2 offset:8
    ds_read_b64_tr_b16 v[30:31], v2 offset:10248
    ds_read_b64_tr_b16 v[32:33], v2 offset:16
    ds_read_b64_tr_b16 v[34:35], v2 offset:10256
    ds_read_b64_tr_b16 v[36:37], v2 offset:24
    ds_read_b64_tr_b16 v[38:39], v2 offset:10264
    ds_read_b64_tr_b16 v[40:41], v2 offset:32
    ds_read_b64_tr_b16 v[42:43], v2 offset:10272
    s_waitcnt lgkmcnt(0)
    s_barrier
    s_add_u32 s4, s20, 64
    s_mul_i32 s7, s4, 5120
    buffer_store_dwordx4 v[24:27], v10, s[16:19], s7 offen offset:0 sc1
    buffer_store_dwordx4 v[28:31], v10, s[16:19], s7 offen offset:1024 sc1
    buffer_store_dwordx4 v[32:35], v10, s[16:19], s7 offen offset:2048 sc1
    buffer_store_dwordx4 v[36:39], v10, s[16:19], s7 offen offset:3072 sc1
    s_add_u32 s7, s7, 4096
    buffer_store_dwordx4 v[40:43], v10, s[16:19], s7 offen sc1
k1_h_end:
    s_waitcnt vmcnt(0)
    s_barrier
    s_cmp_lg_u32 s22, 0
    s_cbranch_scc1 pub_74
    s_lshl_b32 s4, s21, 4
    s_add_u32 s4, s4, s20
    s_lshl_b32 s4, s4, 7
    s_add_u32 s4, s4, 0xe0000
    v_mov_b32 v2, s29
    s_mov_b64 exec, 1
    buffer_store_dword v2, off, s[72:75], s4 sc1
    s_mov_b64 exec, -1
pub_74:
    s_branch p2_entry
p2_entry:
    s_and_b32 s3, s2, 7
    s_lshr_b32 s4, s2, 3
    s_lshl_b32 s5, s3, 1
    s_lshr_b32 s6, s4, 4
    s_add_u32 s20, s5, s6
    s_and_b32 s21, s4, 15
    s_lshr_b32 s5, s3, 1
    s_lshl_b32 s5, s5, 3
    s_and_b32 s6, s4, 7
    s_add_u32 s65, s5, s6
    s_and_b32 s5, s3, 1
    s_lshl_b32 s5, s5, 2
    s_lshr_b32 s6, s4, 3
    s_add_u32 s66, s5, s6
    v_min_u32 v2, 6, v1
    v_add_u32 v2, 2, v2
    v_mul_u32_u24 v3, 43, v2
    v_lshrrev_b32 v3, 7, v3
    v_mul_u32_u24 v4, 3, v3
    v_sub_u32 v2, v2, v4
    s_sub_u32 s4, s21, 2
    v_add_u32 v2, s4, v2
    v_max_i32 v2, 0, v2
    s_lshr_b32 s4, s20, 3
    v_lshl_add_u32 v3, v3, 1, s4
    v_lshl_add_u32 v2, v3, 4, v2
    v_lshlrev_b32 v2, 7, v2
    v_add_u32 v11, 0xe0000, v2
    buffer_load_dword v12, v11, s[72:75], 0 offen sc1
    s_lshr_b32 s23, s22, 2
    s_and_b32 s4, s22, 3
    s_lshl_b32 s24, s21, 2
    s_add_u32 s24, s24, s4
    s_add_u32 s26, s24, 1
    s_cmp_lt_u32 s24, 8
    s_cselect_b32 s26, s26, 99
    v_lshlrev_b32 v2, 4, v1
    v_lshlrev_b32 v3, 3, v1
    s_add_u32 s12, s58, 0xa00000
    s_addc_u32 s13, s59, 0
    s_mov_b32 s14, 0x280000
    s_mov_b32 s15, 0x00020000
    s_and_b32 s4, s22, 3
    s_mul_i32 s4, s4, 6656
    s_lshl_b32 s5, s23, 10
    s_add_u32 s5, s5, s4
    v_add_u32 v14, s5, v2
    s_add_u32 s5, s4, 2048
    v_add_u32 v15, s5, v3
    s_lshl_b32 s5, s23, 11
    s_add_u32 s5, s5, s4
    s_add_u32 s5, s5, 2560
    v_add_u32 v16, s5, v2
    v_lshrrev_b32 v4, 3, v0
    v_mul_u32_u24 v4, 6656, v4
    v_and_b32 v5, 7, v0
    v_lshl_add_u32 v4, v5, 9, v4
    v_add_u32 v4, 2880, v4
    v_mov_b32 v52, 0x3f803f80
    v_mov_b32 v53, 0x3f803f80
    v_mov_b32 v54, 0x3f803f80
    v_mov_b32 v55, 0x3f803f80
    v_cmp_gt_u32 vcc, 96, v0
    s_and_saveexec_b64 s[4:5], vcc
    s_cbranch_execz p2_noones
    ds_write_b128 v4, v[52:55]
p2_noones:
    s_mov_b64 exec, -1
    v_and_b32 v4, 31, v1
    v_lshrrev_b32 v5, 5, v1
    v_lshlrev_b32 v6, 2, v5
    v_sub_u32 v4, v4, v6
    v_mov_b32 v7, 0xf149f2ca
    v_cmp_le_i32 vcc, 0, v4
    s_nop 1
    v_cndmask_b32_e64 v60, v7, 0, vcc
    v_cmp_le_i32 vcc, 1, v4
    s_nop 1
    v_cndmask_b32_e64 v61, v7, 0, vcc
    v_cmp_le_i32 vcc, 2, v4
    s_nop 1
    v_cndmask_b32_e64 v62, v7, 0, vcc
    v_cmp_le_i32 vcc, 3, v4
    s_nop 1
    v_cndmask_b32_e64 v63, v7, 0, vcc
    v_cmp_le_i32 vcc, 8, v4
    s_nop 1
    v_cndmask_b32_e64 v64, v7, 0, vcc
    v_cmp_le_i32 vcc, 9, v4
    s_nop 1
    v_cndmask_b32_e64 v65, v7, 0, vcc
    v_cmp_le_i32 vcc, 10, v4
    s_nop 1
    v_cndmask_b32_e64 v66, v7, 0, vcc
    v_cmp_le_i32 vcc, 11, v4
    s_nop 1
    v_cndmask_b32_e64 v67, v7, 0, vcc
    v_cmp_le_i32 vcc, 16, v4
    s_nop 1
    v_cndmask_b32_e64 v68, v7, 0, vcc
    v_cmp_le_i32 vcc, 17, v4
    s_nop 1
    v_cndmask_b32_e64 v69, v7, 0, vcc
    v_cmp_le_i32 vcc, 18, v4
    s_nop 1
    v_cndmask_b32_e64 v70, v7, 0, vcc
    v_cmp_le_i32 vcc, 19, v4
    s_nop 1
    v_cndmask_b32_e64 v71, v7, 0, vcc
    v_cmp_le_i32 vcc, 24, v4
    s_nop 1
    v_cndmask_b32_e64 v72, v7, 0, vcc
    v_cmp_le_i32 vcc, 25, v4
    s_nop 1
    v_cndmask_b32_e64 v73, v7, 0, vcc
    v_cmp_le_i32 vcc, 26, v4
    s_nop 1
    v_cndmask_b32_e64 v74, v7, 0, vcc
    v_cmp_le_i32 vcc, 27, v4
    s_nop 1
    v_cndmask_b32_e64 v75, v7, 0, vcc
    s_cmp_eq_u32 s26, 1
    s_cselect_b32 s4, 0xf149f2ca, 0
    v_mov_b32 v17, s4
    v_mov_b32 v76, s4
    v_mov_b32 v77, s4
    v_mov_b32 v78, s4
    v_mov_b32 v79, s4
    v_mov_b32 v80, s4
    v_mov_b32 v81, s4
    v_mov_b32 v82, s4
    v_mov_b32 v83, s4
    v_mov_b32 v84, s4
    v_mov_b32 v85, s4
    v_mov_b32 v86, s4
    v_mov_b32 v87, s4
    v_mov_b32 v88, s4
    v_mov_b32 v89, s4
    v_mov_b32 v90, s4
    v_mov_b32 v91, s4
    s_waitcnt vmcnt(0)
    v_cmp_ne_u32 vcc, s29, v12
    s_nop 0
    s_cbranch_vccz poll_75_ok
    s_mov_b32 s25, 20000
poll_75:
    s_sleep 1
    buffer_load_dword v12, v11, s[72:75], 0 offen sc1
    s_waitcnt vmcnt(0)
    v_cmp_ne_u32 vcc, s29, v12
    s_nop 0
    s_cbranch_vccz poll_75_ok
    s_sub_u32 s25, s25, 1
    s_cmp_lg_u32 s25, 0
    s_cbranch_scc1 poll_75
poll_75_ok:
    s_lshl_b32 s4, s20, 6
    s_add_u32 s4, s4, s24
    s_mul_i32 s4, s4, 2560
    s_lshl_b32 s5, s23, 10
    s_add_u32 s5, s5, s4
    s_add_u32 s6, s4, 2048
    buffer_load_dwordx4 v[20:23], v2, s[12:15], s5 offen sc1
    buffer_load_dwordx2 v[18:19], v3, s[12:15], s6 offen sc1
    s_cmp_eq_u32 s22, 7
    s_cbranch_scc1 p2_w7
    s_cmp_ge_u32 s22, 3
    s_cbranch_scc1 p2_vdma
    s_mul_i32 s6, s20, 163840
    s_add_u32 s6, s6, 0xd00000
    s_add_u32 s8, s58, s6
    s_addc_u32 s9, s59, 0
    s_mov_b32 s10, 0x28000
    s_mov_b32 s11, 0x00020000
    s_mov_b32 s33, 2560
    s_lshl_b32 s6, s22, 10
    v_add_u32 v4, s6, v2
    s_mov_b32 s30, s6
    s_cmp_eq_u32 s22, 2
    s_cbranch_scc0 p2_dmago
    s_mov_b32 exec_hi, 0
    s_branch p2_dmago
p2_vdma:
    s_sub_u32 s6, s22, 3
    s_lshr_b32 s7, s6, 1
    s_lshl_b32 s31, s20, 1
    s_add_u32 s7, s7, s31
    s_mul_i32 s7, s7, 81920
    s_add_u32 s7, s7, 0x1000000
    s_add_u32 s8, s58, s7
    s_addc_u32 s9, s59, 0
    s_mov_b32 s10, 0x14000
    s_mov_b32 s11, 0x00020000
    s_mov_b32 s33, 1280
    s_lshl_b32 s30, s6, 10
    s_add_u32 s30, s30, 2560
    s_and_b32 s6, s6, 1
    s_mul_i32 s6, s6, 640
    v_lshrrev_b32 v4, 5, v1
    v_mul_u32_u24 v4, 320, v4
    v_and_b32 v5, 31, v1
    v_lshl_add_u32 v4, v5, 4, v4
    v_add_u32 v4, s6, v4
    s_mov_b32 exec_lo, 0x000fffff
    s_mov_b32 exec_hi, 0x000fffff
    s_barrier
p2_dmago:
    s_lshl_b32 s27, s21, 2
    s_add_u32 s27, s27, 3
    s_add_u32 s30, s30, 73216
    s_mov_b32 s25, 12
p2_dmaloop:
    s_max_i32 s4, s27, 0
    s_mul_i32 s28, s4, s33
    s_mov_b32 m0, s30
    s_sub_u32 s30, s30, 6656
    buffer_load_dwordx4 v4, s[8:11], s28 offen sc1 lds
    s_sub_u32 s27, s27, 1
    s_sub_u32 s25, s25, 1
    s_cmp_lg_u32 s25, 0
    s_cbranch_scc1 p2_dmaloop
    s_mov_b64 exec, -1
    s_cmp_ge_u32 s22, 3
    s_cbranch_scc1 p2_nodma
    s_barrier
    s_branch p2_nodma
p2_w7:
    s_barrier
    v_min_u32 v4, 24, v1
    s_lshr_b32 s4, s65, 1
    s_add_u32 s4, s4, 96
    v_lshl_add_u32 v5, v4, 4, s4
    v_add_u32 v6, 231, v4
    v_cmp_gt_u32 vcc, 9, v4
    s_nop 1
    v_cndmask_b32 v4, v6, v5, vcc
    v_lshlrev_b32 v4, 7, v4
    v_add_u32 v11, 0xe0000, v4
    buffer_load_dword v12, v11, s[72:75], 0 offen sc1
    s_waitcnt vmcnt(0)
    v_cmp_ne_u32 vcc, s29, v12
    s_nop 0
    s_cbranch_vccz poll_76_ok
    s_mov_b32 s25, 20000
poll_76:
    s_sleep 1
    buffer_load_dword v12, v11, s[72:75], 0 offen sc1
    s_waitcnt vmcnt(0)
    v_cmp_ne_u32 vcc, s29, v12
    s_nop 0
    s_cbranch_vccz poll_76_ok
    s_sub_u32 s25, s25, 1
    s_cmp_lg_u32 s25, 0
    s_cbranch_scc1 poll_76
poll_76_ok:
p2_nodma:
    s_lshr_b32 s70, s22, 1
    s_and_b32 s71, s22, 1
    s_lshl_b32 s4, s65, 2
    s_lshl_b32 s5, s71, 1
    s_add_u32 s4, s4, s5
    s_mul_i32 s4, s4, 75776
    s_add_u32 s8, s58, s4
    s_addc_u32 s9, s59, 0
    s_mov_b32 s10, 0x25000
    s_mov_b32 s11, 0x00020000
    s_mul_i32 s4, s66, 378880
    s_add_u32 s4, s4, 0x1300000
    s_add_u32 s12, s58, s4
    s_addc_u32 s13, s59, 0
    s_mov_b32 s14, 0x5f000
    s_mov_b32 s15, 0x00020000
    v_lshlrev_b32 v8, 4, v1
    s_and_b32 s4, s70, 1
    s_mul_i32 s5, s4, 75776
    s_sub_u32 s6, 75776, s5
    v_add_u32 v9, s5, v8
    v_add_u32 v10, s6, v8
    s_lshl_b32 s68, s70, 10
    s_mul_i32 s67, s22, 5120
    s_mul_i32 s69, s22, 5120
    v_lshrrev_b32 v5, 5, v1
    v_cmp_eq_u32 vcc, s23, v5
    s_nop 0
    s_sub_u32 s4, s22, 3
    s_cmp_lt_u32 s4, 4
    s_cbranch_scc1 p2_vl
    s_waitcnt vmcnt(0)
p2_vl:
    s_waitcnt vmcnt(12)
    s_waitcnt lgkmcnt(0)
    v_cndmask_b32 v18, 0, v18, vcc
    v_cndmask_b32 v19, 0, v19, vcc
    s_barrier
    ds_read_b128 v[24:27], v14 offset:53248
    ds_read_b64 v[32:33], v15 offset:53248
    ds_read_b128 v[28:31], v14 offset:46592
    ds_read_b64 v[34:35], v15 offset:46592
    s_waitcnt lgkmcnt(3)
    v_mfma_f32_32x32x16_bf16 v[92:107], v[24:27], v[20:23], v[60:75]
    s_waitcnt lgkmcnt(2)
    v_mfma_f32_32x32x8_bf16 v[92:107], v[32:33], v[18:19], v[92:107]
    s_waitcnt lgkmcnt(1)
    v_mfma_f32_32x32x16_bf16 v[108:123], v[28:31], v[20:23], v[76:91]
    s_waitcnt lgkmcnt(0)
    v_mfma_f32_32x32x8_bf16 v[108:123], v[34:35], v[18:19], v[108:123]
    ds_read_b128 v[24:27], v14 offset:39936
    ds_read_b64 v[32:33], v15 offset:39936
    s_add_u32 m0, s69, 81920
    s_add_u32 s4, s67, 0
    buffer_load_dwordx4 v8, s[12:15], s4 offen sc1 lds
    s_nop 2
    v_max3_f32 v13, v92, v93, v94
    v_max_f32 v13, v13, v95
    v_max3_f32 v13, v13, v96, v97
    v_max3_f32 v13, v13, v98, v99
    s_cmp_eq_u32 s26, 2
    s_cbranch_scc1 p2h_77
p2h_77_b:
    v_max3_f32 v13, v13, v100, v101
    v_max3_f32 v13, v13, v102, v103
    v_max3_f32 v13, v13, v104, v105
    v_max3_f32 v13, v13, v106, v107
    s_waitcnt lgkmcnt(1)
    v_mfma_f32_32x32x16_bf16 v[92:107], v[24:27], v[20:23], v[76:91]
    s_waitcnt lgkmcnt(0)
    v_mfma_f32_32x32x8_bf16 v[92:107], v[32:33], v[18:19], v[92:107]
    ds_read_b128 v[28:31], v14 offset:33280
    ds_read_b64 v[34:35], v15 offset:33280
    s_add_u32 m0, s69, 82944
    s_add_u32 s4, s67, 1024
    buffer_load_dwordx4 v8, s[12:15], s4 offen sc1 lds
    v_max3_f32 v13, v13, v108, v109
    v_max3_f32 v13, v13, v110, v111
    v_max3_f32 v13, v13, v112, v113
    v_max3_f32 v13, v13, v114, v115
    s_cmp_eq_u32 s26, 3
    s_cbranch_scc1 p2h_78
p2h_78_b:
    v_max3_f32 v13, v13, v116, v117
    v_max3_f32 v13, v13, v118, v119
    v_max3_f32 v13, v13, v120, v121
    v_max3_f32 v13, v13, v122, v123
    s_waitcnt lgkmcnt(1)
    v_mfma_f32_32x32x16_bf16 v[108:123], v[28:31], v[20:23], v[76:91]
    s_waitcnt lgkmcnt(0)
    v_mfma_f32_32x32x8_bf16 v[108:123], v[34:35], v[18:19], v[108:123]
    ds_read_b128 v[24:27], v14 offset:26624
    ds_read_b64 v[32:33], v15 offset:26624
    s_add_u32 m0, s69, 83968
    s_add_u32 s4, s67, 2048
    buffer_load_dwordx4 v8, s[12:15], s4 offen sc1 lds
    v_max3_f32 v13, v13, v92, v93
    v_max3_f32 v13, v13, v94, v95
    v_max3_f32 v13, v13, v96, v97
    v_max3_f32 v13, v13, v98, v99
    s_cmp_eq_u32 s26, 4
    s_cbranch_scc1 p2h_79
p2h_79_b:
    v_max3_f32 v13, v13, v100, v101
    v_max3_f32 v13, v13, v102, v103
    v_max3_f32 v13, v13, v104, v105
    v_max3_f32 v13, v13, v106, v107
    s_waitcnt lgkmcnt(1)
    v_mfma_f32_32x32x16_bf16 v[92:107], v[24:27], v[20:23], v[76:91]
    s_waitcnt lgkmcnt(0)
    v_mfma_f32_32x32x8_bf16 v[92:107], v[32:33], v[18:19], v[92:107]
    ds_read_b128 v[28:31], v14 offset:19968
    ds_read_b64 v[34:35], v15 offset:19968
    s_add_u32 m0, s69, 84992
    s_add_u32 s4, s67, 3072
    buffer_load_dwordx4 v8, s[12:15], s4 offen sc1 lds
    v_max3_f32 v13, v13, v108, v109
    v_max3_f32 v13, v13, v110, v111
    v_max3_f32 v13, v13, v112, v113
    v_max3_f32 v13, v13, v114, v115
    s_cmp_eq_u32 s26, 5
    s_cbranch_scc1 p2h_80
p2h_80_b:
    v_max3_f32 v13, v13, v116, v117
    v_max3_f32 v13, v13, v118, v119
    v_max3_f32 v13, v13, v120, v121
    v_max3_f32 v13, v13, v122, v123
    s_waitcnt lgkmcnt(1)
    v_mfma_f32_32x32x16_bf16 v[108:123], v[28:31], v[20:23], v[76:91]
    s_waitcnt lgkmcnt(0)
    v_mfma_f32_32x32x8_bf16 v[108:123], v[34:35], v[18:19], v[108:123]
    ds_read_b128 v[24:27], v14 offset:13312
    ds_read_b64 v[32:33], v15 offset:13312
    s_add_u32 m0, s69, 86016
    s_add_u32 s4, s67, 4096
    buffer_load_dwordx4 v8, s[12:15], s4 offen sc1 lds
    v_max3_f32 v13, v13, v92, v93
    v_max3_f32 v13, v13, v94, v95
    v_max3_f32 v13, v13, v96, v97
    v_max3_f32 v13, v13, v98, v99
    s_cmp_eq_u32 s26, 6
    s_cbranch_scc1 p2h_81
p2h_81_b:
    v_max3_f32 v13, v13, v100, v101
    v_max3_f32 v13, v13, v102, v103
    v_max3_f32 v13, v13, v104, v105
    v_max3_f32 v13, v13, v106, v107
    s_waitcnt lgkmcnt(1)
    v_mfma_f32_32x32x16_bf16 v[92:107], v[24:27], v[20:23], v[76:91]
    s_waitcnt lgkmcnt(0)
    v_mfma_f32_32x32x8_bf16 v[92:107], v[32:33], v[18:19], v[92:107]
    ds_read_b128 v[28:31], v14 offset:6656
    ds_read_b64 v[34:35], v15 offset:6656
    s_add_u32 s5, s68, 0
    buffer_load_dwordx4 v[144:147], v9, s[8:11], s5 offen sc1
    v_max3_f32 v13, v13, v108, v109
    v_max3_f32 v13, v13, v110, v111
    v_max3_f32 v13, v13, v112, v113
    v_max3_f32 v13, v13, v114, v115
    s_cmp_eq_u32 s26, 7
    s_cbranch_scc1 p2h_82
p2h_82_b:
    v_max3_f32 v13, v13, v116, v117
    v_max3_f32 v13, v13, v118, v119
    v_max3_f32 v13, v13, v120, v121
    v_max3_f32 v13, v13, v122, v123
    s_waitcnt lgkmcnt(1)
    v_mfma_f32_32x32x16_bf16 v[108:123], v[28:31], v[20:23], v[76:91]
    s_waitcnt lgkmcnt(0)
    v_mfma_f32_32x32x8_bf16 v[108:123], v[34:35], v[18:19], v[108:123]
    ds_read_b128 v[24:27], v14 offset:0
    ds_read_b64 v[32:33], v15 offset:0
    s_add_u32 s5, s68, 0
    buffer_load_dwordx4 v[148:151], v10, s[8:11], s5 offen sc1
    v_max3_f32 v13, v13, v92, v93
    v_max3_f32 v13, v13, v94, v95
    v_max3_f32 v13, v13, v96, v97
    v_max3_f32 v13, v13, v98, v99
    s_cmp_eq_u32 s26, 8
    s_cbranch_scc1 p2h_83
p2h_83_b:
    v_add_f32 v4, 0xf149f2ca, v17
    v_pk_add_f32 v[76:77], v[4:5], v[60:61] op_sel:[0,0] op_sel_hi:[0,1] neg_lo:[0,1] neg_hi:[0,1]
    v_pk_add_f32 v[78:79], v[4:5], v[62:63] op_sel:[0,0] op_sel_hi:[0,1] neg_lo:[0,1] neg_hi:[0,1]
    v_pk_add_f32 v[80:81], v[4:5], v[64:65] op_sel:[0,0] op_sel_hi:[0,1] neg_lo:[0,1] neg_hi:[0,1]
    v_pk_add_f32 v[82:83], v[4:5], v[66:67] op_sel:[0,0] op_sel_hi:[0,1] neg_lo:[0,1] neg_hi:[0,1]
    v_pk_add_f32 v[84:85], v[4:5], v[68:69] op_sel:[0,0] op_sel_hi:[0,1] neg_lo:[0,1] neg_hi:[0,1]
    v_pk_add_f32 v[86:87], v[4:5], v[70:71] op_sel:[0,0] op_sel_hi:[0,1] neg_lo:[0,1] neg_hi:[0,1]
    v_pk_add_f32 v[88:89], v[4:5], v[72:73] op_sel:[0,0] op_sel_hi:[0,1] neg_lo:[0,1] neg_hi:[0,1]
    v_pk_add_f32 v[90:91], v[4:5], v[74:75] op_sel:[0,0] op_sel_hi:[0,1] neg_lo:[0,1] neg_hi:[0,1]
    v_max3_f32 v13, v13, v100, v101
    v_max3_f32 v13, v13, v102, v103
    v_max3_f32 v13, v13, v104, v105
    v_max3_f32 v13, v13, v106, v107
    s_waitcnt vmcnt(7)
    s_barrier
    s_waitcnt lgkmcnt(1)
    v_mfma_f32_32x32x16_bf16 v[92:107], v[24:27], v[20:23], v[76:91]
    s_waitcnt lgkmcnt(0)
    v_mfma_f32_32x32x8_bf16 v[92:107], v[32:33], v[18:19], v[92:107]
    ds_read_b128 v[28:31], v14 offset:53248
    ds_read_b64 v[34:35], v15 offset:53248
    s_add_u32 s5, s68, 4096
    buffer_load_dwordx4 v[152:155], v9, s[8:11], s5 offen sc1
    v_max3_f32 v13, v13, v108, v109
    v_max3_f32 v13, v13, v110, v111
    v_max3_f32 v13, v13, v112, v113
    v_max3_f32 v13, v13, v114, v115
    v_max3_f32 v13, v13, v116, v117
    v_max3_f32 v13, v13, v118, v119
    v_max3_f32 v13, v13, v120, v121
    v_max3_f32 v13, v13, v122, v123
    ds_read_b128 v[24:27], v14 offset:46592
    ds_read_b64 v[32:33], v15 offset:46592
    s_add_u32 s5, s68, 4096
    buffer_load_dwordx4 v[156:159], v10, s[8:11], s5 offen sc1
    v_max3_f32 v13, v13, v92, v93
    v_max3_f32 v13, v13, v94, v95
    v_max3_f32 v13, v13, v96, v97
    v_max3_f32 v13, v13, v98, v99
    v_max3_f32 v13, v13, v100, v101
    v_max3_f32 v13, v13, v102, v103
    v_max3_f32 v13, v13, v104, v105
    v_max3_f32 v13, v13, v106, v107
    v_mov_b32 v4, v13
    s_nop 1
    v_permlane32_swap_b32 v4, v13
    v_max_f32 v13, v13, v4
    ds_read_b128 v[36:39], v16 offset:53248
    ds_read_b128 v[40:43], v16 offset:54272
    v_pk_add_f32 v[76:77], v[60:61], v[12:13] op_sel:[0,1] op_sel_hi:[1,1] neg_lo:[0,1] neg_hi:[0,1]
    v_pk_add_f32 v[78:79], v[62:63], v[12:13] op_sel:[0,1] op_sel_hi:[1,1] neg_lo:[0,1] neg_hi:[0,1]
    v_pk_add_f32 v[80:81], v[64:65], v[12:13] op_sel:[0,1] op_sel_hi:[1,1] neg_lo:[0,1] neg_hi:[0,1]
    v_pk_add_f32 v[82:83], v[66:67], v[12:13] op_sel:[0,1] op_sel_hi:[1,1] neg_lo:[0,1] neg_hi:[0,1]
    v_pk_add_f32 v[84:85], v[68:69], v[12:13] op_sel:[0,1] op_sel_hi:[1,1] neg_lo:[0,1] neg_hi:[0,1]
    v_pk_add_f32 v[86:87], v[70:71], v[12:13] op_sel:[0,1] op_sel_hi:[1,1] neg_lo:[0,1] neg_hi:[0,1]
    v_pk_add_f32 v[88:89], v[72:73], v[12:13] op_sel:[0,1] op_sel_hi:[1,1] neg_lo:[0,1] neg_hi:[0,1]
    v_pk_add_f32 v[90:91], v[74:75], v[12:13] op_sel:[0,1] op_sel_hi:[1,1] neg_lo:[0,1] neg_hi:[0,1]
    s_waitcnt lgkmcnt(5)
    s_nop 0
    v_mfma_f32_32x32x16_bf16 v[108:123], v[28:31], v[20:23], v[76:91]
    s_waitcnt lgkmcnt(4)
    v_mfma_f32_32x32x8_bf16 v[108:123], v[34:35], v[18:19], v[108:123]
    v_sub_f32 v17, 0, v13
    v_mov_b32 v4, 0xf149f2ca
    v_mov_b32 v5, 0
    v_pk_add_f32 v[60:61], v[4:5], v[60:61] op_sel:[0,0] op_sel_hi:[0,1] neg_lo:[0,1] neg_hi:[0,1]
    v_pk_add_f32 v[62:63], v[4:5], v[62:63] op_sel:[0,0] op_sel_hi:[0,1] neg_lo:[0,1] neg_hi:[0,1]
    v_pk_add_f32 v[64:65], v[4:5], v[64:65] op_sel:[0,0] op_sel_hi:[0,1] neg_lo:[0,1] neg_hi:[0,1]
    v_pk_add_f32 v[66:67], v[4:5], v[66:67] op_sel:[0,0] op_sel_hi:[0,1] neg_lo:[0,1] neg_hi:[0,1]
    v_pk_add_f32 v[68:69], v[4:5], v[68:69] op_sel:[0,0] op_sel_hi:[0,1] neg_lo:[0,1] neg_hi:[0,1]
    v_pk_add_f32 v[70:71], v[4:5], v[70:71] op_sel:[0,0] op_sel_hi:[0,1] neg_lo:[0,1] neg_hi:[0,1]
    v_pk_add_f32 v[72:73], v[4:5], v[72:73] op_sel:[0,0] op_sel_hi:[0,1] neg_lo:[0,1] neg_hi:[0,1]
    v_pk_add_f32 v[74:75], v[4:5], v[74:75] op_sel:[0,0] op_sel_hi:[0,1] neg_lo:[0,1] neg_hi:[0,1]
    v_pk_add_f32 v[76:77], v[16:17], v[4:5] op_sel:[1,1] op_sel_hi:[1,1]
    v_pk_add_f32 v[78:79], v[16:17], v[4:5] op_sel:[1,1] op_sel_hi:[1,1]
    v_pk_add_f32 v[80:81], v[16:17], v[4:5] op_sel:[1,1] op_sel_hi:[1,1]
    v_pk_add_f32 v[82:83], v[16:17], v[4:5] op_sel:[1,1] op_sel_hi:[1,1]
    v_pk_add_f32 v[84:85], v[16:17], v[4:5] op_sel:[1,1] op_sel_hi:[1,1]
    v_pk_add_f32 v[86:87], v[16:17], v[4:5] op_sel:[1,1] op_sel_hi:[1,1]
    v_pk_add_f32 v[88:89], v[16:17], v[4:5] op_sel:[1,1] op_sel_hi:[1,1]
    v_pk_add_f32 v[90:91], v[16:17], v[4:5] op_sel:[1,1] op_sel_hi:[1,1]
    s_cmp_eq_u32 s26, 1
    s_cbranch_scc1 p2h_84
p2h_84_b:
    s_waitcnt lgkmcnt(3)
    v_mfma_f32_32x32x16_bf16 v[92:107], v[24:27], v[20:23], v[76:91]
    v_exp_f32 v108, v108
    v_exp_f32 v109, v109
    v_exp_f32 v110, v110
    v_exp_f32 v111, v111
    s_waitcnt lgkmcnt(2)
    v_mfma_f32_32x32x8_bf16 v[92:107], v[32:33], v[18:19], v[92:107]
    ds_read_b128 v[28:31], v14 offset:39936
    ds_read_b64 v[34:35], v15 offset:39936
    ds_read_b128 v[44:47], v16 offset:46592
    ds_read_b128 v[48:51], v16 offset:47616
    v_exp_f32 v112, v112
    v_exp_f32 v113, v113
    v_exp_f32 v114, v114
    v_exp_f32 v115, v115
    v_cvt_pk_bf16_f32 v52, v108, v109
    v_cvt_pk_bf16_f32 v53, v110, v111
    v_cvt_pk_bf16_f32 v54, v112, v113
    v_cvt_pk_bf16_f32 v55, v114, v115
    v_exp_f32 v116, v116
    v_exp_f32 v117, v117
    s_waitcnt lgkmcnt(5)
    v_mfma_f32_32x32x16_bf16 v[124:139], v[36:39], v[52:55], 0
    v_exp_f32 v118, v118
    v_exp_f32 v119, v119
    v_exp_f32 v120, v120
    v_exp_f32 v121, v121
    v_exp_f32 v122, v122
    v_exp_f32 v123, v123
    s_cmp_eq_u32 s26, 2
    s_cbranch_scc1 p2h_85
p2h_85_b:
    v_cvt_pk_bf16_f32 v56, v116, v117
    v_cvt_pk_bf16_f32 v57, v118, v119
    v_cvt_pk_bf16_f32 v58, v120, v121
    v_cvt_pk_bf16_f32 v59, v122, v123
    s_add_u32 m0, s69, 122880
    s_add_u32 s4, s67, 40960
    buffer_load_dwordx4 v8, s[12:15], s4 offen sc1 lds
    s_add_u32 m0, s69, 123904
    s_add_u32 s4, s67, 41984
    buffer_load_dwordx4 v8, s[12:15], s4 offen sc1 lds
    s_add_u32 m0, s69, 124928
    s_add_u32 s4, s67, 43008
    buffer_load_dwordx4 v8, s[12:15], s4 offen sc1 lds
    s_waitcnt lgkmcnt(4)
    v_mfma_f32_32x32x16_bf16 v[124:139], v[40:43], v[56:59], v[124:139]
    s_waitcnt lgkmcnt(3)
    v_mfma_f32_32x32x16_bf16 v[108:123], v[28:31], v[20:23], v[76:91]
    v_exp_f32 v92, v92
    v_exp_f32 v93, v93
    v_exp_f32 v94, v94
    v_exp_f32 v95, v95
    s_waitcnt lgkmcnt(2)
    v_mfma_f32_32x32x8_bf16 v[108:123], v[34:35], v[18:19], v[108:123]
    ds_read_b128 v[24:27], v14 offset:33280
    ds_read_b64 v[32:33], v15 offset:33280
    ds_read_b128 v[36:39], v16 offset:39936
    ds_read_b128 v[40:43], v16 offset:40960
    v_exp_f32 v96, v96
    v_exp_f32 v97, v97
    v_exp_f32 v98, v98
    v_exp_f32 v99, v99
    v_cvt_pk_bf16_f32 v52, v92, v93
    v_cvt_pk_bf16_f32 v53, v94, v95
    v_cvt_pk_bf16_f32 v54, v96, v97
    v_cvt_pk_bf16_f32 v55, v98, v99
    v_exp_f32 v100, v100
    v_exp_f32 v101, v101
    s_waitcnt lgkmcnt(5)
    v_mfma_f32_32x32x16_bf16 v[124:139], v[44:47], v[52:55], v[124:139]
    v_exp_f32 v102, v102
    v_exp_f32 v103, v103
    v_exp_f32 v104, v104
    v_exp_f32 v105, v105
    v_exp_f32 v106, v106
    v_exp_f32 v107, v107
    s_cmp_eq_u32 s26, 3
    s_cbranch_scc1 p2h_86
p2h_86_b:
    v_cvt_pk_bf16_f32 v56, v100, v101
    v_cvt_pk_bf16_f32 v57, v102, v103
    v_cvt_pk_bf16_f32 v58, v104, v105
    v_cvt_pk_bf16_f32 v59, v106, v107
    s_add_u32 m0, s69, 125952
    s_add_u32 s4, s67, 44032
    buffer_load_dwordx4 v8, s[12:15], s4 offen sc1 lds
    s_add_u32 m0, s69, 126976
    s_add_u32 s4, s67, 45056
    buffer_load_dwordx4 v8, s[12:15], s4 offen sc1 lds
    s_add_u32 s5, s68, 8192
    buffer_load_dwordx4 v[160:163], v9, s[8:11], s5 offen sc1
    s_waitcnt lgkmcnt(4)
    v_mfma_f32_32x32x16_bf16 v[124:139], v[48:51], v[56:59], v[124:139]
    s_waitcnt lgkmcnt(3)
    v_mfma_f32_32x32x16_bf16 v[92:107], v[24:27], v[20:23], v[76:91]
    v_exp_f32 v108, v108
    v_exp_f32 v109, v109
    v_exp_f32 v110, v110
    v_exp_f32 v111, v111
    s_waitcnt lgkmcnt(2)
    v_mfma_f32_32x32x8_bf16 v[92:107], v[32:33], v[18:19], v[92:107]
    ds_read_b128 v[28:31], v14 offset:26624
    ds_read_b64 v[34:35], v15 offset:26624
    ds_read_b128 v[44:47], v16 offset:33280
    ds_read_b128 v[48:51], v16 offset:34304
    v_exp_f32 v112, v112
    v_exp_f32 v113, v113
    v_exp_f32 v114, v114
    v_exp_f32 v115, v115
    v_cvt_pk_bf16_f32 v52, v108, v109
    v_cvt_pk_bf16_f32 v53, v110, v111
    v_cvt_pk_bf16_f32 v54, v112, v113
    v_cvt_pk_bf16_f32 v55, v114, v115
    v_exp_f32 v116, v116
    v_exp_f32 v117, v117
    s_waitcnt lgkmcnt(5)
    v_mfma_f32_32x32x16_bf16 v[124:139], v[36:39], v[52:55], v[124:139]
    v_exp_f32 v118, v118
    v_exp_f32 v119, v119
    v_exp_f32 v120, v120
    v_exp_f32 v121, v121
    v_exp_f32 v122, v122
    v_exp_f32 v123, v123
    s_cmp_eq_u32 s26, 4
    s_cbranch_scc1 p2h_87
p2h_87_b:
    v_cvt_pk_bf16_f32 v56, v116, v117
    v_cvt_pk_bf16_f32 v57, v118, v119
    v_cvt_pk_bf16_f32 v58, v120, v121
    v_cvt_pk_bf16_f32 v59, v122, v123
    s_add_u32 s5, s68, 8192
    buffer_load_dwordx4 v[164:167], v10, s[8:11], s5 offen sc1
    s_add_u32 s5, s68, 12288
    buffer_load_dwordx4 v[168:171], v9, s[8:11], s5 offen sc1
    s_add_u32 s5, s68, 12288
    buffer_load_dwordx4 v[172:175], v10, s[8:11], s5 offen sc1
    s_waitcnt lgkmcnt(4)
    v_mfma_f32_32x32x16_bf16 v[124:139], v[40:43], v[56:59], v[124:139]
    s_waitcnt lgkmcnt(3)
    v_mfma_f32_32x32x16_bf16 v[108:123], v[28:31], v[20:23], v[76:91]
    v_exp_f32 v92, v92
    v_exp_f32 v93, v93
    v_exp_f32 v94, v94
    v_exp_f32 v95, v95
    s_waitcnt lgkmcnt(2)
    v_mfma_f32_32x32x8_bf16 v[108:123], v[34:35], v[18:19], v[108:123]
    ds_read_b128 v[24:27], v14 offset:19968
    ds_read_b64 v[32:33], v15 offset:19968
    ds_read_b128 v[36:39], v16 offset:26624
    ds_read_b128 v[40:43], v16 offset:27648
    v_exp_f32 v96, v96
    v_exp_f32 v97, v97
    v_exp_f32 v98, v98
    v_exp_f32 v99, v99
    v_cvt_pk_bf16_f32 v52, v92, v93
    v_cvt_pk_bf16_f32 v53, v94, v95
    v_cvt_pk_bf16_f32 v54, v96, v97
    v_cvt_pk_bf16_f32 v55, v98, v99
    v_exp_f32 v100, v100
    v_exp_f32 v101, v101
    s_waitcnt lgkmcnt(5)
    v_mfma_f32_32x32x16_bf16 v[124:139], v[44:47], v[52:55], v[124:139]
    v_exp_f32 v102, v102
    v_exp_f32 v103, v103
    v_exp_f32 v104, v104
    v_exp_f32 v105, v105
    v_exp_f32 v106, v106
    v_exp_f32 v107, v107
    s_cmp_eq_u32 s26, 5
    s_cbranch_scc1 p2h_88
p2h_88_b:
    v_cvt_pk_bf16_f32 v56, v100, v101
    v_cvt_pk_bf16_f32 v57, v102, v103
    v_cvt_pk_bf16_f32 v58, v104, v105
    v_cvt_pk_bf16_f32 v59, v106, v107
    s_add_u32 s5, s68, 16384
    buffer_load_dwordx4 v[176:179], v9, s[8:11], s5 offen sc1
    s_add_u32 s5, s68, 16384
    buffer_load_dwordx4 v[180:183], v10, s[8:11], s5 offen sc1
    s_add_u32 s5, s68, 20480
    buffer_load_dwordx4 v[184:187], v9, s[8:11], s5 offen sc1
    s_waitcnt lgkmcnt(4)
    v_mfma_f32_32x32x16_bf16 v[124:139], v[48:51], v[56:59], v[124:139]
    s_waitcnt lgkmcnt(3)
    v_mfma_f32_32x32x16_bf16 v[92:107], v[24:27], v[20:23], v[76:91]
    v_exp_f32 v108, v108
    v_exp_f32 v109, v109
    v_exp_f32 v110, v110
    v_exp_f32 v111, v111
    s_waitcnt lgkmcnt(2)
    v_mfma_f32_32x32x8_bf16 v[92:107], v[32:33], v[18:19], v[92:107]
    ds_read_b128 v[28:31], v14 offset:13312
    ds_read_b64 v[34:35], v15 offset:13312
    ds_read_b128 v[44:47], v16 offset:19968
    ds_read_b128 v[48:51], v16 offset:20992
    v_exp_f32 v112, v112
    v_exp_f32 v113, v113
    v_exp_f32 v114, v114
    v_exp_f32 v115, v115
    v_cvt_pk_bf16_f32 v52, v108, v109
    v_cvt_pk_bf16_f32 v53, v110, v111
    v_cvt_pk_bf16_f32 v54, v112, v113
    v_cvt_pk_bf16_f32 v55, v114, v115
    v_exp_f32 v116, v116
    v_exp_f32 v117, v117
    s_waitcnt lgkmcnt(5)
    v_mfma_f32_32x32x16_bf16 v[124:139], v[36:39], v[52:55], v[124:139]
    v_exp_f32 v118, v118
    v_exp_f32 v119, v119
    v_exp_f32 v120, v120
    v_exp_f32 v121, v121
    v_exp_f32 v122, v122
    v_exp_f32 v123, v123
    s_cmp_eq_u32 s26, 6
    s_cbranch_scc1 p2h_89
p2h_89_b:
    v_cvt_pk_bf16_f32 v56, v116, v117
    v_cvt_pk_bf16_f32 v57, v118, v119
    v_cvt_pk_bf16_f32 v58, v120, v121
    v_cvt_pk_bf16_f32 v59, v122, v123
    s_add_u32 s5, s68, 20480
    buffer_load_dwordx4 v[188:191], v10, s[8:11], s5 offen sc1
    s_add_u32 s5, s68, 24576
    buffer_load_dwordx4 v[192:195], v9, s[8:11], s5 offen sc1
    s_add_u32 s5, s68, 24576
    buffer_load_dwordx4 v[196:199], v10, s[8:11], s5 offen sc1
    s_waitcnt lgkmcnt(4)
    v_mfma_f32_32x32x16_bf16 v[124:139], v[40:43], v[56:59], v[124:139]
    s_waitcnt lgkmcnt(3)
    v_mfma_f32_32x32x16_bf16 v[108:123], v[28:31], v[20:23], v[76:91]
    v_exp_f32 v92, v92
    v_exp_f32 v93, v93
    v_exp_f32 v94, v94
    v_exp_f32 v95, v95
    s_waitcnt lgkmcnt(2)
    v_mfma_f32_32x32x8_bf16 v[108:123], v[34:35], v[18:19], v[108:123]
    ds_read_b128 v[24:27], v14 offset:6656
    ds_read_b64 v[32:33], v15 offset:6656
    ds_read_b128 v[36:39], v16 offset:13312
    ds_read_b128 v[40:43], v16 offset:14336
    v_exp_f32 v96, v96
    v_exp_f32 v97, v97
    v_exp_f32 v98, v98
    v_exp_f32 v99, v99
    v_cvt_pk_bf16_f32 v52, v92, v93
    v_cvt_pk_bf16_f32 v53, v94, v95
    v_cvt_pk_bf16_f32 v54, v96, v97
    v_cvt_pk_bf16_f32 v55, v98, v99
    v_exp_f32 v100, v100
    v_exp_f32 v101, v101
    s_waitcnt lgkmcnt(5)
    v_mfma_f32_32x32x16_bf16 v[124:139], v[44:47], v[52:55], v[124:139]
    v_exp_f32 v102, v102
    v_exp_f32 v103, v103
    v_exp_f32 v104, v104
    v_exp_f32 v105, v105
    v_exp_f32 v106, v106
    v_exp_f32 v107, v107
    s_cmp_eq_u32 s26, 7
    s_cbranch_scc1 p2h_90
p2h_90_b:
    v_cvt_pk_bf16_f32 v56, v100, v101
    v_cvt_pk_bf16_f32 v57, v102, v103
    v_cvt_pk_bf16_f32 v58, v104, v105
    v_cvt_pk_bf16_f32 v59, v106, v107
    s_add_u32 s5, s68, 28672
    buffer_load_dwordx4 v[200:203], v9, s[8:11], s5 offen sc1
    s_add_u32 s5, s68, 28672
    buffer_load_dwordx4 v[204:207], v10, s[8:11], s5 offen sc1
    s_add_u32 s5, s68, 32768
    buffer_load_dwordx4 v[208:211], v9, s[8:11], s5 offen sc1
    s_waitcnt lgkmcnt(4)
    v_mfma_f32_32x32x16_bf16 v[124:139], v[48:51], v[56:59], v[124:139]
    s_waitcnt lgkmcnt(3)
    v_mfma_f32_32x32x16_bf16 v[92:107], v[24:27], v[20:23], v[76:91]
    v_exp_f32 v108, v108
    v_exp_f32 v109, v109
    v_exp_f32 v110, v110
    v_exp_f32 v111, v111
    s_waitcnt lgkmcnt(2)
    v_mfma_f32_32x32x8_bf16 v[92:107], v[32:33], v[18:19], v[92:107]
    ds_read_b128 v[28:31], v14 offset:0
    ds_read_b64 v[34:35], v15 offset:0
    ds_read_b128 v[44:47], v16 offset:6656
    ds_read_b128 v[48:51], v16 offset:7680
    v_exp_f32 v112, v112
    v_exp_f32 v113, v113
    v_exp_f32 v114, v114
    v_exp_f32 v115, v115
    v_cvt_pk_bf16_f32 v52, v108, v109
    v_cvt_pk_bf16_f32 v53, v110, v111
    v_cvt_pk_bf16_f32 v54, v112, v113
    v_cvt_pk_bf16_f32 v55, v114, v115
    v_exp_f32 v116, v116
    v_exp_f32 v117, v117
    s_waitcnt lgkmcnt(5)
    v_mfma_f32_32x32x16_bf16 v[124:139], v[36:39], v[52:55], v[124:139]
    v_exp_f32 v118, v118
    v_exp_f32 v119, v119
    v_exp_f32 v120, v120
    v_exp_f32 v121, v121
    v_exp_f32 v122, v122
    v_exp_f32 v123, v123
    s_cmp_eq_u32 s26, 8
    s_cbranch_scc1 p2h_91
p2h_91_b:
    v_pk_add_f32 v[76:77], v[16:17], v[60:61] op_sel:[1,0] op_sel_hi:[1,1]
    v_pk_add_f32 v[78:79], v[16:17], v[62:63] op_sel:[1,0] op_sel_hi:[1,1]
    v_pk_add_f32 v[80:81], v[16:17], v[64:65] op_sel:[1,0] op_sel_hi:[1,1]
    v_pk_add_f32 v[82:83], v[16:17], v[66:67] op_sel:[1,0] op_sel_hi:[1,1]
    v_pk_add_f32 v[84:85], v[16:17], v[68:69] op_sel:[1,0] op_sel_hi:[1,1]
    v_pk_add_f32 v[86:87], v[16:17], v[70:71] op_sel:[1,0] op_sel_hi:[1,1]
    v_pk_add_f32 v[88:89], v[16:17], v[72:73] op_sel:[1,0] op_sel_hi:[1,1]
    v_pk_add_f32 v[90:91], v[16:17], v[74:75] op_sel:[1,0] op_sel_hi:[1,1]
    v_cvt_pk_bf16_f32 v56, v116, v117
    v_cvt_pk_bf16_f32 v57, v118, v119
    v_cvt_pk_bf16_f32 v58, v120, v121
    v_cvt_pk_bf16_f32 v59, v122, v123
    s_add_u32 s5, s68, 32768
    buffer_load_dwordx4 v[212:215], v10, s[8:11], s5 offen sc1
    s_add_u32 s5, s68, 36864
    buffer_load_dwordx4 v[216:219], v9, s[8:11], s5 offen sc1
    s_add_u32 s5, s68, 36864
    buffer_load_dwordx4 v[220:223], v10, s[8:11], s5 offen sc1
    s_waitcnt lgkmcnt(4)
    v_mfma_f32_32x32x16_bf16 v[124:139], v[40:43], v[56:59], v[124:139]
    s_waitcnt lgkmcnt(3)
    v_mfma_f32_32x32x16_bf16 v[108:123], v[28:31], v[20:23], v[76:91]
    v_exp_f32 v92, v92
    v_exp_f32 v93, v93
    v_exp_f32 v94, v94
    v_exp_f32 v95, v95
    s_waitcnt lgkmcnt(2)
    v_mfma_f32_32x32x8_bf16 v[108:123], v[34:35], v[18:19], v[108:123]
    ds_read_b128 v[36:39], v16 offset:0
    ds_read_b128 v[40:43], v16 offset:1024
    v_exp_f32 v96, v96
    v_exp_f32 v97, v97
    v_exp_f32 v98, v98
    v_exp_f32 v99, v99
    v_cvt_pk_bf16_f32 v52, v92, v93
    v_cvt_pk_bf16_f32 v53, v94, v95
    v_cvt_pk_bf16_f32 v54, v96, v97
    v_cvt_pk_bf16_f32 v55, v98, v99
    v_exp_f32 v100, v100
    v_exp_f32 v101, v101
    s_waitcnt lgkmcnt(3)
    v_mfma_f32_32x32x16_bf16 v[124:139], v[44:47], v[52:55], v[124:139]
    v_exp_f32 v102, v102
    v_exp_f32 v103, v103
    v_exp_f32 v104, v104
    v_exp_f32 v105, v105
    v_exp_f32 v106, v106
    v_exp_f32 v107, v107
    v_cvt_pk_bf16_f32 v56, v100, v101
    v_cvt_pk_bf16_f32 v57, v102, v103
    v_cvt_pk_bf16_f32 v58, v104, v105
    v_cvt_pk_bf16_f32 v59, v106, v107
    s_add_u32 s5, s68, 40960
    buffer_load_dwordx4 v[224:227], v9, s[8:11], s5 offen sc1
    s_add_u32 s5, s68, 40960
    buffer_load_dwordx4 v[228:231], v10, s[8:11], s5 offen sc1
    s_add_u32 s5, s68, 45056
    buffer_load_dwordx4 v[232:235], v9, s[8:11], s5 offen sc1
    s_waitcnt lgkmcnt(2)
    v_mfma_f32_32x32x16_bf16 v[124:139], v[48:51], v[56:59], v[124:139]
    v_exp_f32 v108, v108
    v_exp_f32 v109, v109
    v_exp_f32 v110, v110
    v_exp_f32 v111, v111
    v_exp_f32 v112, v112
    v_exp_f32 v113, v113
    v_exp_f32 v114, v114
    v_exp_f32 v115, v115
    v_cvt_pk_bf16_f32 v52, v108, v109
    v_cvt_pk_bf16_f32 v53, v110, v111
    v_cvt_pk_bf16_f32 v54, v112, v113
    v_cvt_pk_bf16_f32 v55, v114, v115
    v_exp_f32 v116, v116
    v_exp_f32 v117, v117
    s_waitcnt lgkmcnt(1)
    v_mfma_f32_32x32x16_bf16 v[124:139], v[36:39], v[52:55], v[124:139]
    v_exp_f32 v118, v118
    v_exp_f32 v119, v119
    v_exp_f32 v120, v120
    v_exp_f32 v121, v121
    v_exp_f32 v122, v122
    v_exp_f32 v123, v123
    v_cvt_pk_bf16_f32 v56, v116, v117
    v_cvt_pk_bf16_f32 v57, v118, v119
    v_cvt_pk_bf16_f32 v58, v120, v121
    v_cvt_pk_bf16_f32 v59, v122, v123
    s_add_u32 s5, s68, 45056
    buffer_load_dwordx4 v[236:239], v10, s[8:11], s5 offen sc1
    s_add_u32 s5, s68, 49152
    buffer_load_dwordx4 v[240:243], v9, s[8:11], s5 offen sc1
    s_add_u32 s5, s68, 49152
    buffer_load_dwordx4 v[244:247], v10, s[8:11], s5 offen sc1
    s_waitcnt lgkmcnt(0)
    v_mfma_f32_32x32x16_bf16 v[124:139], v[40:43], v[56:59], v[124:139]
    s_cmp_ge_u32 s22, 4
    s_cbranch_scc1 p2_noh13
    s_add_u32 s5, s68, 53248
    buffer_load_dwordx4 v[248:251], v9, s[8:11], s5 offen sc1
    buffer_load_dwordx4 v[252:255], v10, s[8:11], s5 offen sc1
p2_noh13:
p3_entry:
    s_cmp_ge_u32 s22, 4
    s_cbranch_scc1 p3_clsB
    v_mov_b32 v4, v132
    v_mov_b32 v5, v132
    s_nop 1
    v_permlane32_swap_b32 v4, v5
    v_rcp_f32 v5, v5
    s_nop 0
    v_pk_mul_f32 v[124:125], v[4:5], v[124:125] op_sel:[1,0] op_sel_hi:[1,1]
    v_pk_mul_f32 v[126:127], v[4:5], v[126:127] op_sel:[1,0] op_sel_hi:[1,1]
    v_pk_mul_f32 v[128:129], v[4:5], v[128:129] op_sel:[1,0] op_sel_hi:[1,1]
    v_pk_mul_f32 v[130:131], v[4:5], v[130:131] op_sel:[1,0] op_sel_hi:[1,1]
    v_pk_mul_f32 v[132:133], v[4:5], v[132:133] op_sel:[1,0] op_sel_hi:[1,1]
    v_pk_mul_f32 v[134:135], v[4:5], v[134:135] op_sel:[1,0] op_sel_hi:[1,1]
    v_cvt_pk_bf16_f32 v52, v124, v125
    v_cvt_pk_bf16_f32 v53, v126, v127
    v_cvt_pk_bf16_f32 v54, v128, v129
    v_cvt_pk_bf16_f32 v55, v130, v131
    v_cvt_pk_bf16_f32 v56, v132, v133
    v_cvt_pk_bf16_f32 v57, v134, v135
    s_add_u32 s16, s58, 0x0
    s_addc_u32 s17, s59, 0
    s_mov_b32 s18, 0x940000
    s_mov_b32 s19, 0x00020000
    s_lshl_b32 s4, s24, 1
    s_mul_i32 s4, s4, 75776
    v_bfe_u32 v4, v1, 4, 1
    v_mul_u32_u24 v4, 75776, v4
    v_and_b32 v5, 15, v1
    v_lshl_add_u32 v4, v5, 4, v4
    v_add_u32 v4, s4, v4
    v_lshrrev_b32 v5, 5, v1
    v_lshl_add_u32 v5, v5, 8, v4
    s_add_u32 s5, s20, 54
    s_lshl_b32 s5, s5, 10
    s_lshl_b32 s6, s23, 9
    s_add_u32 s5, s5, s6
    buffer_store_dwordx4 v[52:55], v5, s[16:19], s5 offen sc1
    s_lshr_b32 s5, s20, 2
    s_add_u32 s5, s5, 70
    s_lshl_b32 s5, s5, 10
    s_and_b32 s6, s20, 3
    s_lshl_b32 s6, s6, 8
    s_add_u32 s5, s5, s6
    s_lshl_b32 s6, s23, 3
    s_add_u32 s5, s5, s6
    s_mov_b32 exec_hi, 0
    buffer_store_dwordx2 v[56:57], v4, s[16:19], s5 offen sc1
    s_mov_b32 exec_hi, -1
    s_mul_i32 s4, s70, 5120
    v_add_u32 v13, s4, v8
    v_add_u32 v14, 40960, v13
    v_add_u32 v15, 81920, v13
    v_add_u32 v16, 122880, v13
    v_and_b32 v2, 15, v1
    s_lshr_b32 s4, s65, 1
    v_lshl_add_u32 v2, v2, 4, s4
    v_lshlrev_b32 v2, 7, v2
    v_add_u32 v11, 0xe8000, v2
    s_waitcnt vmcnt(26)
    s_barrier
    ds_read_b128 v[60:63], v15 offset:0
    ds_read_b128 v[64:67], v15 offset:1024
    ds_read_b128 v[68:71], v15 offset:2048
    ds_read_b128 v[72:75], v15 offset:3072
    ds_read_b128 v[76:79], v15 offset:4096
    s_add_u32 m0, s69, 0
    s_add_u32 s4, s67, 81920
    buffer_load_dwordx4 v8, s[12:15], s4 offen sc1 lds
    s_add_u32 m0, s69, 1024
    s_add_u32 s4, s67, 82944
    buffer_load_dwordx4 v8, s[12:15], s4 offen sc1 lds
    s_add_u32 m0, s69, 2048
    s_add_u32 s4, s67, 83968
    buffer_load_dwordx4 v8, s[12:15], s4 offen sc1 lds
    s_add_u32 m0, s69, 3072
    s_add_u32 s4, s67, 84992
    buffer_load_dwordx4 v8, s[12:15], s4 offen sc1 lds
    s_add_u32 m0, s69, 4096
    s_add_u32 s4, s67, 86016
    buffer_load_dwordx4 v8, s[12:15], s4 offen sc1 lds
    s_add_u32 m0, s69, 40960
    s_add_u32 s4, s67, 122880
    buffer_load_dwordx4 v8, s[12:15], s4 offen sc1 lds
    s_waitcnt lgkmcnt(4)
    v_mfma_f32_16x16x32_bf16 v[20:23], v[60:63], v[144:147], 0
    ds_read_b128 v[80:83], v15 offset:20480
    v_mfma_f32_16x16x32_bf16 v[40:43], v[60:63], v[148:151], 0
    ds_read_b128 v[84:87], v15 offset:21504
    s_waitcnt lgkmcnt(5)
    v_mfma_f32_16x16x32_bf16 v[24:27], v[64:67], v[144:147], 0
    ds_read_b128 v[88:91], v15 offset:22528
    v_mfma_f32_16x16x32_bf16 v[44:47], v[64:67], v[148:151], 0
    ds_read_b128 v[92:95], v15 offset:23552
    s_waitcnt lgkmcnt(6)
    v_mfma_f32_16x16x32_bf16 v[28:31], v[68:71], v[144:147], 0
    ds_read_b128 v[96:99], v15 offset:24576
    v_mfma_f32_16x16x32_bf16 v[48:51], v[68:71], v[148:151], 0
    s_waitcnt lgkmcnt(6)
    v_mfma_f32_16x16x32_bf16 v[32:35], v[72:75], v[144:147], 0
    v_mfma_f32_16x16x32_bf16 v[52:55], v[72:75], v[148:151], 0
    s_waitcnt lgkmcnt(5)
    v_mfma_f32_16x16x32_bf16 v[36:39], v[76:79], v[144:147], 0
    v_mfma_f32_16x16x32_bf16 v[56:59], v[76:79], v[148:151], 0
    s_waitcnt lgkmcnt(0)
    s_barrier
    s_mov_b32 s76, s40
    s_mov_b32 s77, s41
    s_mov_b32 s78, 0x280000
    s_mov_b32 s79, 0x00020000
    s_mov_b32 s60, s54
    s_mov_b32 s61, s55
    s_mov_b32 s62, 0x280000
    s_mov_b32 s63, 0x00020000
    s_lshl_b32 s4, s65, 2
    s_lshl_b32 s5, s71, 1
    s_add_u32 s4, s4, s5
    s_add_u32 s4, s4, s70
    s_mul_i32 s4, s4, 20480
    s_mul_i32 s5, s66, 160
    s_add_u32 s4, s4, s5
    v_and_b32 v2, 15, v1
    v_mul_u32_u24 v2, 1280, v2
    v_lshrrev_b32 v3, 4, v1
    v_mul_u32_u24 v3, 40, v3
    v_add3_u32 v17, v2, v3, s4
    s_add_u32 m0, s69, 41984
    s_add_u32 s4, s67, 123904
    buffer_load_dwordx4 v8, s[12:15], s4 offen sc1 lds
    s_add_u32 m0, s69, 43008
    s_add_u32 s4, s67, 124928
    buffer_load_dwordx4 v8, s[12:15], s4 offen sc1 lds
    s_add_u32 m0, s69, 44032
    s_add_u32 s4, s67, 125952
    buffer_load_dwordx4 v8, s[12:15], s4 offen sc1 lds
    s_add_u32 m0, s69, 45056
    s_add_u32 s4, s67, 126976
    buffer_load_dwordx4 v8, s[12:15], s4 offen sc1 lds
    s_add_u32 m0, s69, 81920
    s_add_u32 s4, s67, 163840
    buffer_load_dwordx4 v8, s[12:15], s4 offen sc1 lds
    s_add_u32 m0, s69, 82944
    s_add_u32 s4, s67, 164864
    buffer_load_dwordx4 v8, s[12:15], s4 offen sc1 lds
    v_mfma_f32_16x16x32_bf16 v[20:23], v[80:83], v[152:155], v[20:23]
    ds_read_b128 v[60:63], v16 offset:0
    v_mfma_f32_16x16x32_bf16 v[40:43], v[80:83], v[156:159], v[40:43]
    ds_read_b128 v[64:67], v16 offset:1024
    v_mfma_f32_16x16x32_bf16 v[24:27], v[84:87], v[152:155], v[24:27]
    ds_read_b128 v[68:71], v16 offset:2048
    v_mfma_f32_16x16x32_bf16 v[44:47], v[84:87], v[156:159], v[44:47]
    ds_read_b128 v[72:75], v16 offset:3072
    v_mfma_f32_16x16x32_bf16 v[28:31], v[88:91], v[152:155], v[28:31]
    ds_read_b128 v[76:79], v16 offset:4096
    v_mfma_f32_16x16x32_bf16 v[48:51], v[88:91], v[156:159], v[48:51]
    v_mfma_f32_16x16x32_bf16 v[32:35], v[92:95], v[152:155], v[32:35]
    v_mfma_f32_16x16x32_bf16 v[52:55], v[92:95], v[156:159], v[52:55]
    v_mfma_f32_16x16x32_bf16 v[36:39], v[96:99], v[152:155], v[36:39]
    v_mfma_f32_16x16x32_bf16 v[56:59], v[96:99], v[156:159], v[56:59]
    s_waitcnt vmcnt(36)
    s_waitcnt lgkmcnt(4)
    v_mfma_f32_16x16x32_bf16 v[20:23], v[60:63], v[160:163], v[20:23]
    ds_read_b128 v[80:83], v16 offset:20480
    v_mfma_f32_16x16x32_bf16 v[40:43], v[60:63], v[164:167], v[40:43]
    ds_read_b128 v[84:87], v16 offset:21504
    s_waitcnt lgkmcnt(5)
    v_mfma_f32_16x16x32_bf16 v[24:27], v[64:67], v[160:163], v[24:27]
    ds_read_b128 v[88:91], v16 offset:22528
    v_mfma_f32_16x16x32_bf16 v[44:47], v[64:67], v[164:167], v[44:47]
    ds_read_b128 v[92:95], v16 offset:23552
    s_waitcnt lgkmcnt(6)
    v_mfma_f32_16x16x32_bf16 v[28:31], v[68:71], v[160:163], v[28:31]
    ds_read_b128 v[96:99], v16 offset:24576
    v_mfma_f32_16x16x32_bf16 v[48:51], v[68:71], v[164:167], v[48:51]
    s_waitcnt lgkmcnt(6)
    v_mfma_f32_16x16x32_bf16 v[32:35], v[72:75], v[160:163], v[32:35]
    v_mfma_f32_16x16x32_bf16 v[52:55], v[72:75], v[164:167], v[52:55]
    s_waitcnt lgkmcnt(5)
    v_mfma_f32_16x16x32_bf16 v[36:39], v[76:79], v[160:163], v[36:39]
    v_mfma_f32_16x16x32_bf16 v[56:59], v[76:79], v[164:167], v[56:59]
    s_waitcnt vmcnt(7)
    s_waitcnt lgkmcnt(0)
    s_barrier
    s_cmp_lg_u32 s22, 0
    s_cbranch_scc1 pub_92
    s_lshl_b32 s4, s20, 4
    s_add_u32 s4, s4, s21
    s_lshl_b32 s4, s4, 7
    s_add_u32 s4, s4, 0xe8000
    v_mov_b32 v2, s29
    s_mov_b64 exec, 1
    buffer_store_dword v2, off, s[72:75], s4 sc1
    s_mov_b64 exec, -1
pub_92:
    s_add_u32 m0, s69, 83968
    s_add_u32 s4, s67, 165888
    buffer_load_dwordx4 v8, s[12:15], s4 offen sc1 lds
    s_add_u32 m0, s69, 84992
    s_add_u32 s4, s67, 166912
    buffer_load_dwordx4 v8, s[12:15], s4 offen sc1 lds
    s_add_u32 m0, s69, 86016
    s_add_u32 s4, s67, 167936
    buffer_load_dwordx4 v8, s[12:15], s4 offen sc1 lds
    s_add_u32 m0, s69, 122880
    s_add_u32 s4, s67, 204800
    buffer_load_dwordx4 v8, s[12:15], s4 offen sc1 lds
    s_add_u32 m0, s69, 123904
    s_add_u32 s4, s67, 205824
    buffer_load_dwordx4 v8, s[12:15], s4 offen sc1 lds
    s_add_u32 m0, s69, 124928
    s_add_u32 s4, s67, 206848
    buffer_load_dwordx4 v8, s[12:15], s4 offen sc1 lds
    v_mfma_f32_16x16x32_bf16 v[20:23], v[80:83], v[168:171], v[20:23]
    ds_read_b128 v[60:63], v13 offset:0
    v_mfma_f32_16x16x32_bf16 v[40:43], v[80:83], v[172:175], v[40:43]
    ds_read_b128 v[64:67], v13 offset:1024
    v_mfma_f32_16x16x32_bf16 v[24:27], v[84:87], v[168:171], v[24:27]
    ds_read_b128 v[68:71], v13 offset:2048
    v_mfma_f32_16x16x32_bf16 v[44:47], v[84:87], v[172:175], v[44:47]
    ds_read_b128 v[72:75], v13 offset:3072
    v_mfma_f32_16x16x32_bf16 v[28:31], v[88:91], v[168:171], v[28:31]
    ds_read_b128 v[76:79], v13 offset:4096
    v_mfma_f32_16x16x32_bf16 v[48:51], v[88:91], v[172:175], v[48:51]
    v_mfma_f32_16x16x32_bf16 v[32:35], v[92:95], v[168:171], v[32:35]
    v_mfma_f32_16x16x32_bf16 v[52:55], v[92:95], v[172:175], v[52:55]
    v_mfma_f32_16x16x32_bf16 v[36:39], v[96:99], v[168:171], v[36:39]
    v_mfma_f32_16x16x32_bf16 v[56:59], v[96:99], v[172:175], v[56:59]
    s_waitcnt lgkmcnt(4)
    v_mfma_f32_16x16x32_bf16 v[20:23], v[60:63], v[176:179], v[20:23]
    ds_read_b128 v[80:83], v13 offset:20480
    v_mfma_f32_16x16x32_bf16 v[40:43], v[60:63], v[180:183], v[40:43]
    ds_read_b128 v[84:87], v13 offset:21504
    s_waitcnt lgkmcnt(5)
    v_mfma_f32_16x16x32_bf16 v[24:27], v[64:67], v[176:179], v[24:27]
    ds_read_b128 v[88:91], v13 offset:22528
    v_mfma_f32_16x16x32_bf16 v[44:47], v[64:67], v[180:183], v[44:47]
    ds_read_b128 v[92:95], v13 offset:23552
    s_waitcnt lgkmcnt(6)
    v_mfma_f32_16x16x32_bf16 v[28:31], v[68:71], v[176:179], v[28:31]
    ds_read_b128 v[96:99], v13 offset:24576
    v_mfma_f32_16x16x32_bf16 v[48:51], v[68:71], v[180:183], v[48:51]
    s_waitcnt lgkmcnt(6)
    v_mfma_f32_16x16x32_bf16 v[32:35], v[72:75], v[176:179], v[32:35]
    v_mfma_f32_16x16x32_bf16 v[52:55], v[72:75], v[180:183], v[52:55]
    s_waitcnt lgkmcnt(5)
    v_mfma_f32_16x16x32_bf16 v[36:39], v[76:79], v[176:179], v[36:39]
    v_mfma_f32_16x16x32_bf16 v[56:59], v[76:79], v[180:183], v[56:59]
    s_waitcnt vmcnt(8)
    s_waitcnt lgkmcnt(0)
    s_barrier
    buffer_load_dword v12, v11, s[72:75], 0 offen sc1
    s_add_u32 m0, s69, 125952
    s_add_u32 s4, s67, 207872
    buffer_load_dwordx4 v8, s[12:15], s4 offen sc1 lds
    s_add_u32 m0, s69, 126976
    s_add_u32 s4, s67, 208896
    buffer_load_dwordx4 v8, s[12:15], s4 offen sc1 lds
    s_add_u32 m0, s69, 0
    s_add_u32 s4, s67, 245760
    buffer_load_dwordx4 v8, s[12:15], s4 offen sc1 lds
    s_add_u32 m0, s69, 1024
    s_add_u32 s4, s67, 246784
    buffer_load_dwordx4 v8, s[12:15], s4 offen sc1 lds
    s_add_u32 m0, s69, 2048
    s_add_u32 s4, s67, 247808
    buffer_load_dwordx4 v8, s[12:15], s4 offen sc1 lds
    s_add_u32 m0, s69, 3072
    s_add_u32 s4, s67, 248832
    buffer_load_dwordx4 v8, s[12:15], s4 offen sc1 lds
    v_mfma_f32_16x16x32_bf16 v[20:23], v[80:83], v[184:187], v[20:23]
    ds_read_b128 v[60:63], v14 offset:0
    v_mfma_f32_16x16x32_bf16 v[40:43], v[80:83], v[188:191], v[40:43]
    ds_read_b128 v[64:67], v14 offset:1024
    v_mfma_f32_16x16x32_bf16 v[24:27], v[84:87], v[184:187], v[24:27]
    ds_read_b128 v[68:71], v14 offset:2048
    v_mfma_f32_16x16x32_bf16 v[44:47], v[84:87], v[188:191], v[44:47]
    ds_read_b128 v[72:75], v14 offset:3072
    v_mfma_f32_16x16x32_bf16 v[28:31], v[88:91], v[184:187], v[28:31]
    ds_read_b128 v[76:79], v14 offset:4096
    v_mfma_f32_16x16x32_bf16 v[48:51], v[88:91], v[188:191], v[48:51]
    v_mfma_f32_16x16x32_bf16 v[32:35], v[92:95], v[184:187], v[32:35]
    v_mfma_f32_16x16x32_bf16 v[52:55], v[92:95], v[188:191], v[52:55]
    v_mfma_f32_16x16x32_bf16 v[36:39], v[96:99], v[184:187], v[36:39]
    v_mfma_f32_16x16x32_bf16 v[56:59], v[96:99], v[188:191], v[56:59]
    s_waitcnt lgkmcnt(4)
    v_mfma_f32_16x16x32_bf16 v[20:23], v[60:63], v[192:195], v[20:23]
    ds_read_b128 v[80:83], v14 offset:20480
    v_mfma_f32_16x16x32_bf16 v[40:43], v[60:63], v[196:199], v[40:43]
    ds_read_b128 v[84:87], v14 offset:21504
    s_waitcnt lgkmcnt(5)
    v_mfma_f32_16x16x32_bf16 v[24:27], v[64:67], v[192:195], v[24:27]
    ds_read_b128 v[88:91], v14 offset:22528
    v_mfma_f32_16x16x32_bf16 v[44:47], v[64:67], v[196:199], v[44:47]
    ds_read_b128 v[92:95], v14 offset:23552
    s_waitcnt lgkmcnt(6)
    v_mfma_f32_16x16x32_bf16 v[28:31], v[68:71], v[192:195], v[28:31]
    ds_read_b128 v[96:99], v14 offset:24576
    v_mfma_f32_16x16x32_bf16 v[48:51], v[68:71], v[196:199], v[48:51]
    s_waitcnt lgkmcnt(6)
    v_mfma_f32_16x16x32_bf16 v[32:35], v[72:75], v[192:195], v[32:35]
    v_mfma_f32_16x16x32_bf16 v[52:55], v[72:75], v[196:199], v[52:55]
    s_waitcnt lgkmcnt(5)
    v_mfma_f32_16x16x32_bf16 v[36:39], v[76:79], v[192:195], v[36:39]
    v_mfma_f32_16x16x32_bf16 v[56:59], v[76:79], v[196:199], v[56:59]
    s_waitcnt vmcnt(6)
    s_waitcnt lgkmcnt(0)
    v_cmp_ne_u32 vcc, s29, v12
    s_nop 0
    s_cbranch_vccz poll_93_ok
    s_mov_b32 s31, 20000
poll_93:
    s_sleep 1
    buffer_load_dword v12, v11, s[72:75], 0 offen sc1
    s_waitcnt vmcnt(0)
    v_cmp_ne_u32 vcc, s29, v12
    s_nop 0
    s_cbranch_vccz poll_93_ok
    s_sub_u32 s31, s31, 1
    s_cmp_lg_u32 s31, 0
    s_cbranch_scc1 poll_93
poll_93_ok:
    s_barrier
    s_add_u32 m0, s69, 4096
    s_add_u32 s4, s67, 249856
    buffer_load_dwordx4 v8, s[12:15], s4 offen sc1 lds
    s_add_u32 s5, s68, 57344
    buffer_load_dwordx4 v[100:103], v9, s[8:11], s5 offen sc1
    s_add_u32 s5, s68, 57344
    buffer_load_dwordx4 v[104:107], v10, s[8:11], s5 offen sc1
    s_add_u32 m0, s69, 40960
    s_add_u32 s4, s67, 286720
    buffer_load_dwordx4 v8, s[12:15], s4 offen sc1 lds
    s_add_u32 m0, s69, 41984
    s_add_u32 s4, s67, 287744
    buffer_load_dwordx4 v8, s[12:15], s4 offen sc1 lds
    s_add_u32 m0, s69, 43008
    s_add_u32 s4, s67, 288768
    buffer_load_dwordx4 v8, s[12:15], s4 offen sc1 lds
    v_mfma_f32_16x16x32_bf16 v[20:23], v[80:83], v[200:203], v[20:23]
    ds_read_b128 v[60:63], v15 offset:0
    v_mfma_f32_16x16x32_bf16 v[40:43], v[80:83], v[204:207], v[40:43]
    ds_read_b128 v[64:67], v15 offset:1024
    v_mfma_f32_16x16x32_bf16 v[24:27], v[84:87], v[200:203], v[24:27]
    ds_read_b128 v[68:71], v15 offset:2048
    v_mfma_f32_16x16x32_bf16 v[44:47], v[84:87], v[204:207], v[44:47]
    ds_read_b128 v[72:75], v15 offset:3072
    v_mfma_f32_16x16x32_bf16 v[28:31], v[88:91], v[200:203], v[28:31]
    ds_read_b128 v[76:79], v15 offset:4096
    v_mfma_f32_16x16x32_bf16 v[48:51], v[88:91], v[204:207], v[48:51]
    v_mfma_f32_16x16x32_bf16 v[32:35], v[92:95], v[200:203], v[32:35]
    v_mfma_f32_16x16x32_bf16 v[52:55], v[92:95], v[204:207], v[52:55]
    v_mfma_f32_16x16x32_bf16 v[36:39], v[96:99], v[200:203], v[36:39]
    v_mfma_f32_16x16x32_bf16 v[56:59], v[96:99], v[204:207], v[56:59]
    s_waitcnt lgkmcnt(4)
    v_mfma_f32_16x16x32_bf16 v[20:23], v[60:63], v[208:211], v[20:23]
    ds_read_b128 v[80:83], v15 offset:20480
    v_mfma_f32_16x16x32_bf16 v[40:43], v[60:63], v[212:215], v[40:43]
    ds_read_b128 v[84:87], v15 offset:21504
    s_waitcnt lgkmcnt(5)
    v_mfma_f32_16x16x32_bf16 v[24:27], v[64:67], v[208:211], v[24:27]
    ds_read_b128 v[88:91], v15 offset:22528
    v_mfma_f32_16x16x32_bf16 v[44:47], v[64:67], v[212:215], v[44:47]
    ds_read_b128 v[92:95], v15 offset:23552
    s_waitcnt lgkmcnt(6)
    v_mfma_f32_16x16x32_bf16 v[28:31], v[68:71], v[208:211], v[28:31]
    ds_read_b128 v[96:99], v15 offset:24576
    v_mfma_f32_16x16x32_bf16 v[48:51], v[68:71], v[212:215], v[48:51]
    s_waitcnt lgkmcnt(6)
    v_mfma_f32_16x16x32_bf16 v[32:35], v[72:75], v[208:211], v[32:35]
    v_mfma_f32_16x16x32_bf16 v[52:55], v[72:75], v[212:215], v[52:55]
    s_waitcnt lgkmcnt(5)
    v_mfma_f32_16x16x32_bf16 v[36:39], v[76:79], v[208:211], v[36:39]
    v_mfma_f32_16x16x32_bf16 v[56:59], v[76:79], v[212:215], v[56:59]
    s_waitcnt vmcnt(10)
    s_waitcnt lgkmcnt(0)
    s_barrier
    s_add_u32 m0, s69, 44032
    s_add_u32 s4, s67, 289792
    buffer_load_dwordx4 v8, s[12:15], s4 offen sc1 lds
    s_add_u32 m0, s69, 45056
    s_add_u32 s4, s67, 290816
    buffer_load_dwordx4 v8, s[12:15], s4 offen sc1 lds
    s_add_u32 s5, s68, 61440
    buffer_load_dwordx4 v[108:111], v9, s[8:11], s5 offen sc1
    s_add_u32 s5, s68, 61440
    buffer_load_dwordx4 v[112:115], v10, s[8:11], s5 offen sc1
    s_add_u32 s5, s68, 65536
    buffer_load_dwordx4 v[116:119], v9, s[8:11], s5 offen sc1
    s_add_u32 s5, s68, 65536
    buffer_load_dwordx4 v[120:123], v10, s[8:11], s5 offen sc1
    v_mfma_f32_16x16x32_bf16 v[20:23], v[80:83], v[216:219], v[20:23]
    ds_read_b128 v[60:63], v16 offset:0
    v_mfma_f32_16x16x32_bf16 v[40:43], v[80:83], v[220:223], v[40:43]
    ds_read_b128 v[64:67], v16 offset:1024
    v_mfma_f32_16x16x32_bf16 v[24:27], v[84:87], v[216:219], v[24:27]
    ds_read_b128 v[68:71], v16 offset:2048
    v_mfma_f32_16x16x32_bf16 v[44:47], v[84:87], v[220:223], v[44:47]
    ds_read_b128 v[72:75], v16 offset:3072
    v_mfma_f32_16x16x32_bf16 v[28:31], v[88:91], v[216:219], v[28:31]
    ds_read_b128 v[76:79], v16 offset:4096
    v_mfma_f32_16x16x32_bf16 v[48:51], v[88:91], v[220:223], v[48:51]
    v_mfma_f32_16x16x32_bf16 v[32:35], v[92:95], v[216:219], v[32:35]
    v_mfma_f32_16x16x32_bf16 v[52:55], v[92:95], v[220:223], v[52:55]
    v_mfma_f32_16x16x32_bf16 v[36:39], v[96:99], v[216:219], v[36:39]
    v_mfma_f32_16x16x32_bf16 v[56:59], v[96:99], v[220:223], v[56:59]
    s_waitcnt lgkmcnt(4)
    v_mfma_f32_16x16x32_bf16 v[20:23], v[60:63], v[224:227], v[20:23]
    ds_read_b128 v[80:83], v16 offset:20480
    v_mfma_f32_16x16x32_bf16 v[40:43], v[60:63], v[228:231], v[40:43]
    ds_read_b128 v[84:87], v16 offset:21504
    s_waitcnt lgkmcnt(5)
    v_mfma_f32_16x16x32_bf16 v[24:27], v[64:67], v[224:227], v[24:27]
    ds_read_b128 v[88:91], v16 offset:22528
    v_mfma_f32_16x16x32_bf16 v[44:47], v[64:67], v[228:231], v[44:47]
    ds_read_b128 v[92:95], v16 offset:23552
    s_waitcnt lgkmcnt(6)
    v_mfma_f32_16x16x32_bf16 v[28:31], v[68:71], v[224:227], v[28:31]
    ds_read_b128 v[96:99], v16 offset:24576
    v_mfma_f32_16x16x32_bf16 v[48:51], v[68:71], v[228:231], v[48:51]
    s_waitcnt lgkmcnt(6)
    v_mfma_f32_16x16x32_bf16 v[32:35], v[72:75], v[224:227], v[32:35]
    v_mfma_f32_16x16x32_bf16 v[52:55], v[72:75], v[228:231], v[52:55]
    s_waitcnt lgkmcnt(5)
    v_mfma_f32_16x16x32_bf16 v[36:39], v[76:79], v[224:227], v[36:39]
    v_mfma_f32_16x16x32_bf16 v[56:59], v[76:79], v[228:231], v[56:59]
    s_waitcnt vmcnt(11)
    s_waitcnt lgkmcnt(0)
    s_barrier
    s_add_u32 m0, s69, 81920
    s_add_u32 s4, s67, 327680
    buffer_load_dwordx4 v8, s[12:15], s4 offen sc1 lds
    s_add_u32 m0, s69, 82944
    s_add_u32 s4, s67, 328704
    buffer_load_dwordx4 v8, s[12:15], s4 offen sc1 lds
    s_add_u32 m0, s69, 83968
    s_add_u32 s4, s67, 329728
    buffer_load_dwordx4 v8, s[12:15], s4 offen sc1 lds
    s_add_u32 m0, s69, 84992
    s_add_u32 s4, s67, 330752
    buffer_load_dwordx4 v8, s[12:15], s4 offen sc1 lds
    s_add_u32 m0, s69, 86016
    s_add_u32 s4, s67, 331776
    buffer_load_dwordx4 v8, s[12:15], s4 offen sc1 lds
    s_add_u32 s5, s68, 69632
    buffer_load_dwordx4 v[124:127], v9, s[8:11], s5 offen sc1
    v_mfma_f32_16x16x32_bf16 v[20:23], v[80:83], v[232:235], v[20:23]
    ds_read_b128 v[60:63], v13 offset:0
    v_mfma_f32_16x16x32_bf16 v[40:43], v[80:83], v[236:239], v[40:43]
    ds_read_b128 v[64:67], v13 offset:1024
    v_mfma_f32_16x16x32_bf16 v[24:27], v[84:87], v[232:235], v[24:27]
    ds_read_b128 v[68:71], v13 offset:2048
    v_mfma_f32_16x16x32_bf16 v[44:47], v[84:87], v[236:239], v[44:47]
    ds_read_b128 v[72:75], v13 offset:3072
    v_mfma_f32_16x16x32_bf16 v[28:31], v[88:91], v[232:235], v[28:31]
    ds_read_b128 v[76:79], v13 offset:4096
    v_mfma_f32_16x16x32_bf16 v[48:51], v[88:91], v[236:239], v[48:51]
    v_mfma_f32_16x16x32_bf16 v[32:35], v[92:95], v[232:235], v[32:35]
    v_mfma_f32_16x16x32_bf16 v[52:55], v[92:95], v[236:239], v[52:55]
    v_mfma_f32_16x16x32_bf16 v[36:39], v[96:99], v[232:235], v[36:39]
    v_mfma_f32_16x16x32_bf16 v[56:59], v[96:99], v[236:239], v[56:59]
    s_waitcnt lgkmcnt(4)
    v_mfma_f32_16x16x32_bf16 v[20:23], v[60:63], v[240:243], v[20:23]
    ds_read_b128 v[80:83], v13 offset:20480
    v_mfma_f32_16x16x32_bf16 v[40:43], v[60:63], v[244:247], v[40:43]
    ds_read_b128 v[84:87], v13 offset:21504
    s_waitcnt lgkmcnt(5)
    v_mfma_f32_16x16x32_bf16 v[24:27], v[64:67], v[240:243], v[24:27]
    ds_read_b128 v[88:91], v13 offset:22528
    v_mfma_f32_16x16x32_bf16 v[44:47], v[64:67], v[244:247], v[44:47]
    ds_read_b128 v[92:95], v13 offset:23552
    s_waitcnt lgkmcnt(6)
    v_mfma_f32_16x16x32_bf16 v[28:31], v[68:71], v[240:243], v[28:31]
    ds_read_b128 v[96:99], v13 offset:24576
    v_mfma_f32_16x16x32_bf16 v[48:51], v[68:71], v[244:247], v[48:51]
    s_waitcnt lgkmcnt(6)
    v_mfma_f32_16x16x32_bf16 v[32:35], v[72:75], v[240:243], v[32:35]
    v_mfma_f32_16x16x32_bf16 v[52:55], v[72:75], v[244:247], v[52:55]
    s_waitcnt lgkmcnt(5)
    v_mfma_f32_16x16x32_bf16 v[36:39], v[76:79], v[240:243], v[36:39]
    v_mfma_f32_16x16x32_bf16 v[56:59], v[76:79], v[244:247], v[56:59]
    s_waitcnt vmcnt(10)
    s_waitcnt lgkmcnt(0)
    s_barrier
    s_add_u32 s5, s68, 69632
    buffer_load_dwordx4 v[128:131], v10, s[8:11], s5 offen sc1
    s_add_u32 s5, s68, 73728
    buffer_load_dwordx4 v[132:135], v9, s[8:11], s5 offen sc1
    s_add_u32 s5, s68, 73728
    buffer_load_dwordx4 v[136:139], v10, s[8:11], s5 offen sc1
    s_mul_i32 s4, s22, 3072
    s_add_u32 m0, s4, 122880
    s_add_u32 s4, s4, 368640
    buffer_load_dwordx4 v8, s[12:15], s4 offen sc1 lds
    s_mul_i32 s4, s22, 3072
    s_add_u32 m0, s4, 123904
    s_add_u32 s4, s4, 369664
    buffer_load_dwordx4 v8, s[12:15], s4 offen sc1 lds
    s_mul_i32 s4, s22, 3072
    s_add_u32 m0, s4, 124928
    s_add_u32 s4, s4, 370688
    buffer_load_dwordx4 v8, s[12:15], s4 offen sc1 lds
    v_mfma_f32_16x16x32_bf16 v[20:23], v[80:83], v[248:251], v[20:23]
    ds_read_b128 v[60:63], v14 offset:0
    v_mfma_f32_16x16x32_bf16 v[40:43], v[80:83], v[252:255], v[40:43]
    ds_read_b128 v[64:67], v14 offset:1024
    v_mfma_f32_16x16x32_bf16 v[24:27], v[84:87], v[248:251], v[24:27]
    ds_read_b128 v[68:71], v14 offset:2048
    v_mfma_f32_16x16x32_bf16 v[44:47], v[84:87], v[252:255], v[44:47]
    ds_read_b128 v[72:75], v14 offset:3072
    v_mfma_f32_16x16x32_bf16 v[28:31], v[88:91], v[248:251], v[28:31]
    ds_read_b128 v[76:79], v14 offset:4096
    v_mfma_f32_16x16x32_bf16 v[48:51], v[88:91], v[252:255], v[48:51]
    v_mfma_f32_16x16x32_bf16 v[32:35], v[92:95], v[248:251], v[32:35]
    v_mfma_f32_16x16x32_bf16 v[52:55], v[92:95], v[252:255], v[52:55]
    v_mfma_f32_16x16x32_bf16 v[36:39], v[96:99], v[248:251], v[36:39]
    v_mfma_f32_16x16x32_bf16 v[56:59], v[96:99], v[252:255], v[56:59]
    s_waitcnt lgkmcnt(4)
    v_mfma_f32_16x16x32_bf16 v[20:23], v[60:63], v[100:103], v[20:23]
    ds_read_b128 v[80:83], v14 offset:20480
    v_mfma_f32_16x16x32_bf16 v[40:43], v[60:63], v[104:107], v[40:43]
    ds_read_b128 v[84:87], v14 offset:21504
    s_waitcnt lgkmcnt(5)
    v_mfma_f32_16x16x32_bf16 v[24:27], v[64:67], v[100:103], v[24:27]
    ds_read_b128 v[88:91], v14 offset:22528
    v_mfma_f32_16x16x32_bf16 v[44:47], v[64:67], v[104:107], v[44:47]
    ds_read_b128 v[92:95], v14 offset:23552
    s_waitcnt lgkmcnt(6)
    v_mfma_f32_16x16x32_bf16 v[28:31], v[68:71], v[100:103], v[28:31]
    ds_read_b128 v[96:99], v14 offset:24576
    v_mfma_f32_16x16x32_bf16 v[48:51], v[68:71], v[104:107], v[48:51]
    s_waitcnt lgkmcnt(6)
    v_mfma_f32_16x16x32_bf16 v[32:35], v[72:75], v[100:103], v[32:35]
    v_mfma_f32_16x16x32_bf16 v[52:55], v[72:75], v[104:107], v[52:55]
    s_waitcnt lgkmcnt(5)
    v_mfma_f32_16x16x32_bf16 v[36:39], v[76:79], v[100:103], v[36:39]
    v_mfma_f32_16x16x32_bf16 v[56:59], v[76:79], v[104:107], v[56:59]
    s_waitcnt vmcnt(7)
    s_waitcnt lgkmcnt(0)
    s_barrier
    buffer_load_dwordx4 v[144:147], v17, s[76:79], 0 offen
    buffer_load_dwordx4 v[148:151], v17, s[76:79], 0 offen offset:16
    buffer_load_dwordx2 v[152:153], v17, s[76:79], 0 offen offset:32
    v_mfma_f32_16x16x32_bf16 v[20:23], v[80:83], v[108:111], v[20:23]
    ds_read_b128 v[60:63], v15 offset:0
    v_mfma_f32_16x16x32_bf16 v[40:43], v[80:83], v[112:115], v[40:43]
    ds_read_b128 v[64:67], v15 offset:1024
    v_mfma_f32_16x16x32_bf16 v[24:27], v[84:87], v[108:111], v[24:27]
    ds_read_b128 v[68:71], v15 offset:2048
    v_mfma_f32_16x16x32_bf16 v[44:47], v[84:87], v[112:115], v[44:47]
    ds_read_b128 v[72:75], v15 offset:3072
    v_mfma_f32_16x16x32_bf16 v[28:31], v[88:91], v[108:111], v[28:31]
    ds_read_b128 v[76:79], v15 offset:4096
    v_mfma_f32_16x16x32_bf16 v[48:51], v[88:91], v[112:115], v[48:51]
    v_mfma_f32_16x16x32_bf16 v[32:35], v[92:95], v[108:111], v[32:35]
    v_mfma_f32_16x16x32_bf16 v[52:55], v[92:95], v[112:115], v[52:55]
    v_mfma_f32_16x16x32_bf16 v[36:39], v[96:99], v[108:111], v[36:39]
    v_mfma_f32_16x16x32_bf16 v[56:59], v[96:99], v[112:115], v[56:59]
    s_waitcnt lgkmcnt(4)
    v_mfma_f32_16x16x32_bf16 v[20:23], v[60:63], v[116:119], v[20:23]
    ds_read_b128 v[80:83], v15 offset:20480
    v_mfma_f32_16x16x32_bf16 v[40:43], v[60:63], v[120:123], v[40:43]
    ds_read_b128 v[84:87], v15 offset:21504
    s_waitcnt lgkmcnt(5)
    v_mfma_f32_16x16x32_bf16 v[24:27], v[64:67], v[116:119], v[24:27]
    ds_read_b128 v[88:91], v15 offset:22528
    v_mfma_f32_16x16x32_bf16 v[44:47], v[64:67], v[120:123], v[44:47]
    ds_read_b128 v[92:95], v15 offset:23552
    s_waitcnt lgkmcnt(6)
    v_mfma_f32_16x16x32_bf16 v[28:31], v[68:71], v[116:119], v[28:31]
    ds_read_b128 v[96:99], v15 offset:24576
    v_mfma_f32_16x16x32_bf16 v[48:51], v[68:71], v[120:123], v[48:51]
    s_waitcnt lgkmcnt(6)
    v_mfma_f32_16x16x32_bf16 v[32:35], v[72:75], v[116:119], v[32:35]
    v_mfma_f32_16x16x32_bf16 v[52:55], v[72:75], v[120:123], v[52:55]
    s_waitcnt lgkmcnt(5)
    v_mfma_f32_16x16x32_bf16 v[36:39], v[76:79], v[116:119], v[36:39]
    v_mfma_f32_16x16x32_bf16 v[56:59], v[76:79], v[120:123], v[56:59]
    s_waitcnt vmcnt(3)
    s_waitcnt lgkmcnt(0)
    s_barrier
    v_mfma_f32_16x16x32_bf16 v[20:23], v[80:83], v[124:127], v[20:23]
    ds_read_b128 v[60:63], v16 offset:0
    v_mfma_f32_16x16x32_bf16 v[40:43], v[80:83], v[128:131], v[40:43]
    ds_read_b128 v[64:67], v16 offset:1024
    v_mfma_f32_16x16x32_bf16 v[24:27], v[84:87], v[124:127], v[24:27]
    ds_read_b128 v[68:71], v16 offset:2048
    v_mfma_f32_16x16x32_bf16 v[44:47], v[84:87], v[128:131], v[44:47]
    ds_read_b128 v[72:75], v16 offset:3072
    v_mfma_f32_16x16x32_bf16 v[28:31], v[88:91], v[124:127], v[28:31]
    ds_read_b128 v[76:79], v16 offset:4096
    v_mfma_f32_16x16x32_bf16 v[48:51], v[88:91], v[128:131], v[48:51]
    v_mfma_f32_16x16x32_bf16 v[32:35], v[92:95], v[124:127], v[32:35]
    v_mfma_f32_16x16x32_bf16 v[52:55], v[92:95], v[128:131], v[52:55]
    v_mfma_f32_16x16x32_bf16 v[36:39], v[96:99], v[124:127], v[36:39]
    v_mfma_f32_16x16x32_bf16 v[56:59], v[96:99], v[128:131], v[56:59]
    s_waitcnt lgkmcnt(4)
    v_mfma_f32_16x16x32_bf16 v[20:23], v[60:63], v[132:135], v[20:23]
    v_mfma_f32_16x16x32_bf16 v[40:43], v[60:63], v[136:139], v[40:43]
    s_waitcnt lgkmcnt(3)
    v_mfma_f32_16x16x32_bf16 v[24:27], v[64:67], v[132:135], v[24:27]
    v_mfma_f32_16x16x32_bf16 v[44:47], v[64:67], v[136:139], v[44:47]
    s_waitcnt lgkmcnt(2)
    v_mfma_f32_16x16x32_bf16 v[28:31], v[68:71], v[132:135], v[28:31]
    v_mfma_f32_16x16x32_bf16 v[48:51], v[68:71], v[136:139], v[48:51]
    s_waitcnt lgkmcnt(1)
    v_mfma_f32_16x16x32_bf16 v[32:35], v[72:75], v[132:135], v[32:35]
    v_mfma_f32_16x16x32_bf16 v[52:55], v[72:75], v[136:139], v[52:55]
    s_waitcnt lgkmcnt(0)
    v_mfma_f32_16x16x32_bf16 v[36:39], v[76:79], v[132:135], v[36:39]
    v_mfma_f32_16x16x32_bf16 v[56:59], v[76:79], v[136:139], v[56:59]
    s_and_b32 s4, s70, 1
    s_lshl_b32 s5, s71, 1
    s_xor_b32 s6, s4, 1
    s_sub_u32 s7, s70, s6
    s_sub_u32 s7, s7, 1
    s_and_b32 s7, s7, 3
    s_add_u32 s6, s6, s5
    s_mul_i32 s6, s6, 3
    s_add_u32 s6, s6, s7
    s_mul_i32 s6, s6, 5120
    v_add_u32 v18, s6, v8
    ds_write_b128 v18, v[40:43] offset:0
    ds_write_b128 v18, v[44:47] offset:1024
    ds_write_b128 v18, v[48:51] offset:2048
    ds_write_b128 v18, v[52:55] offset:3072
    ds_write_b128 v18, v[56:59] offset:4096
    s_waitcnt lgkmcnt(0)
    s_barrier
    s_add_u32 s6, s70, s5
    s_mul_i32 s6, s6, 15360
    v_add_u32 v18, s6, v8
    ds_read_b128 v[60:63], v18 offset:0
    ds_read_b128 v[80:83], v18 offset:5120
    ds_read_b128 v[100:103], v18 offset:10240
    ds_read_b128 v[64:67], v18 offset:1024
    ds_read_b128 v[84:87], v18 offset:6144
    ds_read_b128 v[104:107], v18 offset:11264
    ds_read_b128 v[68:71], v18 offset:2048
    ds_read_b128 v[88:91], v18 offset:7168
    ds_read_b128 v[108:111], v18 offset:12288
    ds_read_b128 v[72:75], v18 offset:3072
    ds_read_b128 v[92:95], v18 offset:8192
    ds_read_b128 v[112:115], v18 offset:13312
    ds_read_b128 v[76:79], v18 offset:4096
    ds_read_b128 v[96:99], v18 offset:9216
    ds_read_b128 v[116:119], v18 offset:14336
    s_waitcnt vmcnt(0)
    s_waitcnt lgkmcnt(14)
    v_pk_add_f32 v[20:21], v[20:21], v[60:61] op_sel:[0,0] op_sel_hi:[1,1]
    s_waitcnt lgkmcnt(12)
    v_pk_add_f32 v[80:81], v[80:81], v[100:101] op_sel:[0,0] op_sel_hi:[1,1]
    v_lshlrev_b32 v4, 16, v144
    v_and_b32 v5, 0xffff0000, v144
    v_pk_add_f32 v[80:81], v[80:81], v[4:5] op_sel:[0,0] op_sel_hi:[1,1]
    v_pk_add_f32 v[20:21], v[20:21], v[80:81] op_sel:[0,0] op_sel_hi:[1,1]
    v_cvt_pk_bf16_f32 v120, v20, v21
    v_pk_add_f32 v[22:23], v[22:23], v[62:63] op_sel:[0,0] op_sel_hi:[1,1]
    v_pk_add_f32 v[82:83], v[82:83], v[102:103] op_sel:[0,0] op_sel_hi:[1,1]
    v_lshlrev_b32 v4, 16, v145
    v_and_b32 v5, 0xffff0000, v145
    v_pk_add_f32 v[82:83], v[82:83], v[4:5] op_sel:[0,0] op_sel_hi:[1,1]
    v_pk_add_f32 v[22:23], v[22:23], v[82:83] op_sel:[0,0] op_sel_hi:[1,1]
    v_cvt_pk_bf16_f32 v121, v22, v23
    s_waitcnt lgkmcnt(11)
    v_pk_add_f32 v[24:25], v[24:25], v[64:65] op_sel:[0,0] op_sel_hi:[1,1]
    s_waitcnt lgkmcnt(9)
    v_pk_add_f32 v[84:85], v[84:85], v[104:105] op_sel:[0,0] op_sel_hi:[1,1]
    v_lshlrev_b32 v4, 16, v146
    v_and_b32 v5, 0xffff0000, v146
    v_pk_add_f32 v[84:85], v[84:85], v[4:5] op_sel:[0,0] op_sel_hi:[1,1]
    v_pk_add_f32 v[24:25], v[24:25], v[84:85] op_sel:[0,0] op_sel_hi:[1,1]
    v_cvt_pk_bf16_f32 v122, v24, v25
    v_pk_add_f32 v[26:27], v[26:27], v[66:67] op_sel:[0,0] op_sel_hi:[1,1]
    v_pk_add_f32 v[86:87], v[86:87], v[106:107] op_sel:[0,0] op_sel_hi:[1,1]
    v_lshlrev_b32 v4, 16, v147
    v_and_b32 v5, 0xffff0000, v147
    v_pk_add_f32 v[86:87], v[86:87], v[4:5] op_sel:[0,0] op_sel_hi:[1,1]
    v_pk_add_f32 v[26:27], v[26:27], v[86:87] op_sel:[0,0] op_sel_hi:[1,1]
    v_cvt_pk_bf16_f32 v123, v26, v27
    s_waitcnt lgkmcnt(8)
    v_pk_add_f32 v[28:29], v[28:29], v[68:69] op_sel:[0,0] op_sel_hi:[1,1]
    s_waitcnt lgkmcnt(6)
    v_pk_add_f32 v[88:89], v[88:89], v[108:109] op_sel:[0,0] op_sel_hi:[1,1]
    v_lshlrev_b32 v4, 16, v148
    v_and_b32 v5, 0xffff0000, v148
    v_pk_add_f32 v[88:89], v[88:89], v[4:5] op_sel:[0,0] op_sel_hi:[1,1]
    v_pk_add_f32 v[28:29], v[28:29], v[88:89] op_sel:[0,0] op_sel_hi:[1,1]
    v_cvt_pk_bf16_f32 v124, v28, v29
    v_pk_add_f32 v[30:31], v[30:31], v[70:71] op_sel:[0,0] op_sel_hi:[1,1]
    v_pk_add_f32 v[90:91], v[90:91], v[110:111] op_sel:[0,0] op_sel_hi:[1,1]
    v_lshlrev_b32 v4, 16, v149
    v_and_b32 v5, 0xffff0000, v149
    v_pk_add_f32 v[90:91], v[90:91], v[4:5] op_sel:[0,0] op_sel_hi:[1,1]
    v_pk_add_f32 v[30:31], v[30:31], v[90:91] op_sel:[0,0] op_sel_hi:[1,1]
    v_cvt_pk_bf16_f32 v125, v30, v31
    s_waitcnt lgkmcnt(5)
    v_pk_add_f32 v[32:33], v[32:33], v[72:73] op_sel:[0,0] op_sel_hi:[1,1]
    s_waitcnt lgkmcnt(3)
    v_pk_add_f32 v[92:93], v[92:93], v[112:113] op_sel:[0,0] op_sel_hi:[1,1]
    v_lshlrev_b32 v4, 16, v150
    v_and_b32 v5, 0xffff0000, v150
    v_pk_add_f32 v[92:93], v[92:93], v[4:5] op_sel:[0,0] op_sel_hi:[1,1]
    v_pk_add_f32 v[32:33], v[32:33], v[92:93] op_sel:[0,0] op_sel_hi:[1,1]
    v_cvt_pk_bf16_f32 v126, v32, v33
    v_pk_add_f32 v[34:35], v[34:35], v[74:75] op_sel:[0,0] op_sel_hi:[1,1]
    v_pk_add_f32 v[94:95], v[94:95], v[114:115] op_sel:[0,0] op_sel_hi:[1,1]
    v_lshlrev_b32 v4, 16, v151
    v_and_b32 v5, 0xffff0000, v151
    v_pk_add_f32 v[94:95], v[94:95], v[4:5] op_sel:[0,0] op_sel_hi:[1,1]
    v_pk_add_f32 v[34:35], v[34:35], v[94:95] op_sel:[0,0] op_sel_hi:[1,1]
    v_cvt_pk_bf16_f32 v127, v34, v35
    s_waitcnt lgkmcnt(2)
    v_pk_add_f32 v[36:37], v[36:37], v[76:77] op_sel:[0,0] op_sel_hi:[1,1]
    s_waitcnt lgkmcnt(0)
    v_pk_add_f32 v[96:97], v[96:97], v[116:117] op_sel:[0,0] op_sel_hi:[1,1]
    v_lshlrev_b32 v4, 16, v152
    v_and_b32 v5, 0xffff0000, v152
    v_pk_add_f32 v[96:97], v[96:97], v[4:5] op_sel:[0,0] op_sel_hi:[1,1]
    v_pk_add_f32 v[36:37], v[36:37], v[96:97] op_sel:[0,0] op_sel_hi:[1,1]
    v_cvt_pk_bf16_f32 v128, v36, v37
    v_pk_add_f32 v[38:39], v[38:39], v[78:79] op_sel:[0,0] op_sel_hi:[1,1]
    v_pk_add_f32 v[98:99], v[98:99], v[118:119] op_sel:[0,0] op_sel_hi:[1,1]
    v_lshlrev_b32 v4, 16, v153
    v_and_b32 v5, 0xffff0000, v153
    v_pk_add_f32 v[98:99], v[98:99], v[4:5] op_sel:[0,0] op_sel_hi:[1,1]
    v_pk_add_f32 v[38:39], v[38:39], v[98:99] op_sel:[0,0] op_sel_hi:[1,1]
    v_cvt_pk_bf16_f32 v129, v38, v39
    buffer_store_dwordx4 v[120:123], v17, s[60:63], 0 offen
    buffer_store_dwordx4 v[124:127], v17, s[60:63], 0 offen offset:16
    buffer_store_dwordx2 v[128:129], v17, s[60:63], 0 offen offset:32
    s_endpgm
p3_clsB:
    v_mov_b32 v4, v132
    v_mov_b32 v5, v132
    s_nop 1
    v_permlane32_swap_b32 v4, v5
    v_rcp_f32 v5, v5
    s_nop 0
    v_pk_mul_f32 v[124:125], v[4:5], v[124:125] op_sel:[1,0] op_sel_hi:[1,1]
    v_pk_mul_f32 v[126:127], v[4:5], v[126:127] op_sel:[1,0] op_sel_hi:[1,1]
    v_pk_mul_f32 v[128:129], v[4:5], v[128:129] op_sel:[1,0] op_sel_hi:[1,1]
    v_pk_mul_f32 v[130:131], v[4:5], v[130:131] op_sel:[1,0] op_sel_hi:[1,1]
    v_pk_mul_f32 v[132:133], v[4:5], v[132:133] op_sel:[1,0] op_sel_hi:[1,1]
    v_pk_mul_f32 v[134:135], v[4:5], v[134:135] op_sel:[1,0] op_sel_hi:[1,1]
    v_cvt_pk_bf16_f32 v52, v124, v125
    v_cvt_pk_bf16_f32 v53, v126, v127
    v_cvt_pk_bf16_f32 v54, v128, v129
    v_cvt_pk_bf16_f32 v55, v130, v131
    v_cvt_pk_bf16_f32 v56, v132, v133
    v_cvt_pk_bf16_f32 v57, v134, v135
    s_add_u32 s16, s58, 0x0
    s_addc_u32 s17, s59, 0
    s_mov_b32 s18, 0x940000
    s_mov_b32 s19, 0x00020000
    s_lshl_b32 s4, s24, 1
    s_mul_i32 s4, s4, 75776
    v_bfe_u32 v4, v1, 4, 1
    v_mul_u32_u24 v4, 75776, v4
    v_and_b32 v5, 15, v1
    v_lshl_add_u32 v4, v5, 4, v4
    v_add_u32 v4, s4, v4
    v_lshrrev_b32 v5, 5, v1
    v_lshl_add_u32 v5, v5, 8, v4
    s_add_u32 s5, s20, 54
    s_lshl_b32 s5, s5, 10
    s_lshl_b32 s6, s23, 9
    s_add_u32 s5, s5, s6
    buffer_store_dwordx4 v[52:55], v5, s[16:19], s5 offen sc1
    s_lshr_b32 s5, s20, 2
    s_add_u32 s5, s5, 70
    s_lshl_b32 s5, s5, 10
    s_and_b32 s6, s20, 3
    s_lshl_b32 s6, s6, 8
    s_add_u32 s5, s5, s6
    s_lshl_b32 s6, s23, 3
    s_add_u32 s5, s5, s6
    s_mov_b32 exec_hi, 0
    buffer_store_dwordx2 v[56:57], v4, s[16:19], s5 offen sc1
    s_mov_b32 exec_hi, -1
    s_mul_i32 s4, s70, 5120
    v_add_u32 v13, s4, v8
    v_add_u32 v14, 40960, v13
    v_add_u32 v15, 81920, v13
    v_add_u32 v16, 122880, v13
    v_and_b32 v2, 15, v1
    s_lshr_b32 s4, s65, 1
    v_lshl_add_u32 v2, v2, 4, s4
    v_lshlrev_b32 v2, 7, v2
    v_add_u32 v11, 0xe8000, v2
    s_waitcnt vmcnt(24)
    s_barrier
    ds_read_b128 v[60:63], v15 offset:0
    ds_read_b128 v[64:67], v15 offset:1024
    ds_read_b128 v[68:71], v15 offset:2048
    ds_read_b128 v[72:75], v15 offset:3072
    ds_read_b128 v[76:79], v15 offset:4096
    s_waitcnt lgkmcnt(4)
    v_mfma_f32_16x16x32_bf16 v[20:23], v[60:63], v[144:147], 0
    ds_read_b128 v[80:83], v15 offset:20480
    v_mfma_f32_16x16x32_bf16 v[40:43], v[60:63], v[148:151], 0
    ds_read_b128 v[84:87], v15 offset:21504
    s_waitcnt lgkmcnt(5)
    v_mfma_f32_16x16x32_bf16 v[24:27], v[64:67], v[144:147], 0
    ds_read_b128 v[88:91], v15 offset:22528
    v_mfma_f32_16x16x32_bf16 v[44:47], v[64:67], v[148:151], 0
    ds_read_b128 v[92:95], v15 offset:23552
    s_waitcnt lgkmcnt(6)
    v_mfma_f32_16x16x32_bf16 v[28:31], v[68:71], v[144:147], 0
    ds_read_b128 v[96:99], v15 offset:24576
    v_mfma_f32_16x16x32_bf16 v[48:51], v[68:71], v[148:151], 0
    s_waitcnt lgkmcnt(6)
    v_mfma_f32_16x16x32_bf16 v[32:35], v[72:75], v[144:147], 0
    v_mfma_f32_16x16x32_bf16 v[52:55], v[72:75], v[148:151], 0
    s_waitcnt lgkmcnt(5)
    v_mfma_f32_16x16x32_bf16 v[36:39], v[76:79], v[144:147], 0
    v_mfma_f32_16x16x32_bf16 v[56:59], v[76:79], v[148:151], 0
    s_add_u32 m0, s69, 0
    s_add_u32 s4, s67, 81920
    buffer_load_dwordx4 v8, s[12:15], s4 offen sc1 lds
    s_add_u32 m0, s69, 1024
    s_add_u32 s4, s67, 82944
    buffer_load_dwordx4 v8, s[12:15], s4 offen sc1 lds
    s_add_u32 m0, s69, 2048
    s_add_u32 s4, s67, 83968
    buffer_load_dwordx4 v8, s[12:15], s4 offen sc1 lds
    s_add_u32 m0, s69, 3072
    s_add_u32 s4, s67, 84992
    buffer_load_dwordx4 v8, s[12:15], s4 offen sc1 lds
    s_add_u32 m0, s69, 4096
    s_add_u32 s4, s67, 86016
    buffer_load_dwordx4 v8, s[12:15], s4 offen sc1 lds
    s_add_u32 m0, s69, 40960
    s_add_u32 s4, s67, 122880
    buffer_load_dwordx4 v8, s[12:15], s4 offen sc1 lds
    s_waitcnt lgkmcnt(0)
    s_barrier
    v_mfma_f32_16x16x32_bf16 v[20:23], v[80:83], v[152:155], v[20:23]
    ds_read_b128 v[60:63], v16 offset:0
    v_mfma_f32_16x16x32_bf16 v[40:43], v[80:83], v[156:159], v[40:43]
    ds_read_b128 v[64:67], v16 offset:1024
    v_mfma_f32_16x16x32_bf16 v[24:27], v[84:87], v[152:155], v[24:27]
    ds_read_b128 v[68:71], v16 offset:2048
    v_mfma_f32_16x16x32_bf16 v[44:47], v[84:87], v[156:159], v[44:47]
    ds_read_b128 v[72:75], v16 offset:3072
    v_mfma_f32_16x16x32_bf16 v[28:31], v[88:91], v[152:155], v[28:31]
    ds_read_b128 v[76:79], v16 offset:4096
    v_mfma_f32_16x16x32_bf16 v[48:51], v[88:91], v[156:159], v[48:51]
    v_mfma_f32_16x16x32_bf16 v[32:35], v[92:95], v[152:155], v[32:35]
    v_mfma_f32_16x16x32_bf16 v[52:55], v[92:95], v[156:159], v[52:55]
    v_mfma_f32_16x16x32_bf16 v[36:39], v[96:99], v[152:155], v[36:39]
    v_mfma_f32_16x16x32_bf16 v[56:59], v[96:99], v[156:159], v[56:59]
    s_waitcnt vmcnt(28)
    s_waitcnt lgkmcnt(4)
    v_mfma_f32_16x16x32_bf16 v[20:23], v[60:63], v[160:163], v[20:23]
    ds_read_b128 v[80:83], v16 offset:20480
    v_mfma_f32_16x16x32_bf16 v[40:43], v[60:63], v[164:167], v[40:43]
    ds_read_b128 v[84:87], v16 offset:21504
    s_waitcnt lgkmcnt(5)
    v_mfma_f32_16x16x32_bf16 v[24:27], v[64:67], v[160:163], v[24:27]
    ds_read_b128 v[88:91], v16 offset:22528
    v_mfma_f32_16x16x32_bf16 v[44:47], v[64:67], v[164:167], v[44:47]
    ds_read_b128 v[92:95], v16 offset:23552
    s_waitcnt lgkmcnt(6)
    v_mfma_f32_16x16x32_bf16 v[28:31], v[68:71], v[160:163], v[28:31]
    ds_read_b128 v[96:99], v16 offset:24576
    v_mfma_f32_16x16x32_bf16 v[48:51], v[68:71], v[164:167], v[48:51]
    s_waitcnt lgkmcnt(6)
    v_mfma_f32_16x16x32_bf16 v[32:35], v[72:75], v[160:163], v[32:35]
    v_mfma_f32_16x16x32_bf16 v[52:55], v[72:75], v[164:167], v[52:55]
    s_waitcnt lgkmcnt(5)
    v_mfma_f32_16x16x32_bf16 v[36:39], v[76:79], v[160:163], v[36:39]
    v_mfma_f32_16x16x32_bf16 v[56:59], v[76:79], v[164:167], v[56:59]
    s_add_u32 m0, s69, 41984
    s_add_u32 s4, s67, 123904
    buffer_load_dwordx4 v8, s[12:15], s4 offen sc1 lds
    s_add_u32 m0, s69, 43008
    s_add_u32 s4, s67, 124928
    buffer_load_dwordx4 v8, s[12:15], s4 offen sc1 lds
    s_add_u32 m0, s69, 44032
    s_add_u32 s4, s67, 125952
    buffer_load_dwordx4 v8, s[12:15], s4 offen sc1 lds
    s_add_u32 m0, s69, 45056
    s_add_u32 s4, s67, 126976
    buffer_load_dwordx4 v8, s[12:15], s4 offen sc1 lds
    s_add_u32 m0, s69, 81920
    s_add_u32 s4, s67, 163840
    buffer_load_dwordx4 v8, s[12:15], s4 offen sc1 lds
    s_add_u32 m0, s69, 82944
    s_add_u32 s4, s67, 164864
    buffer_load_dwordx4 v8, s[12:15], s4 offen sc1 lds
    s_waitcnt vmcnt(7)
    s_waitcnt lgkmcnt(0)
    s_barrier
    s_cmp_lg_u32 s22, 0
    s_cbranch_scc1 pub_94
    s_lshl_b32 s4, s20, 4
    s_add_u32 s4, s4, s21
    s_lshl_b32 s4, s4, 7
    s_add_u32 s4, s4, 0xe8000
    v_mov_b32 v2, s29
    s_mov_b64 exec, 1
    buffer_store_dword v2, off, s[72:75], s4 sc1
    s_mov_b64 exec, -1
pub_94:
    v_mfma_f32_16x16x32_bf16 v[20:23], v[80:83], v[168:171], v[20:23]
    ds_read_b128 v[60:63], v13 offset:0
    v_mfma_f32_16x16x32_bf16 v[40:43], v[80:83], v[172:175], v[40:43]
    ds_read_b128 v[64:67], v13 offset:1024
    v_mfma_f32_16x16x32_bf16 v[24:27], v[84:87], v[168:171], v[24:27]
    ds_read_b128 v[68:71], v13 offset:2048
    v_mfma_f32_16x16x32_bf16 v[44:47], v[84:87], v[172:175], v[44:47]
    ds_read_b128 v[72:75], v13 offset:3072
    v_mfma_f32_16x16x32_bf16 v[28:31], v[88:91], v[168:171], v[28:31]
    ds_read_b128 v[76:79], v13 offset:4096
    v_mfma_f32_16x16x32_bf16 v[48:51], v[88:91], v[172:175], v[48:51]
    v_mfma_f32_16x16x32_bf16 v[32:35], v[92:95], v[168:171], v[32:35]
    v_mfma_f32_16x16x32_bf16 v[52:55], v[92:95], v[172:175], v[52:55]
    v_mfma_f32_16x16x32_bf16 v[36:39], v[96:99], v[168:171], v[36:39]
    v_mfma_f32_16x16x32_bf16 v[56:59], v[96:99], v[172:175], v[56:59]
    s_waitcnt lgkmcnt(4)
    v_mfma_f32_16x16x32_bf16 v[20:23], v[60:63], v[176:179], v[20:23]
    ds_read_b128 v[80:83], v13 offset:20480
    v_mfma_f32_16x16x32_bf16 v[40:43], v[60:63], v[180:183], v[40:43]
    ds_read_b128 v[84:87], v13 offset:21504
    s_waitcnt lgkmcnt(5)
    v_mfma_f32_16x16x32_bf16 v[24:27], v[64:67], v[176:179], v[24:27]
    ds_read_b128 v[88:91], v13 offset:22528
    v_mfma_f32_16x16x32_bf16 v[44:47], v[64:67], v[180:183], v[44:47]
    ds_read_b128 v[92:95], v13 offset:23552
    s_waitcnt lgkmcnt(6)
    v_mfma_f32_16x16x32_bf16 v[28:31], v[68:71], v[176:179], v[28:31]
    ds_read_b128 v[96:99], v13 offset:24576
    v_mfma_f32_16x16x32_bf16 v[48:51], v[68:71], v[180:183], v[48:51]
    s_waitcnt lgkmcnt(6)
    v_mfma_f32_16x16x32_bf16 v[32:35], v[72:75], v[176:179], v[32:35]
    v_mfma_f32_16x16x32_bf16 v[52:55], v[72:75], v[180:183], v[52:55]
    s_waitcnt lgkmcnt(5)
    v_mfma_f32_16x16x32_bf16 v[36:39], v[76:79], v[176:179], v[36:39]
    v_mfma_f32_16x16x32_bf16 v[56:59], v[76:79], v[180:183], v[56:59]
    s_add_u32 m0, s69, 83968
    s_add_u32 s4, s67, 165888
    buffer_load_dwordx4 v8, s[12:15], s4 offen sc1 lds
    s_add_u32 m0, s69, 84992
    s_add_u32 s4, s67, 166912
    buffer_load_dwordx4 v8, s[12:15], s4 offen sc1 lds
    s_add_u32 m0, s69, 86016
    s_add_u32 s4, s67, 167936
    buffer_load_dwordx4 v8, s[12:15], s4 offen sc1 lds
    s_add_u32 m0, s69, 122880
    s_add_u32 s4, s67, 204800
    buffer_load_dwordx4 v8, s[12:15], s4 offen sc1 lds
    s_add_u32 m0, s69, 123904
    s_add_u32 s4, s67, 205824
    buffer_load_dwordx4 v8, s[12:15], s4 offen sc1 lds
    s_add_u32 m0, s69, 124928
    s_add_u32 s4, s67, 206848
    buffer_load_dwordx4 v8, s[12:15], s4 offen sc1 lds
    s_waitcnt vmcnt(8)
    s_waitcnt lgkmcnt(0)
    s_barrier
    buffer_load_dword v12, v11, s[72:75], 0 offen sc1
    v_mfma_f32_16x16x32_bf16 v[20:23], v[80:83], v[184:187], v[20:23]
    ds_read_b128 v[60:63], v14 offset:0
    v_mfma_f32_16x16x32_bf16 v[40:43], v[80:83], v[188:191], v[40:43]
    ds_read_b128 v[64:67], v14 offset:1024
    v_mfma_f32_16x16x32_bf16 v[24:27], v[84:87], v[184:187], v[24:27]
    ds_read_b128 v[68:71], v14 offset:2048
    v_mfma_f32_16x16x32_bf16 v[44:47], v[84:87], v[188:191], v[44:47]
    ds_read_b128 v[72:75], v14 offset:3072
    v_mfma_f32_16x16x32_bf16 v[28:31], v[88:91], v[184:187], v[28:31]
    ds_read_b128 v[76:79], v14 offset:4096
    v_mfma_f32_16x16x32_bf16 v[48:51], v[88:91], v[188:191], v[48:51]
    v_mfma_f32_16x16x32_bf16 v[32:35], v[92:95], v[184:187], v[32:35]
    v_mfma_f32_16x16x32_bf16 v[52:55], v[92:95], v[188:191], v[52:55]
    v_mfma_f32_16x16x32_bf16 v[36:39], v[96:99], v[184:187], v[36:39]
    v_mfma_f32_16x16x32_bf16 v[56:59], v[96:99], v[188:191], v[56:59]
    s_waitcnt lgkmcnt(4)
    v_mfma_f32_16x16x32_bf16 v[20:23], v[60:63], v[192:195], v[20:23]
    ds_read_b128 v[80:83], v14 offset:20480
    v_mfma_f32_16x16x32_bf16 v[40:43], v[60:63], v[196:199], v[40:43]
    ds_read_b128 v[84:87], v14 offset:21504
    s_waitcnt lgkmcnt(5)
    v_mfma_f32_16x16x32_bf16 v[24:27], v[64:67], v[192:195], v[24:27]
    ds_read_b128 v[88:91], v14 offset:22528
    v_mfma_f32_16x16x32_bf16 v[44:47], v[64:67], v[196:199], v[44:47]
    ds_read_b128 v[92:95], v14 offset:23552
    s_waitcnt lgkmcnt(6)
    v_mfma_f32_16x16x32_bf16 v[28:31], v[68:71], v[192:195], v[28:31]
    ds_read_b128 v[96:99], v14 offset:24576
    v_mfma_f32_16x16x32_bf16 v[48:51], v[68:71], v[196:199], v[48:51]
    s_waitcnt lgkmcnt(6)
    v_mfma_f32_16x16x32_bf16 v[32:35], v[72:75], v[192:195], v[32:35]
    v_mfma_f32_16x16x32_bf16 v[52:55], v[72:75], v[196:199], v[52:55]
    s_waitcnt lgkmcnt(5)
    v_mfma_f32_16x16x32_bf16 v[36:39], v[76:79], v[192:195], v[36:39]
    v_mfma_f32_16x16x32_bf16 v[56:59], v[76:79], v[196:199], v[56:59]
    s_add_u32 m0, s69, 125952
    s_add_u32 s4, s67, 207872
    buffer_load_dwordx4 v8, s[12:15], s4 offen sc1 lds
    s_add_u32 m0, s69, 126976
    s_add_u32 s4, s67, 208896
    buffer_load_dwordx4 v8, s[12:15], s4 offen sc1 lds
    s_add_u32 m0, s69, 0
    s_add_u32 s4, s67, 245760
    buffer_load_dwordx4 v8, s[12:15], s4 offen sc1 lds
    s_add_u32 m0, s69, 1024
    s_add_u32 s4, s67, 246784
    buffer_load_dwordx4 v8, s[12:15], s4 offen sc1 lds
    s_add_u32 m0, s69, 2048
    s_add_u32 s4, s67, 247808
    buffer_load_dwordx4 v8, s[12:15], s4 offen sc1 lds
    s_add_u32 m0, s69, 3072
    s_add_u32 s4, s67, 248832
    buffer_load_dwordx4 v8, s[12:15], s4 offen sc1 lds
    s_waitcnt vmcnt(6)
    s_waitcnt lgkmcnt(0)
    v_cmp_ne_u32 vcc, s29, v12
    s_nop 0
    s_cbranch_vccz poll_95_ok
    s_mov_b32 s31, 20000
poll_95:
    s_sleep 1
    buffer_load_dword v12, v11, s[72:75], 0 offen sc1
    s_waitcnt vmcnt(0)
    v_cmp_ne_u32 vcc, s29, v12
    s_nop 0
    s_cbranch_vccz poll_95_ok
    s_sub_u32 s31, s31, 1
    s_cmp_lg_u32 s31, 0
    s_cbranch_scc1 poll_95
poll_95_ok:
    s_barrier
    v_mfma_f32_16x16x32_bf16 v[20:23], v[80:83], v[200:203], v[20:23]
    ds_read_b128 v[60:63], v15 offset:0
    v_mfma_f32_16x16x32_bf16 v[40:43], v[80:83], v[204:207], v[40:43]
    ds_read_b128 v[64:67], v15 offset:1024
    v_mfma_f32_16x16x32_bf16 v[24:27], v[84:87], v[200:203], v[24:27]
    ds_read_b128 v[68:71], v15 offset:2048
    v_mfma_f32_16x16x32_bf16 v[44:47], v[84:87], v[204:207], v[44:47]
    ds_read_b128 v[72:75], v15 offset:3072
    v_mfma_f32_16x16x32_bf16 v[28:31], v[88:91], v[200:203], v[28:31]
    ds_read_b128 v[76:79], v15 offset:4096
    v_mfma_f32_16x16x32_bf16 v[48:51], v[88:91], v[204:207], v[48:51]
    v_mfma_f32_16x16x32_bf16 v[32:35], v[92:95], v[200:203], v[32:35]
    v_mfma_f32_16x16x32_bf16 v[52:55], v[92:95], v[204:207], v[52:55]
    v_mfma_f32_16x16x32_bf16 v[36:39], v[96:99], v[200:203], v[36:39]
    v_mfma_f32_16x16x32_bf16 v[56:59], v[96:99], v[204:207], v[56:59]
    s_waitcnt lgkmcnt(4)
    v_mfma_f32_16x16x32_bf16 v[20:23], v[60:63], v[208:211], v[20:23]
    ds_read_b128 v[80:83], v15 offset:20480
    v_mfma_f32_16x16x32_bf16 v[40:43], v[60:63], v[212:215], v[40:43]
    ds_read_b128 v[84:87], v15 offset:21504
    s_waitcnt lgkmcnt(5)
    v_mfma_f32_16x16x32_bf16 v[24:27], v[64:67], v[208:211], v[24:27]
    ds_read_b128 v[88:91], v15 offset:22528
    v_mfma_f32_16x16x32_bf16 v[44:47], v[64:67], v[212:215], v[44:47]
    ds_read_b128 v[92:95], v15 offset:23552
    s_waitcnt lgkmcnt(6)
    v_mfma_f32_16x16x32_bf16 v[28:31], v[68:71], v[208:211], v[28:31]
    ds_read_b128 v[96:99], v15 offset:24576
    v_mfma_f32_16x16x32_bf16 v[48:51], v[68:71], v[212:215], v[48:51]
    s_waitcnt lgkmcnt(6)
    v_mfma_f32_16x16x32_bf16 v[32:35], v[72:75], v[208:211], v[32:35]
    v_mfma_f32_16x16x32_bf16 v[52:55], v[72:75], v[212:215], v[52:55]
    s_waitcnt lgkmcnt(5)
    v_mfma_f32_16x16x32_bf16 v[36:39], v[76:79], v[208:211], v[36:39]
    v_mfma_f32_16x16x32_bf16 v[56:59], v[76:79], v[212:215], v[56:59]
    s_add_u32 m0, s69, 4096
    s_add_u32 s4, s67, 249856
    buffer_load_dwordx4 v8, s[12:15], s4 offen sc1 lds
    s_add_u32 s5, s68, 53248
    buffer_load_dwordx4 v[248:251], v9, s[8:11], s5 offen sc1
    s_add_u32 s5, s68, 53248
    buffer_load_dwordx4 v[252:255], v10, s[8:11], s5 offen sc1
    s_add_u32 s5, s68, 57344
    buffer_load_dwordx4 v[100:103], v9, s[8:11], s5 offen sc1
    s_add_u32 s5, s68, 57344
    buffer_load_dwordx4 v[104:107], v10, s[8:11], s5 offen sc1
    s_add_u32 m0, s69, 40960
    s_add_u32 s4, s67, 286720
    buffer_load_dwordx4 v8, s[12:15], s4 offen sc1 lds
    s_waitcnt vmcnt(10)
    s_waitcnt lgkmcnt(0)
    s_barrier
    v_mfma_f32_16x16x32_bf16 v[20:23], v[80:83], v[216:219], v[20:23]
    ds_read_b128 v[60:63], v16 offset:0
    v_mfma_f32_16x16x32_bf16 v[40:43], v[80:83], v[220:223], v[40:43]
    ds_read_b128 v[64:67], v16 offset:1024
    v_mfma_f32_16x16x32_bf16 v[24:27], v[84:87], v[216:219], v[24:27]
    ds_read_b128 v[68:71], v16 offset:2048
    v_mfma_f32_16x16x32_bf16 v[44:47], v[84:87], v[220:223], v[44:47]
    ds_read_b128 v[72:75], v16 offset:3072
    v_mfma_f32_16x16x32_bf16 v[28:31], v[88:91], v[216:219], v[28:31]
    ds_read_b128 v[76:79], v16 offset:4096
    v_mfma_f32_16x16x32_bf16 v[48:51], v[88:91], v[220:223], v[48:51]
    v_mfma_f32_16x16x32_bf16 v[32:35], v[92:95], v[216:219], v[32:35]
    v_mfma_f32_16x16x32_bf16 v[52:55], v[92:95], v[220:223], v[52:55]
    v_mfma_f32_16x16x32_bf16 v[36:39], v[96:99], v[216:219], v[36:39]
    v_mfma_f32_16x16x32_bf16 v[56:59], v[96:99], v[220:223], v[56:59]
    s_waitcnt lgkmcnt(4)
    v_mfma_f32_16x16x32_bf16 v[20:23], v[60:63], v[224:227], v[20:23]
    ds_read_b128 v[80:83], v16 offset:20480
    v_mfma_f32_16x16x32_bf16 v[40:43], v[60:63], v[228:231], v[40:43]
    ds_read_b128 v[84:87], v16 offset:21504
    s_waitcnt lgkmcnt(5)
    v_mfma_f32_16x16x32_bf16 v[24:27], v[64:67], v[224:227], v[24:27]
    ds_read_b128 v[88:91], v16 offset:22528
    v_mfma_f32_16x16x32_bf16 v[44:47], v[64:67], v[228:231], v[44:47]
    ds_read_b128 v[92:95], v16 offset:23552
    s_waitcnt lgkmcnt(6)
    v_mfma_f32_16x16x32_bf16 v[28:31], v[68:71], v[224:227], v[28:31]
    ds_read_b128 v[96:99], v16 offset:24576
    v_mfma_f32_16x16x32_bf16 v[48:51], v[68:71], v[228:231], v[48:51]
    s_waitcnt lgkmcnt(6)
    v_mfma_f32_16x16x32_bf16 v[32:35], v[72:75], v[224:227], v[32:35]
    v_mfma_f32_16x16x32_bf16 v[52:55], v[72:75], v[228:231], v[52:55]
    s_waitcnt lgkmcnt(5)
    v_mfma_f32_16x16x32_bf16 v[36:39], v[76:79], v[224:227], v[36:39]
    v_mfma_f32_16x16x32_bf16 v[56:59], v[76:79], v[228:231], v[56:59]
    s_add_u32 m0, s69, 41984
    s_add_u32 s4, s67, 287744
    buffer_load_dwordx4 v8, s[12:15], s4 offen sc1 lds
    s_add_u32 m0, s69, 43008
    s_add_u32 s4, s67, 288768
    buffer_load_dwordx4 v8, s[12:15], s4 offen sc1 lds
    s_add_u32 m0, s69, 44032
    s_add_u32 s4, s67, 289792
    buffer_load_dwordx4 v8, s[12:15], s4 offen sc1 lds
    s_add_u32 m0, s69, 45056
    s_add_u32 s4, s67, 290816
    buffer_load_dwordx4 v8, s[12:15], s4 offen sc1 lds
    s_add_u32 s5, s68, 61440
    buffer_load_dwordx4 v[108:111], v9, s[8:11], s5 offen sc1
    s_add_u32 s5, s68, 61440
    buffer_load_dwordx4 v[112:115], v10, s[8:11], s5 offen sc1
    s_waitcnt vmcnt(11)
    s_waitcnt lgkmcnt(0)
    s_barrier
    v_mfma_f32_16x16x32_bf16 v[20:23], v[80:83], v[232:235], v[20:23]
    ds_read_b128 v[60:63], v13 offset:0
    v_mfma_f32_16x16x32_bf16 v[40:43], v[80:83], v[236:239], v[40:43]
    ds_read_b128 v[64:67], v13 offset:1024
    v_mfma_f32_16x16x32_bf16 v[24:27], v[84:87], v[232:235], v[24:27]
    ds_read_b128 v[68:71], v13 offset:2048
    v_mfma_f32_16x16x32_bf16 v[44:47], v[84:87], v[236:239], v[44:47]
    ds_read_b128 v[72:75], v13 offset:3072
    v_mfma_f32_16x16x32_bf16 v[28:31], v[88:91], v[232:235], v[28:31]
    ds_read_b128 v[76:79], v13 offset:4096
    v_mfma_f32_16x16x32_bf16 v[48:51], v[88:91], v[236:239], v[48:51]
    v_mfma_f32_16x16x32_bf16 v[32:35], v[92:95], v[232:235], v[32:35]
    v_mfma_f32_16x16x32_bf16 v[52:55], v[92:95], v[236:239], v[52:55]
    v_mfma_f32_16x16x32_bf16 v[36:39], v[96:99], v[232:235], v[36:39]
    v_mfma_f32_16x16x32_bf16 v[56:59], v[96:99], v[236:239], v[56:59]
    s_waitcnt lgkmcnt(4)
    v_mfma_f32_16x16x32_bf16 v[20:23], v[60:63], v[240:243], v[20:23]
    ds_read_b128 v[80:83], v13 offset:20480
    v_mfma_f32_16x16x32_bf16 v[40:43], v[60:63], v[244:247], v[40:43]
    ds_read_b128 v[84:87], v13 offset:21504
    s_waitcnt lgkmcnt(5)
    v_mfma_f32_16x16x32_bf16 v[24:27], v[64:67], v[240:243], v[24:27]
    ds_read_b128 v[88:91], v13 offset:22528
    v_mfma_f32_16x16x32_bf16 v[44:47], v[64:67], v[244:247], v[44:47]
    ds_read_b128 v[92:95], v13 offset:23552
    s_waitcnt lgkmcnt(6)
    v_mfma_f32_16x16x32_bf16 v[28:31], v[68:71], v[240:243], v[28:31]
    ds_read_b128 v[96:99], v13 offset:24576
    v_mfma_f32_16x16x32_bf16 v[48:51], v[68:71], v[244:247], v[48:51]
    s_waitcnt lgkmcnt(6)
    v_mfma_f32_16x16x32_bf16 v[32:35], v[72:75], v[240:243], v[32:35]
    v_mfma_f32_16x16x32_bf16 v[52:55], v[72:75], v[244:247], v[52:55]
    s_waitcnt lgkmcnt(5)
    v_mfma_f32_16x16x32_bf16 v[36:39], v[76:79], v[240:243], v[36:39]
    v_mfma_f32_16x16x32_bf16 v[56:59], v[76:79], v[244:247], v[56:59]
    s_add_u32 s5, s68, 65536
    buffer_load_dwordx4 v[116:119], v9, s[8:11], s5 offen sc1
    s_add_u32 s5, s68, 65536
    buffer_load_dwordx4 v[120:123], v10, s[8:11], s5 offen sc1
    s_add_u32 m0, s69, 81920
    s_add_u32 s4, s67, 327680
    buffer_load_dwordx4 v8, s[12:15], s4 offen sc1 lds
    s_add_u32 m0, s69, 82944
    s_add_u32 s4, s67, 328704
    buffer_load_dwordx4 v8, s[12:15], s4 offen sc1 lds
    s_add_u32 m0, s69, 83968
    s_add_u32 s4, s67, 329728
    buffer_load_dwordx4 v8, s[12:15], s4 offen sc1 lds
    s_add_u32 m0, s69, 84992
    s_add_u32 s4, s67, 330752
    buffer_load_dwordx4 v8, s[12:15], s4 offen sc1 lds
    s_add_u32 m0, s69, 86016
    s_add_u32 s4, s67, 331776
    buffer_load_dwordx4 v8, s[12:15], s4 offen sc1 lds
    s_waitcnt vmcnt(9)
    s_waitcnt lgkmcnt(0)
    s_barrier
    v_mfma_f32_16x16x32_bf16 v[20:23], v[80:83], v[248:251], v[20:23]
    ds_read_b128 v[60:63], v14 offset:0
    v_mfma_f32_16x16x32_bf16 v[40:43], v[80:83], v[252:255], v[40:43]
    ds_read_b128 v[64:67], v14 offset:1024
    v_mfma_f32_16x16x32_bf16 v[24:27], v[84:87], v[248:251], v[24:27]
    ds_read_b128 v[68:71], v14 offset:2048
    v_mfma_f32_16x16x32_bf16 v[44:47], v[84:87], v[252:255], v[44:47]
    ds_read_b128 v[72:75], v14 offset:3072
    v_mfma_f32_16x16x32_bf16 v[28:31], v[88:91], v[248:251], v[28:31]
    ds_read_b128 v[76:79], v14 offset:4096
    v_mfma_f32_16x16x32_bf16 v[48:51], v[88:91], v[252:255], v[48:51]
    v_mfma_f32_16x16x32_bf16 v[32:35], v[92:95], v[248:251], v[32:35]
    v_mfma_f32_16x16x32_bf16 v[52:55], v[92:95], v[252:255], v[52:55]
    v_mfma_f32_16x16x32_bf16 v[36:39], v[96:99], v[248:251], v[36:39]
    v_mfma_f32_16x16x32_bf16 v[56:59], v[96:99], v[252:255], v[56:59]
    s_waitcnt lgkmcnt(4)
    v_mfma_f32_16x16x32_bf16 v[20:23], v[60:63], v[100:103], v[20:23]
    ds_read_b128 v[80:83], v14 offset:20480
    v_mfma_f32_16x16x32_bf16 v[40:43], v[60:63], v[104:107], v[40:43]
    ds_read_b128 v[84:87], v14 offset:21504
    s_waitcnt lgkmcnt(5)
    v_mfma_f32_16x16x32_bf16 v[24:27], v[64:67], v[100:103], v[24:27]
    ds_read_b128 v[88:91], v14 offset:22528
    v_mfma_f32_16x16x32_bf16 v[44:47], v[64:67], v[104:107], v[44:47]
    ds_read_b128 v[92:95], v14 offset:23552
    s_waitcnt lgkmcnt(6)
    v_mfma_f32_16x16x32_bf16 v[28:31], v[68:71], v[100:103], v[28:31]
    ds_read_b128 v[96:99], v14 offset:24576
    v_mfma_f32_16x16x32_bf16 v[48:51], v[68:71], v[104:107], v[48:51]
    s_waitcnt lgkmcnt(6)
    v_mfma_f32_16x16x32_bf16 v[32:35], v[72:75], v[100:103], v[32:35]
    v_mfma_f32_16x16x32_bf16 v[52:55], v[72:75], v[104:107], v[52:55]
    s_waitcnt lgkmcnt(5)
    v_mfma_f32_16x16x32_bf16 v[36:39], v[76:79], v[100:103], v[36:39]
    v_mfma_f32_16x16x32_bf16 v[56:59], v[76:79], v[104:107], v[56:59]
    s_add_u32 s5, s68, 69632
    buffer_load_dwordx4 v[124:127], v9, s[8:11], s5 offen sc1
    s_add_u32 s5, s68, 69632
    buffer_load_dwordx4 v[128:131], v10, s[8:11], s5 offen sc1
    s_waitcnt vmcnt(2)
    s_waitcnt lgkmcnt(0)
    s_barrier
    v_mfma_f32_16x16x32_bf16 v[20:23], v[80:83], v[108:111], v[20:23]
    ds_read_b128 v[60:63], v15 offset:0
    v_mfma_f32_16x16x32_bf16 v[40:43], v[80:83], v[112:115], v[40:43]
    ds_read_b128 v[64:67], v15 offset:1024
    v_mfma_f32_16x16x32_bf16 v[24:27], v[84:87], v[108:111], v[24:27]
    ds_read_b128 v[68:71], v15 offset:2048
    v_mfma_f32_16x16x32_bf16 v[44:47], v[84:87], v[112:115], v[44:47]
    ds_read_b128 v[72:75], v15 offset:3072
    v_mfma_f32_16x16x32_bf16 v[28:31], v[88:91], v[108:111], v[28:31]
    ds_read_b128 v[76:79], v15 offset:4096
    v_mfma_f32_16x16x32_bf16 v[48:51], v[88:91], v[112:115], v[48:51]
    v_mfma_f32_16x16x32_bf16 v[32:35], v[92:95], v[108:111], v[32:35]
    v_mfma_f32_16x16x32_bf16 v[52:55], v[92:95], v[112:115], v[52:55]
    v_mfma_f32_16x16x32_bf16 v[36:39], v[96:99], v[108:111], v[36:39]
    v_mfma_f32_16x16x32_bf16 v[56:59], v[96:99], v[112:115], v[56:59]
    s_waitcnt lgkmcnt(4)
    v_mfma_f32_16x16x32_bf16 v[20:23], v[60:63], v[116:119], v[20:23]
    ds_read_b128 v[80:83], v15 offset:20480
    v_mfma_f32_16x16x32_bf16 v[40:43], v[60:63], v[120:123], v[40:43]
    ds_read_b128 v[84:87], v15 offset:21504
    s_waitcnt lgkmcnt(5)
    v_mfma_f32_16x16x32_bf16 v[24:27], v[64:67], v[116:119], v[24:27]
    ds_read_b128 v[88:91], v15 offset:22528
    v_mfma_f32_16x16x32_bf16 v[44:47], v[64:67], v[120:123], v[44:47]
    ds_read_b128 v[92:95], v15 offset:23552
    s_waitcnt lgkmcnt(6)
    v_mfma_f32_16x16x32_bf16 v[28:31], v[68:71], v[116:119], v[28:31]
    ds_read_b128 v[96:99], v15 offset:24576
    v_mfma_f32_16x16x32_bf16 v[48:51], v[68:71], v[120:123], v[48:51]
    s_waitcnt lgkmcnt(6)
    v_mfma_f32_16x16x32_bf16 v[32:35], v[72:75], v[116:119], v[32:35]
    v_mfma_f32_16x16x32_bf16 v[52:55], v[72:75], v[120:123], v[52:55]
    s_waitcnt lgkmcnt(5)
    v_mfma_f32_16x16x32_bf16 v[36:39], v[76:79], v[116:119], v[36:39]
    v_mfma_f32_16x16x32_bf16 v[56:59], v[76:79], v[120:123], v[56:59]
    s_waitcnt lgkmcnt(0)
    s_barrier
    s_waitcnt vmcnt(0)
    v_mfma_f32_16x16x32_bf16 v[20:23], v[80:83], v[124:127], v[20:23]
    v_mfma_f32_16x16x32_bf16 v[40:43], v[80:83], v[128:131], v[40:43]
    v_mfma_f32_16x16x32_bf16 v[24:27], v[84:87], v[124:127], v[24:27]
    v_mfma_f32_16x16x32_bf16 v[44:47], v[84:87], v[128:131], v[44:47]
    v_mfma_f32_16x16x32_bf16 v[28:31], v[88:91], v[124:127], v[28:31]
    v_mfma_f32_16x16x32_bf16 v[48:51], v[88:91], v[128:131], v[48:51]
    v_mfma_f32_16x16x32_bf16 v[32:35], v[92:95], v[124:127], v[32:35]
    v_mfma_f32_16x16x32_bf16 v[52:55], v[92:95], v[128:131], v[52:55]
    v_mfma_f32_16x16x32_bf16 v[36:39], v[96:99], v[124:127], v[36:39]
    v_mfma_f32_16x16x32_bf16 v[56:59], v[96:99], v[128:131], v[56:59]
    s_and_b32 s4, s70, 1
    s_lshl_b32 s5, s71, 1
    s_xor_b32 s6, s4, 0
    s_sub_u32 s7, s70, s6
    s_sub_u32 s7, s7, 1
    s_and_b32 s7, s7, 3
    s_add_u32 s6, s6, s5
    s_mul_i32 s6, s6, 3
    s_add_u32 s6, s6, s7
    s_mul_i32 s6, s6, 5120
    v_add_u32 v18, s6, v8
    ds_write_b128 v18, v[20:23] offset:0
    ds_write_b128 v18, v[24:27] offset:1024
    ds_write_b128 v18, v[28:31] offset:2048
    ds_write_b128 v18, v[32:35] offset:3072
    ds_write_b128 v18, v[36:39] offset:4096
    s_xor_b32 s6, s4, 1
    s_sub_u32 s7, s70, s6
    s_sub_u32 s7, s7, 1
    s_and_b32 s7, s7, 3
    s_add_u32 s6, s6, s5
    s_mul_i32 s6, s6, 3
    s_add_u32 s6, s6, s7
    s_mul_i32 s6, s6, 5120
    v_add_u32 v18, s6, v8
    ds_write_b128 v18, v[40:43] offset:0
    ds_write_b128 v18, v[44:47] offset:1024
    ds_write_b128 v18, v[48:51] offset:2048
    ds_write_b128 v18, v[52:55] offset:3072
    ds_write_b128 v18, v[56:59] offset:4096
    s_waitcnt lgkmcnt(0)
    s_barrier
    s_endpgm
p2h_77:
    s_nop 7
    v_mov_b32 v17, 0xf149f2ca
    v_mov_b32 v76, 0xf149f2ca
    v_mov_b32 v77, 0xf149f2ca
    v_mov_b32 v78, 0xf149f2ca
    v_mov_b32 v79, 0xf149f2ca
    v_mov_b32 v80, 0xf149f2ca
    v_mov_b32 v81, 0xf149f2ca
    v_mov_b32 v82, 0xf149f2ca
    v_mov_b32 v83, 0xf149f2ca
    v_mov_b32 v84, 0xf149f2ca
    v_mov_b32 v85, 0xf149f2ca
    v_mov_b32 v86, 0xf149f2ca
    v_mov_b32 v87, 0xf149f2ca
    v_mov_b32 v88, 0xf149f2ca
    v_mov_b32 v89, 0xf149f2ca
    v_mov_b32 v90, 0xf149f2ca
    v_mov_b32 v91, 0xf149f2ca
    s_nop 1
    s_branch p2h_77_b
p2h_78:
    s_nop 7
    v_mov_b32 v17, 0xf149f2ca
    v_mov_b32 v76, 0xf149f2ca
    v_mov_b32 v77, 0xf149f2ca
    v_mov_b32 v78, 0xf149f2ca
    v_mov_b32 v79, 0xf149f2ca
    v_mov_b32 v80, 0xf149f2ca
    v_mov_b32 v81, 0xf149f2ca
    v_mov_b32 v82, 0xf149f2ca
    v_mov_b32 v83, 0xf149f2ca
    v_mov_b32 v84, 0xf149f2ca
    v_mov_b32 v85, 0xf149f2ca
    v_mov_b32 v86, 0xf149f2ca
    v_mov_b32 v87, 0xf149f2ca
    v_mov_b32 v88, 0xf149f2ca
    v_mov_b32 v89, 0xf149f2ca
    v_mov_b32 v90, 0xf149f2ca
    v_mov_b32 v91, 0xf149f2ca
    s_nop 1
    s_branch p2h_78_b
p2h_79:
    s_nop 7
    v_mov_b32 v17, 0xf149f2ca
    v_mov_b32 v76, 0xf149f2ca
    v_mov_b32 v77, 0xf149f2ca
    v_mov_b32 v78, 0xf149f2ca
    v_mov_b32 v79, 0xf149f2ca
    v_mov_b32 v80, 0xf149f2ca
    v_mov_b32 v81, 0xf149f2ca
    v_mov_b32 v82, 0xf149f2ca
    v_mov_b32 v83, 0xf149f2ca
    v_mov_b32 v84, 0xf149f2ca
    v_mov_b32 v85, 0xf149f2ca
    v_mov_b32 v86, 0xf149f2ca
    v_mov_b32 v87, 0xf149f2ca
    v_mov_b32 v88, 0xf149f2ca
    v_mov_b32 v89, 0xf149f2ca
    v_mov_b32 v90, 0xf149f2ca
    v_mov_b32 v91, 0xf149f2ca
    s_nop 1
    s_branch p2h_79_b
p2h_80:
    s_nop 7
    v_mov_b32 v17, 0xf149f2ca
    v_mov_b32 v76, 0xf149f2ca
    v_mov_b32 v77, 0xf149f2ca
    v_mov_b32 v78, 0xf149f2ca
    v_mov_b32 v79, 0xf149f2ca
    v_mov_b32 v80, 0xf149f2ca
    v_mov_b32 v81, 0xf149f2ca
    v_mov_b32 v82, 0xf149f2ca
    v_mov_b32 v83, 0xf149f2ca
    v_mov_b32 v84, 0xf149f2ca
    v_mov_b32 v85, 0xf149f2ca
    v_mov_b32 v86, 0xf149f2ca
    v_mov_b32 v87, 0xf149f2ca
    v_mov_b32 v88, 0xf149f2ca
    v_mov_b32 v89, 0xf149f2ca
    v_mov_b32 v90, 0xf149f2ca
    v_mov_b32 v91, 0xf149f2ca
    s_nop 1
    s_branch p2h_80_b
p2h_81:
    s_nop 7
    v_mov_b32 v17, 0xf149f2ca
    v_mov_b32 v76, 0xf149f2ca
    v_mov_b32 v77, 0xf149f2ca
    v_mov_b32 v78, 0xf149f2ca
    v_mov_b32 v79, 0xf149f2ca
    v_mov_b32 v80, 0xf149f2ca
    v_mov_b32 v81, 0xf149f2ca
    v_mov_b32 v82, 0xf149f2ca
    v_mov_b32 v83, 0xf149f2ca
    v_mov_b32 v84, 0xf149f2ca
    v_mov_b32 v85, 0xf149f2ca
    v_mov_b32 v86, 0xf149f2ca
    v_mov_b32 v87, 0xf149f2ca
    v_mov_b32 v88, 0xf149f2ca
    v_mov_b32 v89, 0xf149f2ca
    v_mov_b32 v90, 0xf149f2ca
    v_mov_b32 v91, 0xf149f2ca
    s_nop 1
    s_branch p2h_81_b
p2h_82:
    s_nop 7
    v_mov_b32 v17, 0xf149f2ca
    v_mov_b32 v76, 0xf149f2ca
    v_mov_b32 v77, 0xf149f2ca
    v_mov_b32 v78, 0xf149f2ca
    v_mov_b32 v79, 0xf149f2ca
    v_mov_b32 v80, 0xf149f2ca
    v_mov_b32 v81, 0xf149f2ca
    v_mov_b32 v82, 0xf149f2ca
    v_mov_b32 v83, 0xf149f2ca
    v_mov_b32 v84, 0xf149f2ca
    v_mov_b32 v85, 0xf149f2ca
    v_mov_b32 v86, 0xf149f2ca
    v_mov_b32 v87, 0xf149f2ca
    v_mov_b32 v88, 0xf149f2ca
    v_mov_b32 v89, 0xf149f2ca
    v_mov_b32 v90, 0xf149f2ca
    v_mov_b32 v91, 0xf149f2ca
    s_nop 1
    s_branch p2h_82_b
p2h_83:
    s_nop 7
    v_mov_b32 v17, 0xf149f2ca
    v_mov_b32 v76, 0xf149f2ca
    v_mov_b32 v77, 0xf149f2ca
    v_mov_b32 v78, 0xf149f2ca
    v_mov_b32 v79, 0xf149f2ca
    v_mov_b32 v80, 0xf149f2ca
    v_mov_b32 v81, 0xf149f2ca
    v_mov_b32 v82, 0xf149f2ca
    v_mov_b32 v83, 0xf149f2ca
    v_mov_b32 v84, 0xf149f2ca
    v_mov_b32 v85, 0xf149f2ca
    v_mov_b32 v86, 0xf149f2ca
    v_mov_b32 v87, 0xf149f2ca
    v_mov_b32 v88, 0xf149f2ca
    v_mov_b32 v89, 0xf149f2ca
    v_mov_b32 v90, 0xf149f2ca
    v_mov_b32 v91, 0xf149f2ca
    s_nop 1
    s_branch p2h_83_b
p2h_84:
    s_nop 7
    v_mov_b32 v17, 0xf149f2ca
    v_mov_b32 v76, 0xf149f2ca
    v_mov_b32 v77, 0xf149f2ca
    v_mov_b32 v78, 0xf149f2ca
    v_mov_b32 v79, 0xf149f2ca
    v_mov_b32 v80, 0xf149f2ca
    v_mov_b32 v81, 0xf149f2ca
    v_mov_b32 v82, 0xf149f2ca
    v_mov_b32 v83, 0xf149f2ca
    v_mov_b32 v84, 0xf149f2ca
    v_mov_b32 v85, 0xf149f2ca
    v_mov_b32 v86, 0xf149f2ca
    v_mov_b32 v87, 0xf149f2ca
    v_mov_b32 v88, 0xf149f2ca
    v_mov_b32 v89, 0xf149f2ca
    v_mov_b32 v90, 0xf149f2ca
    v_mov_b32 v91, 0xf149f2ca
    s_nop 1
    s_branch p2h_84_b
p2h_85:
    s_nop 7
    v_mov_b32 v17, 0xf149f2ca
    v_mov_b32 v76, 0xf149f2ca
    v_mov_b32 v77, 0xf149f2ca
    v_mov_b32 v78, 0xf149f2ca
    v_mov_b32 v79, 0xf149f2ca
    v_mov_b32 v80, 0xf149f2ca
    v_mov_b32 v81, 0xf149f2ca
    v_mov_b32 v82, 0xf149f2ca
    v_mov_b32 v83, 0xf149f2ca
    v_mov_b32 v84, 0xf149f2ca
    v_mov_b32 v85, 0xf149f2ca
    v_mov_b32 v86, 0xf149f2ca
    v_mov_b32 v87, 0xf149f2ca
    v_mov_b32 v88, 0xf149f2ca
    v_mov_b32 v89, 0xf149f2ca
    v_mov_b32 v90, 0xf149f2ca
    v_mov_b32 v91, 0xf149f2ca
    s_nop 1
    s_branch p2h_85_b
p2h_86:
    s_nop 7
    v_mov_b32 v17, 0xf149f2ca
    v_mov_b32 v76, 0xf149f2ca
    v_mov_b32 v77, 0xf149f2ca
    v_mov_b32 v78, 0xf149f2ca
    v_mov_b32 v79, 0xf149f2ca
    v_mov_b32 v80, 0xf149f2ca
    v_mov_b32 v81, 0xf149f2ca
    v_mov_b32 v82, 0xf149f2ca
    v_mov_b32 v83, 0xf149f2ca
    v_mov_b32 v84, 0xf149f2ca
    v_mov_b32 v85, 0xf149f2ca
    v_mov_b32 v86, 0xf149f2ca
    v_mov_b32 v87, 0xf149f2ca
    v_mov_b32 v88, 0xf149f2ca
    v_mov_b32 v89, 0xf149f2ca
    v_mov_b32 v90, 0xf149f2ca
    v_mov_b32 v91, 0xf149f2ca
    s_nop 1
    s_branch p2h_86_b
p2h_87:
    s_nop 7
    v_mov_b32 v17, 0xf149f2ca
    v_mov_b32 v76, 0xf149f2ca
    v_mov_b32 v77, 0xf149f2ca
    v_mov_b32 v78, 0xf149f2ca
    v_mov_b32 v79, 0xf149f2ca
    v_mov_b32 v80, 0xf149f2ca
    v_mov_b32 v81, 0xf149f2ca
    v_mov_b32 v82, 0xf149f2ca
    v_mov_b32 v83, 0xf149f2ca
    v_mov_b32 v84, 0xf149f2ca
    v_mov_b32 v85, 0xf149f2ca
    v_mov_b32 v86, 0xf149f2ca
    v_mov_b32 v87, 0xf149f2ca
    v_mov_b32 v88, 0xf149f2ca
    v_mov_b32 v89, 0xf149f2ca
    v_mov_b32 v90, 0xf149f2ca
    v_mov_b32 v91, 0xf149f2ca
    s_nop 1
    s_branch p2h_87_b
p2h_88:
    s_nop 7
    v_mov_b32 v17, 0xf149f2ca
    v_mov_b32 v76, 0xf149f2ca
    v_mov_b32 v77, 0xf149f2ca
    v_mov_b32 v78, 0xf149f2ca
    v_mov_b32 v79, 0xf149f2ca
    v_mov_b32 v80, 0xf149f2ca
    v_mov_b32 v81, 0xf149f2ca
    v_mov_b32 v82, 0xf149f2ca
    v_mov_b32 v83, 0xf149f2ca
    v_mov_b32 v84, 0xf149f2ca
    v_mov_b32 v85, 0xf149f2ca
    v_mov_b32 v86, 0xf149f2ca
    v_mov_b32 v87, 0xf149f2ca
    v_mov_b32 v88, 0xf149f2ca
    v_mov_b32 v89, 0xf149f2ca
    v_mov_b32 v90, 0xf149f2ca
    v_mov_b32 v91, 0xf149f2ca
    s_nop 1
    s_branch p2h_88_b
p2h_89:
    s_nop 7
    v_mov_b32 v17, 0xf149f2ca
    v_mov_b32 v76, 0xf149f2ca
    v_mov_b32 v77, 0xf149f2ca
    v_mov_b32 v78, 0xf149f2ca
    v_mov_b32 v79, 0xf149f2ca
    v_mov_b32 v80, 0xf149f2ca
    v_mov_b32 v81, 0xf149f2ca
    v_mov_b32 v82, 0xf149f2ca
    v_mov_b32 v83, 0xf149f2ca
    v_mov_b32 v84, 0xf149f2ca
    v_mov_b32 v85, 0xf149f2ca
    v_mov_b32 v86, 0xf149f2ca
    v_mov_b32 v87, 0xf149f2ca
    v_mov_b32 v88, 0xf149f2ca
    v_mov_b32 v89, 0xf149f2ca
    v_mov_b32 v90, 0xf149f2ca
    v_mov_b32 v91, 0xf149f2ca
    s_nop 1
    s_branch p2h_89_b
p2h_90:
    s_nop 7
    v_mov_b32 v17, 0xf149f2ca
    v_mov_b32 v76, 0xf149f2ca
    v_mov_b32 v77, 0xf149f2ca
    v_mov_b32 v78, 0xf149f2ca
    v_mov_b32 v79, 0xf149f2ca
    v_mov_b32 v80, 0xf149f2ca
    v_mov_b32 v81, 0xf149f2ca
    v_mov_b32 v82, 0xf149f2ca
    v_mov_b32 v83, 0xf149f2ca
    v_mov_b32 v84, 0xf149f2ca
    v_mov_b32 v85, 0xf149f2ca
    v_mov_b32 v86, 0xf149f2ca
    v_mov_b32 v87, 0xf149f2ca
    v_mov_b32 v88, 0xf149f2ca
    v_mov_b32 v89, 0xf149f2ca
    v_mov_b32 v90, 0xf149f2ca
    v_mov_b32 v91, 0xf149f2ca
    s_nop 1
    s_branch p2h_90_b
p2h_91:
    s_nop 7
    v_mov_b32 v17, 0xf149f2ca
    v_mov_b32 v76, 0xf149f2ca
    v_mov_b32 v77, 0xf149f2ca
    v_mov_b32 v78, 0xf149f2ca
    v_mov_b32 v79, 0xf149f2ca
    v_mov_b32 v80, 0xf149f2ca
    v_mov_b32 v81, 0xf149f2ca
    v_mov_b32 v82, 0xf149f2ca
    v_mov_b32 v83, 0xf149f2ca
    v_mov_b32 v84, 0xf149f2ca
    v_mov_b32 v85, 0xf149f2ca
    v_mov_b32 v86, 0xf149f2ca
    v_mov_b32 v87, 0xf149f2ca
    v_mov_b32 v88, 0xf149f2ca
    v_mov_b32 v89, 0xf149f2ca
    v_mov_b32 v90, 0xf149f2ca
    v_mov_b32 v91, 0xf149f2ca
    s_nop 1
    s_branch p2h_91_b
k1_exit:
    s_endpgm
.section .rodata,"a"
.p2align 6
.amdhsa_kernel parallel_sum__sliding_block__glu_gated_reglu__prompt_kernel
  .amdhsa_next_free_vgpr 256
  .amdhsa_next_free_sgpr 102
  .amdhsa_accum_offset 256
  .amdhsa_group_segment_fixed_size 0
  .amdhsa_kernarg_size 80
  .amdhsa_user_sgpr_count 2
  .amdhsa_user_sgpr_kernarg_segment_ptr 1
  .amdhsa_system_sgpr_workgroup_id_x 1
.end_amdhsa_kernel
```
